```python
import torch

def _softmax(x, axis=-1):
    return torch.softmax(x, dim=axis)
def _gelu(x):
    return torch.nn.functional.gelu(x, approximate="tanh")
def _silu(x):
    return torch.nn.functional.silu(x)
def _sigmoid(x):
    return torch.sigmoid(x)
def _layernorm(x, axis=-1, eps=1e-5):
    m = x.mean(dim=axis, keepdim=True)
    v = x.var(dim=axis, keepdim=True, unbiased=False)
    return (x - m) / torch.sqrt(v + eps)
def _scatter_add(tgt, idx, src, axis=0):
    return tgt.clone().index_add_(axis, idx, src)
def _segment_sum(src, seg, n):
    out = torch.zeros((n,) + src.shape[1:], dtype=src.dtype)
    return out.index_add_(0, seg, src)
def _pad(x, pw):
    flat = tuple(v for pair in reversed(pw) for v in pair)
    return torch.nn.functional.pad(x, flat)

kernel_name = 'interleave_layers__ssm_conv_h3__swiglu_ffn__prompt'

def setup_inputs():

    _w = (lambda a: (lambda t: t.to(torch.bfloat16) if t.is_floating_point() else t)(torch.as_tensor(a)))
    def _A_setup():
        B, S, D = 1, 2048, 640
        ks = 4
        return {
            "q": _w((lambda *s: torch.randn(*s, dtype=torch.bfloat16) * 0.05)(B, S, D)),
            "k": _w((lambda *s: torch.randn(*s, dtype=torch.bfloat16) * 1.6)(B, S, D)),
            "v": _w((lambda *s: torch.randn(*s, dtype=torch.bfloat16) * 1.6)(B, S, D)),
            "shift_k": _w((lambda *s: torch.randn(*s, dtype=torch.bfloat16) * 1.6)(D, ks) * 0.5),
            "ssm_k": _w((lambda *s: torch.randn(*s, dtype=torch.bfloat16) * 1.6)(D, S) * (1.0 / S ** 0.5)),
            "ssm_D": _w((lambda *s: torch.randn(*s, dtype=torch.bfloat16) * 1.6)(D)),
        }
    _A_in = _A_setup()

    def _B_setup():
        B, S, D, F = 1, 2048, 640, 1728
        return {
            "x": _w((lambda *s: torch.randn(*s, dtype=torch.bfloat16) * 0.05)(B, S, D)),
            "w_gate": _w((lambda *s: torch.randn(*s, dtype=torch.bfloat16) * 0.2)(D, F)),
            "w_up": _w((lambda *s: torch.randn(*s, dtype=torch.bfloat16) * 0.2)(D, F)),
            "w_down": _w((lambda *s: torch.randn(*s, dtype=torch.bfloat16) * 0.2)(F, D)),
        }
    _B_in = _B_setup()

    return {
        "A_q": _A_in["q"],
        "A_k": _A_in["k"],
        "A_v": _A_in["v"],
        "A_shift_k": _A_in["shift_k"],
        "A_ssm_k": _A_in["ssm_k"],
        "A_ssm_D": _A_in["ssm_D"],
        "B_x": _B_in["x"],
        "B_w_gate": _B_in["w_gate"],
        "B_w_up": _B_in["w_up"],
        "B_w_down": _B_in["w_down"],
    }

def reference(A_q, A_k, A_v, A_shift_k, A_ssm_k, A_ssm_D, B_x, B_w_gate, B_w_up, B_w_down):
    def _A_ref(q, k, v, shift_k, ssm_k, ssm_D):
        B, S, D = q.shape
        ks = shift_k.shape[-1]
        k_pad = _pad(k, ((0, 0), (ks - 1, 0), (0, 0)))
        k_shift = torch.zeros_like(k)
        for t in range(ks):
            k_shift = k_shift + k_pad[:, t:t + S, :] * shift_k[:, ks - 1 - t][None, None, :]
        kv = k_shift * v
        L = 2 * S
        kv_pad = _pad(kv, ((0, 0), (0, S), (0, 0)))
        kf_pad = _pad(ssm_k, ((0, 0), (0, S)))
        kv_f = (lambda x, axes=(-2,-1): torch.fft.rfft2(x.float(), dim=axes))(kv_pad[:, None, :, :], axes=(1, 2))
        kf_f = (lambda x, axes=(-2,-1): torch.fft.rfft2(x.float(), dim=axes))(kf_pad[:, None, :], axes=(1, 2))
        kf_f = (lambda x, *d: x.permute(*d))(kf_f, 1, 2, 0)
        y_f = kv_f * kf_f[None, :, :, :]
        y = (lambda x, s, axes=(-2,-1): torch.fft.irfft2(x, s=s, dim=axes).to(torch.bfloat16))(y_f, (1, L), axes=(1, 2))[:, 0, :S, :]
        y = y + kv * ssm_D[None, None, :]
        return q * y

    def _B_ref(x, w_gate, w_up, w_down):
        g = _silu(x @ w_gate)
        u = x @ w_up
        return (g * u) @ w_down

    x = A_q
    x = x + _A_ref(_layernorm(x, axis=-1), A_k, A_v, A_shift_k, A_ssm_k, A_ssm_D)
    x = x + _B_ref(_layernorm(x, axis=-1), B_w_gate, B_w_up, B_w_down)
    x = x + _A_ref(_layernorm(x, axis=-1), A_k, A_v, A_shift_k, A_ssm_k, A_ssm_D)
    x = x + _B_ref(_layernorm(x, axis=-1), B_w_gate, B_w_up, B_w_down)
    return x
```

```asm
; @launch grid=(256,1,1) block=(256,1,1) lds=163840
.amdgcn_target "amdgcn-amd-amdhsa--gfx950"
.text
.globl interleave_layers__ssm_conv_h3__swiglu_ffn__prompt_kernel
.p2align 8
.type interleave_layers__ssm_conv_h3__swiglu_ffn__prompt_kernel,@function
interleave_layers__ssm_conv_h3__swiglu_ffn__prompt_kernel:
    s_cmp_ge_u32 s2, 256
    s_cbranch_scc1 L_exit
    s_getpc_b64 s[16:17]
L_pc:
    s_lshr_b32 s18, s2, 3
    s_lshl_b32 s18, s18, 12
    v_lshlrev_b32 v4, 4, v0
    v_add_u32 v4, s18, v4
    v_min_u32 v4, L_code_end-L_pc-16, v4
    v_mov_b32 v5, s17
    v_add_co_u32 v4, vcc, s16, v4
    s_nop 1
    v_addc_co_u32 v5, vcc, 0, v5, vcc
    global_load_dwordx4 v[248:251], v[4:5], off
    s_load_dwordx2 s[4:5], s[0:1], 96
    s_mov_b32 s6, 38273024
    s_mov_b32 s7, 0x00020000
    v_lshrrev_b32 v1, 6, v0
    s_nop 0
    v_readfirstlane_b32 s59, v1
    s_and_b32 s62, s2, 7
    s_lshr_b32 s63, s2, 3
    s_lshr_b32 s64, s62, 1
    s_lshl_b32 s64, s64, 2
    s_lshr_b32 s65, s63, 3
    s_add_u32 s64, s64, s65
    s_lshr_b32 s68, s62, 1
    s_lshl_b32 s68, s68, 3
    s_add_u32 s68, s68, s65
    s_and_b32 s62, s62, 1
    s_lshl_b32 s69, s62, 2
    s_add_u32 s68, s68, s69
    s_and_b32 s69, s63, 7
    s_lshl_b32 s65, s62, 3
    s_add_u32 s65, s65, s69
    s_mul_i32 s66, s65, 7
    s_mul_i32 s62, s65, 6
    s_add_u32 s62, s62, 12
    s_cmp_lt_u32 s65, 12
    s_cselect_b32 s66, s66, s62
    s_mul_i32 s67, s66, 40960
    s_add_u32 s67, s67, 16777216
    s_lshl_b32 s71, s59, 12
    s_cmp_ge_u32 s2, 160
    s_cbranch_scc1 L_roleP
    s_load_dwordx2 s[8:9], s[0:1], 8
    s_mov_b32 s10, 2621440
    s_mov_b32 s11, 0x00020000
    s_load_dwordx2 s[12:13], s[0:1], 16
    s_mov_b32 s14, 2621440
    s_mov_b32 s15, 0x00020000
    s_load_dwordx2 s[16:17], s[0:1], 24
    s_mov_b32 s18, 5120
    s_mov_b32 s19, 0x00020000
    s_load_dwordx2 s[20:21], s[0:1], 32
    s_mov_b32 s22, 2621440
    s_mov_b32 s23, 0x00020000
    s_load_dwordx2 s[24:25], s[0:1], 40
    s_mov_b32 s26, 1280
    s_mov_b32 s27, 0x00020000
    s_load_dwordx2 s[92:93], s[0:1], 0
    s_mov_b32 s94, 2621440
    s_mov_b32 s95, 0x00020000
    s_waitcnt lgkmcnt(0)
    s_load_dword s3, s[4:5], 0
    s_mul_i32 s28, s2, 205
    s_lshr_b32 s28, s28, 10
    s_mul_i32 s29, s28, 5
    s_sub_u32 s29, s2, s29
    v_bfe_u32 v1, v0, 4, 2
    v_lshrrev_b32 v2, 7, v0
    v_lshl_add_u32 v1, v2, 2, v1
    v_and_b32 v2, 15, v0
    v_bfe_u32 v3, v0, 6, 1
    v_lshl_add_u32 v2, v3, 4, v2
    s_mul_i32 s30, s28, 81920
    s_lshl_b32 s31, s29, 8
    s_add_u32 s30, s30, s31
    v_mul_u32_u24 v3, 10240, v1
    v_lshl_add_u32 v3, v2, 3, v3
    v_add_u32 v3, s30, v3
    v_add_u32 v4, 5120, v3
    v_subrev_u32 v5, 3840, v3
    s_lshl_b32 s31, s29, 10
    v_lshlrev_b32 v6, 5, v2
    v_add_u32 v6, s31, v6
    buffer_load_dwordx2 v[10:11], v5, s[8:11], 0 offen offset:0
    buffer_load_dwordx2 v[12:13], v5, s[8:11], 0 offen offset:1280
    buffer_load_dwordx2 v[14:15], v5, s[8:11], 0 offen offset:2560
    buffer_load_dwordx2 v[16:17], v3, s[8:11], 0 offen offset:0
    buffer_load_dwordx2 v[18:19], v3, s[8:11], 0 offen offset:1280
    buffer_load_dwordx2 v[20:21], v3, s[8:11], 0 offen offset:2560
    buffer_load_dwordx2 v[22:23], v3, s[8:11], 0 offen offset:3840
    buffer_load_dwordx2 v[24:25], v4, s[8:11], 0 offen offset:0
    buffer_load_dwordx2 v[26:27], v4, s[8:11], 0 offen offset:1280
    buffer_load_dwordx2 v[28:29], v4, s[8:11], 0 offen offset:2560
    buffer_load_dwordx2 v[30:31], v4, s[8:11], 0 offen offset:3840
    buffer_load_dwordx4 v[48:51], v6, s[16:19], 0 offen
    buffer_load_dwordx4 v[52:55], v6, s[16:19], 0 offen offset:16
    buffer_load_dwordx2 v[32:33], v3, s[12:15], 0 offen offset:0
    buffer_load_dwordx2 v[34:35], v3, s[12:15], 0 offen offset:1280
    buffer_load_dwordx2 v[36:37], v3, s[12:15], 0 offen offset:2560
    buffer_load_dwordx2 v[38:39], v3, s[12:15], 0 offen offset:3840
    buffer_load_dwordx2 v[40:41], v4, s[12:15], 0 offen offset:0
    buffer_load_dwordx2 v[42:43], v4, s[12:15], 0 offen offset:1280
    buffer_load_dwordx2 v[44:45], v4, s[12:15], 0 offen offset:2560
    buffer_load_dwordx2 v[46:47], v4, s[12:15], 0 offen offset:3840
    v_and_b32 v8, 7, v2
    v_xor_b32 v8, v8, v1
    v_lshlrev_b32 v8, 4, v8
    v_lshl_add_u32 v8, v2, 9, v8
    v_lshrrev_b32 v9, 5, v0
    v_and_b32 v7, 7, v0
    v_xor_b32 v9, v9, v7
    v_lshlrev_b32 v9, 4, v9
    v_lshrrev_b32 v148, 3, v0
    v_lshl_add_u32 v9, v148, 7, v9
    s_lshl_b32 s30, s29, 19
    s_lshl_b32 s31, s28, 7
    s_add_u32 s30, s30, s31
    v_lshlrev_b32 v7, 4, v7
    v_lshl_add_u32 v7, v148, 12, v7
    v_add_u32 v7, s30, v7
    s_mov_b32 s36, 1048576
    s_mov_b32 s37, 1179648
    s_mov_b32 s38, 1310720
    s_mov_b32 s39, 1441792
    s_mov_b32 s40, 0xffff0000
    s_waitcnt lgkmcnt(0)
    s_mul_i32 s3, s3, 1664525
    s_add_u32 s3, s3, 1013904223
    s_getreg_b32 s89, hwreg(HW_REG_XCC_ID, 0, 4)
    s_cmp_lg_u32 s59, 0
    s_cbranch_scc1 L_xt_1
    s_and_b32 s90, s2, 7
    s_lshl_b32 s90, s90, 8
    s_lshr_b32 s91, s2, 3
    s_lshl_b32 s91, s91, 3
    s_add_u32 s90, s90, s91
    s_add_u32 s90, s90, 28672
    v_mov_b32 v150, 0
    v_mov_b32 v154, s3
    v_mov_b32 v155, s89
    s_mov_b64 exec, 1
    buffer_store_dwordx2 v[154:155], v150, s[4:7], s90 offen sc1
    s_mov_b64 exec, -1
L_xt_1:
    s_waitcnt vmcnt(8)
    s_and_b32 s96, s2, 7
    s_mul_i32 s96, s96, 20
    s_lshr_b32 s32, s2, 3
    s_add_u32 s96, s96, s32
    s_lshl_b32 s32, s96, 2
    s_add_u32 s32, s32, s59
    s_lshl_b32 s33, s32, 12
    s_add_u32 s20, s20, s33
    s_addc_u32 s21, s21, 0
    s_mov_b32 s22, 4096
    v_and_b32 v160, 63, v0
    v_lshlrev_b32 v161, 4, v160
    v_subrev_u32 v162, 32, v161
    v_add_u32 v163, 16, v162
    v_add_u32 v164, 0x1000, v162
    v_add_u32 v165, 0x1000, v163
    buffer_load_dwordx4 v[192:195], v162, s[20:23], 0 offen nt
    buffer_load_dwordx2 v[196:197], v163, s[20:23], 0 offen nt
    buffer_load_dwordx4 v[198:201], v161, s[20:23], 0 offen offset:992 nt
    buffer_load_dwordx2 v[202:203], v161, s[20:23], 0 offen offset:1008 nt
    buffer_load_dwordx4 v[204:207], v161, s[20:23], 0 offen offset:2016 nt
    buffer_load_dwordx2 v[208:209], v161, s[20:23], 0 offen offset:2032 nt
    buffer_load_dwordx4 v[210:213], v161, s[20:23], 0 offen offset:3040 nt
    buffer_load_dwordx2 v[214:215], v161, s[20:23], 0 offen offset:3056 nt
    buffer_load_dwordx4 v[216:219], v164, s[20:23], 0 offen nt
    buffer_load_dwordx2 v[220:221], v165, s[20:23], 0 offen nt
    s_lshl_b32 s34, s32, 1
    v_mov_b32 v166, s34
    buffer_load_ushort v153, v166, s[24:27], 0 offen
    v_lshlrev_b32 v56, 16, v10
    v_and_b32 v57, s40, v10
    v_lshlrev_b32 v58, 16, v11
    v_and_b32 v59, s40, v11
    v_lshlrev_b32 v60, 16, v12
    v_and_b32 v61, s40, v12
    v_lshlrev_b32 v62, 16, v13
    v_and_b32 v63, s40, v13
    v_lshlrev_b32 v64, 16, v14
    v_and_b32 v65, s40, v14
    v_lshlrev_b32 v66, 16, v15
    v_and_b32 v67, s40, v15
    v_lshlrev_b32 v68, 16, v16
    v_and_b32 v69, s40, v16
    v_lshlrev_b32 v70, 16, v17
    v_and_b32 v71, s40, v17
    v_lshlrev_b32 v72, 16, v18
    v_and_b32 v73, s40, v18
    v_lshlrev_b32 v74, 16, v19
    v_and_b32 v75, s40, v19
    v_lshlrev_b32 v76, 16, v20
    v_and_b32 v77, s40, v20
    v_lshlrev_b32 v78, 16, v21
    v_and_b32 v79, s40, v21
    v_lshlrev_b32 v80, 16, v22
    v_and_b32 v81, s40, v22
    v_lshlrev_b32 v82, 16, v23
    v_and_b32 v83, s40, v23
    v_lshlrev_b32 v84, 16, v24
    v_and_b32 v85, s40, v24
    v_lshlrev_b32 v86, 16, v25
    v_and_b32 v87, s40, v25
    v_lshlrev_b32 v88, 16, v26
    v_and_b32 v89, s40, v26
    v_lshlrev_b32 v90, 16, v27
    v_and_b32 v91, s40, v27
    v_lshlrev_b32 v92, 16, v28
    v_and_b32 v93, s40, v28
    v_lshlrev_b32 v94, 16, v29
    v_and_b32 v95, s40, v29
    v_lshlrev_b32 v96, 16, v30
    v_and_b32 v97, s40, v30
    v_lshlrev_b32 v98, 16, v31
    v_and_b32 v99, s40, v31
    v_lshlrev_b32 v100, 16, v48
    v_and_b32 v104, s40, v48
    v_lshlrev_b32 v108, 16, v49
    v_and_b32 v112, s40, v49
    v_lshlrev_b32 v101, 16, v50
    v_and_b32 v105, s40, v50
    v_lshlrev_b32 v109, 16, v51
    v_and_b32 v113, s40, v51
    v_lshlrev_b32 v102, 16, v52
    v_and_b32 v106, s40, v52
    v_lshlrev_b32 v110, 16, v53
    v_and_b32 v114, s40, v53
    v_lshlrev_b32 v103, 16, v54
    v_and_b32 v107, s40, v54
    v_lshlrev_b32 v111, 16, v55
    v_and_b32 v115, s40, v55
    v_pk_mul_f32 v[116:117], v[68:69], v[100:101]
    v_pk_fma_f32 v[116:117], v[64:65], v[104:105], v[116:117]
    v_pk_fma_f32 v[116:117], v[60:61], v[108:109], v[116:117]
    v_pk_fma_f32 v[116:117], v[56:57], v[112:113], v[116:117]
    v_pk_mul_f32 v[118:119], v[70:71], v[102:103]
    v_pk_fma_f32 v[118:119], v[66:67], v[106:107], v[118:119]
    v_pk_fma_f32 v[118:119], v[62:63], v[110:111], v[118:119]
    v_pk_fma_f32 v[118:119], v[58:59], v[114:115], v[118:119]
    v_pk_mul_f32 v[120:121], v[72:73], v[100:101]
    v_pk_fma_f32 v[120:121], v[68:69], v[104:105], v[120:121]
    v_pk_fma_f32 v[120:121], v[64:65], v[108:109], v[120:121]
    v_pk_fma_f32 v[120:121], v[60:61], v[112:113], v[120:121]
    v_pk_mul_f32 v[122:123], v[74:75], v[102:103]
    v_pk_fma_f32 v[122:123], v[70:71], v[106:107], v[122:123]
    v_pk_fma_f32 v[122:123], v[66:67], v[110:111], v[122:123]
    v_pk_fma_f32 v[122:123], v[62:63], v[114:115], v[122:123]
    v_pk_mul_f32 v[124:125], v[76:77], v[100:101]
    v_pk_fma_f32 v[124:125], v[72:73], v[104:105], v[124:125]
    v_pk_fma_f32 v[124:125], v[68:69], v[108:109], v[124:125]
    v_pk_fma_f32 v[124:125], v[64:65], v[112:113], v[124:125]
    v_pk_mul_f32 v[126:127], v[78:79], v[102:103]
    v_pk_fma_f32 v[126:127], v[74:75], v[106:107], v[126:127]
    v_pk_fma_f32 v[126:127], v[70:71], v[110:111], v[126:127]
    v_pk_fma_f32 v[126:127], v[66:67], v[114:115], v[126:127]
    v_pk_mul_f32 v[128:129], v[80:81], v[100:101]
    v_pk_fma_f32 v[128:129], v[76:77], v[104:105], v[128:129]
    v_pk_fma_f32 v[128:129], v[72:73], v[108:109], v[128:129]
    v_pk_fma_f32 v[128:129], v[68:69], v[112:113], v[128:129]
    v_pk_mul_f32 v[130:131], v[82:83], v[102:103]
    v_pk_fma_f32 v[130:131], v[78:79], v[106:107], v[130:131]
    v_pk_fma_f32 v[130:131], v[74:75], v[110:111], v[130:131]
    v_pk_fma_f32 v[130:131], v[70:71], v[114:115], v[130:131]
    v_pk_mul_f32 v[132:133], v[84:85], v[100:101]
    v_pk_fma_f32 v[132:133], v[80:81], v[104:105], v[132:133]
    v_pk_fma_f32 v[132:133], v[76:77], v[108:109], v[132:133]
    v_pk_fma_f32 v[132:133], v[72:73], v[112:113], v[132:133]
    v_pk_mul_f32 v[134:135], v[86:87], v[102:103]
    v_pk_fma_f32 v[134:135], v[82:83], v[106:107], v[134:135]
    v_pk_fma_f32 v[134:135], v[78:79], v[110:111], v[134:135]
    v_pk_fma_f32 v[134:135], v[74:75], v[114:115], v[134:135]
    v_pk_mul_f32 v[136:137], v[88:89], v[100:101]
    v_pk_fma_f32 v[136:137], v[84:85], v[104:105], v[136:137]
    v_pk_fma_f32 v[136:137], v[80:81], v[108:109], v[136:137]
    v_pk_fma_f32 v[136:137], v[76:77], v[112:113], v[136:137]
    v_pk_mul_f32 v[138:139], v[90:91], v[102:103]
    v_pk_fma_f32 v[138:139], v[86:87], v[106:107], v[138:139]
    v_pk_fma_f32 v[138:139], v[82:83], v[110:111], v[138:139]
    v_pk_fma_f32 v[138:139], v[78:79], v[114:115], v[138:139]
    v_pk_mul_f32 v[140:141], v[92:93], v[100:101]
    v_pk_fma_f32 v[140:141], v[88:89], v[104:105], v[140:141]
    v_pk_fma_f32 v[140:141], v[84:85], v[108:109], v[140:141]
    v_pk_fma_f32 v[140:141], v[80:81], v[112:113], v[140:141]
    v_pk_mul_f32 v[142:143], v[94:95], v[102:103]
    v_pk_fma_f32 v[142:143], v[90:91], v[106:107], v[142:143]
    v_pk_fma_f32 v[142:143], v[86:87], v[110:111], v[142:143]
    v_pk_fma_f32 v[142:143], v[82:83], v[114:115], v[142:143]
    v_pk_mul_f32 v[144:145], v[96:97], v[100:101]
    v_pk_fma_f32 v[144:145], v[92:93], v[104:105], v[144:145]
    v_pk_fma_f32 v[144:145], v[88:89], v[108:109], v[144:145]
    v_pk_fma_f32 v[144:145], v[84:85], v[112:113], v[144:145]
    v_pk_mul_f32 v[146:147], v[98:99], v[102:103]
    v_pk_fma_f32 v[146:147], v[94:95], v[106:107], v[146:147]
    v_pk_fma_f32 v[146:147], v[90:91], v[110:111], v[146:147]
    v_pk_fma_f32 v[146:147], v[86:87], v[114:115], v[146:147]
    s_waitcnt vmcnt(18)
    v_lshlrev_b32 v56, 16, v32
    v_and_b32 v57, s40, v32
    v_pk_mul_f32 v[116:117], v[116:117], v[56:57]
    v_lshlrev_b32 v58, 16, v33
    v_and_b32 v59, s40, v33
    v_pk_mul_f32 v[118:119], v[118:119], v[58:59]
    s_waitcnt vmcnt(17)
    v_lshlrev_b32 v60, 16, v34
    v_and_b32 v61, s40, v34
    v_pk_mul_f32 v[120:121], v[120:121], v[60:61]
    v_lshlrev_b32 v62, 16, v35
    v_and_b32 v63, s40, v35
    v_pk_mul_f32 v[122:123], v[122:123], v[62:63]
    s_waitcnt vmcnt(16)
    v_lshlrev_b32 v64, 16, v36
    v_and_b32 v65, s40, v36
    v_pk_mul_f32 v[124:125], v[124:125], v[64:65]
    v_lshlrev_b32 v66, 16, v37
    v_and_b32 v67, s40, v37
    v_pk_mul_f32 v[126:127], v[126:127], v[66:67]
    s_waitcnt vmcnt(15)
    v_lshlrev_b32 v68, 16, v38
    v_and_b32 v69, s40, v38
    v_pk_mul_f32 v[128:129], v[128:129], v[68:69]
    v_lshlrev_b32 v70, 16, v39
    v_and_b32 v71, s40, v39
    v_pk_mul_f32 v[130:131], v[130:131], v[70:71]
    s_waitcnt vmcnt(14)
    v_lshlrev_b32 v72, 16, v40
    v_and_b32 v73, s40, v40
    v_pk_mul_f32 v[132:133], v[132:133], v[72:73]
    v_lshlrev_b32 v74, 16, v41
    v_and_b32 v75, s40, v41
    v_pk_mul_f32 v[134:135], v[134:135], v[74:75]
    s_waitcnt vmcnt(13)
    v_lshlrev_b32 v76, 16, v42
    v_and_b32 v77, s40, v42
    v_pk_mul_f32 v[136:137], v[136:137], v[76:77]
    v_lshlrev_b32 v78, 16, v43
    v_and_b32 v79, s40, v43
    v_pk_mul_f32 v[138:139], v[138:139], v[78:79]
    s_waitcnt vmcnt(12)
    v_lshlrev_b32 v80, 16, v44
    v_and_b32 v81, s40, v44
    v_pk_mul_f32 v[140:141], v[140:141], v[80:81]
    v_lshlrev_b32 v82, 16, v45
    v_and_b32 v83, s40, v45
    v_pk_mul_f32 v[142:143], v[142:143], v[82:83]
    s_waitcnt vmcnt(11)
    v_lshlrev_b32 v84, 16, v46
    v_and_b32 v85, s40, v46
    v_pk_mul_f32 v[144:145], v[144:145], v[84:85]
    v_lshlrev_b32 v86, 16, v47
    v_and_b32 v87, s40, v47
    v_pk_mul_f32 v[146:147], v[146:147], v[86:87]
    v_cvt_pk_bf16_f32 v12, v144, v140
    v_cvt_pk_bf16_f32 v13, v136, v132
    v_cvt_pk_bf16_f32 v14, v128, v124
    v_cvt_pk_bf16_f32 v15, v120, v116
    ds_write_b128 v8, v[12:15] offset:0
    v_cvt_pk_bf16_f32 v16, v145, v141
    v_cvt_pk_bf16_f32 v17, v137, v133
    v_cvt_pk_bf16_f32 v18, v129, v125
    v_cvt_pk_bf16_f32 v19, v121, v117
    ds_write_b128 v8, v[16:19] offset:128
    v_cvt_pk_bf16_f32 v20, v146, v142
    v_cvt_pk_bf16_f32 v21, v138, v134
    v_cvt_pk_bf16_f32 v22, v130, v126
    v_cvt_pk_bf16_f32 v23, v122, v118
    ds_write_b128 v8, v[20:23] offset:256
    v_cvt_pk_bf16_f32 v24, v147, v143
    v_cvt_pk_bf16_f32 v25, v139, v135
    v_cvt_pk_bf16_f32 v26, v131, v127
    v_cvt_pk_bf16_f32 v27, v123, v119
    ds_write_b128 v8, v[24:27] offset:384
    s_waitcnt lgkmcnt(0)
    s_barrier
    ds_read_b128 v[12:15], v9 offset:0
    ds_read_b128 v[16:19], v9 offset:4096
    ds_read_b128 v[20:23], v9 offset:8192
    ds_read_b128 v[24:27], v9 offset:12288
    s_waitcnt lgkmcnt(3)
    buffer_store_dwordx4 v[12:15], v7, s[4:7], s36 offen sc1
    s_waitcnt lgkmcnt(2)
    buffer_store_dwordx4 v[16:19], v7, s[4:7], s37 offen sc1
    s_waitcnt lgkmcnt(1)
    buffer_store_dwordx4 v[20:23], v7, s[4:7], s38 offen sc1
    s_waitcnt lgkmcnt(0)
    buffer_store_dwordx4 v[24:27], v7, s[4:7], s39 offen sc1
    buffer_load_dwordx2 v[128:129], v3, s[92:95], 0 offen offset:0
    buffer_load_dwordx2 v[130:131], v3, s[92:95], 0 offen offset:1280
    buffer_load_dwordx2 v[132:133], v3, s[92:95], 0 offen offset:2560
    buffer_load_dwordx2 v[134:135], v3, s[92:95], 0 offen offset:3840
    buffer_load_dwordx2 v[136:137], v4, s[92:95], 0 offen offset:0
    buffer_load_dwordx2 v[138:139], v4, s[92:95], 0 offen offset:1280
    buffer_load_dwordx2 v[140:141], v4, s[92:95], 0 offen offset:2560
    buffer_load_dwordx2 v[142:143], v4, s[92:95], 0 offen offset:3840
    s_lshl_b32 s98, s2, 2
    s_add_u32 s98, s98, s59
    s_cmp_lt_u32 s2, 128
    s_cselect_b32 s99, 0, 2147483648
    s_mul_i32 s97, s98, 5120
    v_bfe_u32 v150, v0, 4, 2
    v_mul_u32_u24 v150, 1280, v150
    v_and_b32 v151, 15, v0
    v_lshl_add_u32 v150, v151, 4, v150
    v_or_b32 v150, s99, v150
    buffer_load_dwordx4 v[168:171], v150, s[92:95], s97 offen offset:0
    buffer_load_dwordx4 v[172:175], v150, s[92:95], s97 offen offset:256
    buffer_load_dwordx4 v[176:179], v150, s[92:95], s97 offen offset:512
    buffer_load_dwordx4 v[180:183], v150, s[92:95], s97 offen offset:768
    buffer_load_dwordx4 v[184:187], v150, s[92:95], s97 offen offset:1024
    s_lshl_b32 s41, s29, 7
    s_add_u32 s41, s41, s28
    s_lshl_b32 s41, s41, 2
    s_add_u32 s41, s41, 4096
    v_and_b32 v2, 63, v0
    v_lshlrev_b32 v3, 4, v2
    s_mul_i32 s35, s59, 21248
    s_add_u32 s35, s35, 78848
    v_add_u32 v14, s35, v3
    v_and_b32 v15, 15, v2
    v_lshrrev_b32 v16, 4, v2
    v_add_u32 v17, 1, v15
    v_and_b32 v18, 3, v17
    v_lshrrev_b32 v17, 2, v17
    v_mul_u32_u24 v18, 4160, v18
    v_lshl_add_u32 v18, v17, 3, v18
    v_lshl_add_u32 v18, v16, 4, v18
    v_add_u32 v18, s35, v18
    v_lshlrev_b32 v19, 5, v15
    v_lshlrev_b32 v20, 4, v16
    v_sub_u32 v19, v19, v20
    v_add_u32 v19, s35, v19
    v_add_u32 v19, 17168, v19
    v_mov_b32 v28, 0
    v_mov_b32 v29, 0
    v_mov_b32 v30, 0
    v_mov_b32 v31, 0
    s_mov_b64 exec, 0xffffffff
    ds_write_b128 v14, v[28:31] offset:16640
    s_mov_b64 exec, -1
    s_waitcnt vmcnt(13)
    s_waitcnt lgkmcnt(0)
    s_barrier
    s_cmp_lg_u32 s59, 0
    s_cbranch_scc1 L_fs_2
    v_mbcnt_lo_u32_b32 v4, -1, 0
    v_mul_u32_u24 v4, 128, v4
    v_mov_b32 v5, s3
    s_mov_b64 exec, 15
    buffer_store_dword v5, v4, s[4:7], s41 offen sc1
    s_mov_b64 exec, -1
L_fs_2:
    s_lshr_b32 s42, s96, 5
    s_lshl_b32 s42, s42, 2
    s_and_b32 s43, s2, 3
    s_add_u32 s42, s42, s43
    s_lshl_b32 s42, s42, 7
    s_add_u32 s42, s42, 4096
    v_and_b32 v4, 31, v2
    v_lshlrev_b32 v4, 2, v4
    s_cmp_lg_u32 s59, 1
    s_cbranch_scc1 L_p1_3
    buffer_load_dword v5, v4, s[4:7], s42 offen sc1
L_p1_3:
    ds_write_b128 v14, v[192:195] offset:0
    v_alignbit_b32 v96, v193, v192, 16
    v_alignbit_b32 v97, v194, v193, 16
    v_alignbit_b32 v98, v195, v194, 16
    v_alignbit_b32 v99, v196, v195, 16
    ds_write_b128 v14, v[96:99] offset:4160
    v_mov_b32 v100, v193
    v_mov_b32 v101, v194
    v_mov_b32 v102, v195
    v_mov_b32 v103, v196
    ds_write_b128 v14, v[100:103] offset:8320
    v_alignbit_b32 v104, v194, v193, 16
    v_alignbit_b32 v105, v195, v194, 16
    v_alignbit_b32 v106, v196, v195, 16
    v_alignbit_b32 v107, v197, v196, 16
    ds_write_b128 v14, v[104:107] offset:12480
    ds_write_b128 v14, v[198:201] offset:1024
    v_alignbit_b32 v96, v199, v198, 16
    v_alignbit_b32 v97, v200, v199, 16
    v_alignbit_b32 v98, v201, v200, 16
    v_alignbit_b32 v99, v202, v201, 16
    ds_write_b128 v14, v[96:99] offset:5184
    v_mov_b32 v100, v199
    v_mov_b32 v101, v200
    v_mov_b32 v102, v201
    v_mov_b32 v103, v202
    ds_write_b128 v14, v[100:103] offset:9344
    v_alignbit_b32 v104, v200, v199, 16
    v_alignbit_b32 v105, v201, v200, 16
    v_alignbit_b32 v106, v202, v201, 16
    v_alignbit_b32 v107, v203, v202, 16
    ds_write_b128 v14, v[104:107] offset:13504
    ds_write_b128 v14, v[204:207] offset:2048
    v_alignbit_b32 v96, v205, v204, 16
    v_alignbit_b32 v97, v206, v205, 16
    v_alignbit_b32 v98, v207, v206, 16
    v_alignbit_b32 v99, v208, v207, 16
    ds_write_b128 v14, v[96:99] offset:6208
    v_mov_b32 v100, v205
    v_mov_b32 v101, v206
    v_mov_b32 v102, v207
    v_mov_b32 v103, v208
    ds_write_b128 v14, v[100:103] offset:10368
    v_alignbit_b32 v104, v206, v205, 16
    v_alignbit_b32 v105, v207, v206, 16
    v_alignbit_b32 v106, v208, v207, 16
    v_alignbit_b32 v107, v209, v208, 16
    ds_write_b128 v14, v[104:107] offset:14528
    ds_write_b128 v14, v[210:213] offset:3072
    v_alignbit_b32 v96, v211, v210, 16
    v_alignbit_b32 v97, v212, v211, 16
    v_alignbit_b32 v98, v213, v212, 16
    v_alignbit_b32 v99, v214, v213, 16
    ds_write_b128 v14, v[96:99] offset:7232
    v_mov_b32 v100, v211
    v_mov_b32 v101, v212
    v_mov_b32 v102, v213
    v_mov_b32 v103, v214
    ds_write_b128 v14, v[100:103] offset:11392
    v_alignbit_b32 v104, v212, v211, 16
    v_alignbit_b32 v105, v213, v212, 16
    v_alignbit_b32 v106, v214, v213, 16
    v_alignbit_b32 v107, v215, v214, 16
    ds_write_b128 v14, v[104:107] offset:15552
    s_mov_b64 exec, 3
    ds_write_b128 v14, v[216:219] offset:4096
    v_alignbit_b32 v96, v217, v216, 16
    v_alignbit_b32 v97, v218, v217, 16
    v_alignbit_b32 v98, v219, v218, 16
    v_alignbit_b32 v99, v220, v219, 16
    ds_write_b128 v14, v[96:99] offset:8256
    v_mov_b32 v100, v217
    v_mov_b32 v101, v218
    v_mov_b32 v102, v219
    v_mov_b32 v103, v220
    ds_write_b128 v14, v[100:103] offset:12416
    v_alignbit_b32 v104, v218, v217, 16
    v_alignbit_b32 v105, v219, v218, 16
    v_alignbit_b32 v106, v220, v219, 16
    v_alignbit_b32 v107, v221, v220, 16
    ds_write_b128 v14, v[104:107] offset:16576
    s_mov_b64 exec, -1
    v_lshl_add_u32 v21, v16, 3, v15
    v_sub_u32 v21, 15, v21
    v_and_b32 v22, 1, v21
    v_lshlrev_b32 v22, 4, v22
    v_lshlrev_b32 v22, v22, v153
    v_ashrrev_i32 v21, 1, v21
    s_waitcnt lgkmcnt(0)
    v_cmp_eq_u32 vcc, 0, v21
    s_nop 1
    v_cndmask_b32 v28, 0, v22, vcc
    v_cmp_eq_u32 vcc, 1, v21
    s_nop 1
    v_cndmask_b32 v29, 0, v22, vcc
    v_cmp_eq_u32 vcc, 2, v21
    s_nop 1
    v_cndmask_b32 v30, 0, v22, vcc
    v_cmp_eq_u32 vcc, 3, v21
    s_nop 1
    v_cndmask_b32 v31, 0, v22, vcc
    s_cmp_lg_u32 s59, 1
    s_cbranch_scc1 L_p1c_4
    s_waitcnt vmcnt(0)
    v_cmp_ne_u32 vcc, s3, v5
    s_cbranch_vccnz L_spin_5
L_back_6:
L_p1c_4:
    s_barrier
    s_add_u32 s43, s33, 1048576
    s_add_u32 s44, s35, 17152
    s_mov_b32 m0, s44
    s_nop 0
    buffer_load_dwordx4 v3, s[4:7], s43 offen offset:0 sc1 lds
    buffer_load_dwordx4 v3, s[4:7], s43 offen offset:1024 sc1 lds
    buffer_load_dwordx4 v3, s[4:7], s43 offen offset:2048 sc1 lds
    buffer_load_dwordx4 v3, s[4:7], s43 offen offset:3072 sc1 lds
    s_mov_b32 s39, 0x3f803f80
    s_lshl_b32 s97, s59, 12
    v_lshlrev_b32 v24, 2, v16
    v_lshl_add_u32 v25, v15, 8, s97
    s_waitcnt vmcnt(4)
    v_add_u32 v27, 0, v24
    v_xor_b32 v27, v27, v15
    v_lshl_add_u32 v27, v27, 4, v25
    ds_write_b128 v27, v[128:131]
    v_add_u32 v27, 1, v24
    v_xor_b32 v27, v27, v15
    v_lshl_add_u32 v27, v27, 4, v25
    ds_write_b128 v27, v[132:135]
    v_add_u32 v27, 2, v24
    v_xor_b32 v27, v27, v15
    v_lshl_add_u32 v27, v27, 4, v25
    ds_write_b128 v27, v[136:139]
    v_add_u32 v27, 3, v24
    v_xor_b32 v27, v27, v15
    v_lshl_add_u32 v27, v27, 4, v25
    ds_write_b128 v27, v[140:143]
    v_dot2_f32_bf16 v188, v168, s39, 0
    v_dot2_f32_bf16 v189, v168, v168, 0
    v_dot2_f32_bf16 v190, v169, s39, 0
    v_dot2_f32_bf16 v191, v169, v169, 0
    v_dot2_f32_bf16 v188, v170, s39, v188
    v_dot2_f32_bf16 v189, v170, v170, v189
    v_dot2_f32_bf16 v190, v171, s39, v190
    v_dot2_f32_bf16 v191, v171, v171, v191
    v_dot2_f32_bf16 v188, v172, s39, v188
    v_dot2_f32_bf16 v189, v172, v172, v189
    v_dot2_f32_bf16 v190, v173, s39, v190
    v_dot2_f32_bf16 v191, v173, v173, v191
    v_dot2_f32_bf16 v188, v174, s39, v188
    v_dot2_f32_bf16 v189, v174, v174, v189
    v_dot2_f32_bf16 v190, v175, s39, v190
    v_dot2_f32_bf16 v191, v175, v175, v191
    v_dot2_f32_bf16 v188, v176, s39, v188
    v_dot2_f32_bf16 v189, v176, v176, v189
    v_dot2_f32_bf16 v190, v177, s39, v190
    v_dot2_f32_bf16 v191, v177, v177, v191
    v_dot2_f32_bf16 v188, v178, s39, v188
    v_dot2_f32_bf16 v189, v178, v178, v189
    v_dot2_f32_bf16 v190, v179, s39, v190
    v_dot2_f32_bf16 v191, v179, v179, v191
    v_dot2_f32_bf16 v188, v180, s39, v188
    v_dot2_f32_bf16 v189, v180, v180, v189
    v_dot2_f32_bf16 v190, v181, s39, v190
    v_dot2_f32_bf16 v191, v181, v181, v191
    v_dot2_f32_bf16 v188, v182, s39, v188
    v_dot2_f32_bf16 v189, v182, v182, v189
    v_dot2_f32_bf16 v190, v183, s39, v190
    v_dot2_f32_bf16 v191, v183, v183, v191
    v_dot2_f32_bf16 v188, v184, s39, v188
    v_dot2_f32_bf16 v189, v184, v184, v189
    v_dot2_f32_bf16 v190, v185, s39, v190
    v_dot2_f32_bf16 v191, v185, v185, v191
    v_dot2_f32_bf16 v188, v186, s39, v188
    v_dot2_f32_bf16 v189, v186, v186, v189
    v_dot2_f32_bf16 v190, v187, s39, v190
    v_dot2_f32_bf16 v191, v187, v187, v191
    s_waitcnt lgkmcnt(0)
    v_add_u32 v27, 0, v16
    v_xor_b32 v26, v27, v15
    v_lshlrev_b32 v26, 4, v26
    v_lshl_add_u32 v26, v27, 8, v26
    v_add_u32 v26, s97, v26
    ds_read_b128 v[128:131], v26
    v_add_u32 v27, 4, v16
    v_xor_b32 v26, v27, v15
    v_lshlrev_b32 v26, 4, v26
    v_lshl_add_u32 v26, v27, 8, v26
    v_add_u32 v26, s97, v26
    ds_read_b128 v[132:135], v26
    v_add_u32 v27, 8, v16
    v_xor_b32 v26, v27, v15
    v_lshlrev_b32 v26, 4, v26
    v_lshl_add_u32 v26, v27, 8, v26
    v_add_u32 v26, s97, v26
    ds_read_b128 v[136:139], v26
    v_add_u32 v27, 12, v16
    v_xor_b32 v26, v27, v15
    v_lshlrev_b32 v26, 4, v26
    v_lshl_add_u32 v26, v27, 8, v26
    v_add_u32 v26, s97, v26
    ds_read_b128 v[140:143], v26
    v_add_f32 v188, v188, v190
    v_add_f32 v189, v189, v191
    s_nop 0
    v_add_f32_dpp v188, v188, v188 row_ror:8 row_mask:0xf bank_mask:0xf
    v_add_f32_dpp v189, v189, v189 row_ror:8 row_mask:0xf bank_mask:0xf
    s_nop 0
    v_add_f32_dpp v188, v188, v188 row_ror:4 row_mask:0xf bank_mask:0xf
    v_add_f32_dpp v189, v189, v189 row_ror:4 row_mask:0xf bank_mask:0xf
    s_nop 0
    v_add_f32_dpp v188, v188, v188 row_ror:2 row_mask:0xf bank_mask:0xf
    v_add_f32_dpp v189, v189, v189 row_ror:2 row_mask:0xf bank_mask:0xf
    s_nop 0
    v_add_f32_dpp v188, v188, v188 row_ror:1 row_mask:0xf bank_mask:0xf
    v_add_f32_dpp v189, v189, v189 row_ror:1 row_mask:0xf bank_mask:0xf
    s_lshr_b32 s97, s59, 1
    s_lshl_b32 s99, s28, 1
    s_add_u32 s97, s97, s99
    s_mul_i32 s97, s97, 40960
    s_and_b32 s99, s59, 1
    s_lshl_b32 s99, s99, 12
    s_add_u32 s97, s97, s99
    s_lshl_b32 s99, s29, 13
    s_add_u32 s97, s97, s99
    s_add_u32 s97, s97, 3670016
    s_mov_b32 s33, 0x3acccccd
    s_mov_b32 s34, 0x3727c5ac
    v_mul_f32 v188, s33, v188
    v_mul_f32 v189, s33, v189
    v_fma_f32 v189, -v188, v188, v189
    v_max_f32 v189, 0, v189
    v_add_f32 v189, s34, v189
    v_rsq_f32 v189, v189
    s_waitcnt lgkmcnt(0)
    buffer_store_dwordx4 v[128:131], v3, s[4:7], s97 offen offset:0 sc1
    buffer_store_dwordx4 v[132:135], v3, s[4:7], s97 offen offset:1024 sc1
    buffer_store_dwordx4 v[136:139], v3, s[4:7], s97 offen offset:2048 sc1
    buffer_store_dwordx4 v[140:143], v3, s[4:7], s97 offen offset:3072 sc1
    v_mul_f32 v188, v188, v189
    v_sub_f32 v188, 0, v188
    s_lshl_b32 s97, s98, 5
    s_add_u32 s97, s97, 6291456
    s_cmp_lt_u32 s2, 128
    s_cselect_b32 s99, 0, 2147483648
    v_lshlrev_b32 v26, 3, v16
    v_or_b32 v26, s99, v26
    s_mov_b32 exec_lo, 0x00010001
    s_mov_b32 exec_hi, 0x00010001
    buffer_store_dwordx2 v[188:189], v26, s[4:7], s97 offen sc1
    s_mov_b64 exec, -1
    s_waitcnt vmcnt(5)
    v_min_u32 v7, 23, v2
    v_lshlrev_b32 v7, 4, v7
    v_min_u32 v6, 39, v2
    v_lshlrev_b32 v6, 4, v6
    s_and_b32 s45, s2, 15
    s_lshl_b32 s52, s45, 9
    s_add_u32 s52, s52, 69632
    s_lshl_b32 s45, s45, 10
    s_add_u32 s45, s45, 110592
    ds_read_b128 v[96:99], v19 offset:0
    ds_read_b64 v[64:65], v18 offset:0
    ds_read_b64 v[66:67], v18 offset:8
    ds_read_b128 v[100:103], v19 offset:512
    ds_read_b64 v[68:69], v18 offset:512
    ds_read_b64 v[70:71], v18 offset:520
    ds_read_b128 v[104:107], v19 offset:1024
    ds_read_b64 v[72:73], v18 offset:1024
    ds_read_b64 v[74:75], v18 offset:1032
    ds_read_b128 v[108:111], v19 offset:1536
    ds_read_b64 v[76:77], v18 offset:1536
    ds_read_b64 v[78:79], v18 offset:1544
    ds_read_b128 v[112:115], v19 offset:2048
    ds_read_b64 v[80:81], v18 offset:2048
    ds_read_b64 v[82:83], v18 offset:2056
    ds_read_b128 v[116:119], v19 offset:2560
    ds_read_b64 v[84:85], v18 offset:2560
    ds_read_b64 v[86:87], v18 offset:2568
    ds_read_b128 v[120:123], v19 offset:3072
    ds_read_b64 v[88:89], v18 offset:3072
    ds_read_b64 v[90:91], v18 offset:3080
    ds_read_b128 v[124:127], v19 offset:3584
    ds_read_b64 v[92:93], v18 offset:3584
    ds_read_b64 v[94:95], v18 offset:3592
    v_add_u32 v18, 64, v18
    v_subrev_u32 v19, 64, v19
    s_waitcnt lgkmcnt(0)
    v_mfma_f32_16x16x32_bf16 v[32:35], v[28:31], v[96:99], 0
    v_mfma_f32_16x16x32_bf16 v[36:39], v[28:31], v[100:103], 0
    v_mfma_f32_16x16x32_bf16 v[40:43], v[28:31], v[104:107], 0
    v_mfma_f32_16x16x32_bf16 v[44:47], v[28:31], v[108:111], 0
    v_mfma_f32_16x16x32_bf16 v[48:51], v[28:31], v[112:115], 0
    v_mfma_f32_16x16x32_bf16 v[52:55], v[28:31], v[116:119], 0
    v_mfma_f32_16x16x32_bf16 v[56:59], v[28:31], v[120:123], 0
    v_mfma_f32_16x16x32_bf16 v[60:63], v[28:31], v[124:127], 0
    v_mfma_f32_16x16x32_bf16 v[32:35], v[64:67], v[96:99], v[32:35]
    ds_read_b128 v[160:163], v19 offset:0
    v_mfma_f32_16x16x32_bf16 v[36:39], v[64:67], v[100:103], v[36:39]
    ds_read_b64 v[128:129], v18 offset:0
    v_mfma_f32_16x16x32_bf16 v[40:43], v[64:67], v[104:107], v[40:43]
    ds_read_b64 v[130:131], v18 offset:8
    v_mfma_f32_16x16x32_bf16 v[44:47], v[64:67], v[108:111], v[44:47]
    ds_read_b128 v[164:167], v19 offset:512
    v_mfma_f32_16x16x32_bf16 v[48:51], v[64:67], v[112:115], v[48:51]
    ds_read_b64 v[132:133], v18 offset:512
    v_mfma_f32_16x16x32_bf16 v[52:55], v[64:67], v[116:119], v[52:55]
    ds_read_b64 v[134:135], v18 offset:520
    v_mfma_f32_16x16x32_bf16 v[56:59], v[64:67], v[120:123], v[56:59]
    ds_read_b128 v[168:171], v19 offset:1024
    v_mfma_f32_16x16x32_bf16 v[60:63], v[64:67], v[124:127], v[60:63]
    ds_read_b64 v[136:137], v18 offset:1024
    v_mfma_f32_16x16x32_bf16 v[36:39], v[68:71], v[96:99], v[36:39]
    ds_read_b64 v[138:139], v18 offset:1032
    v_mfma_f32_16x16x32_bf16 v[40:43], v[68:71], v[100:103], v[40:43]
    ds_read_b128 v[172:175], v19 offset:1536
    v_mfma_f32_16x16x32_bf16 v[44:47], v[68:71], v[104:107], v[44:47]
    ds_read_b64 v[140:141], v18 offset:1536
    v_mfma_f32_16x16x32_bf16 v[48:51], v[68:71], v[108:111], v[48:51]
    ds_read_b64 v[142:143], v18 offset:1544
    v_mfma_f32_16x16x32_bf16 v[52:55], v[68:71], v[112:115], v[52:55]
    ds_read_b128 v[176:179], v19 offset:2048
    v_mfma_f32_16x16x32_bf16 v[56:59], v[68:71], v[116:119], v[56:59]
    ds_read_b64 v[144:145], v18 offset:2048
    v_mfma_f32_16x16x32_bf16 v[60:63], v[68:71], v[120:123], v[60:63]
    ds_read_b64 v[146:147], v18 offset:2056
    v_mfma_f32_16x16x32_bf16 v[40:43], v[72:75], v[96:99], v[40:43]
    ds_read_b128 v[180:183], v19 offset:2560
    v_mfma_f32_16x16x32_bf16 v[44:47], v[72:75], v[100:103], v[44:47]
    ds_read_b64 v[148:149], v18 offset:2560
    v_mfma_f32_16x16x32_bf16 v[48:51], v[72:75], v[104:107], v[48:51]
    ds_read_b64 v[150:151], v18 offset:2568
    v_mfma_f32_16x16x32_bf16 v[52:55], v[72:75], v[108:111], v[52:55]
    ds_read_b128 v[184:187], v19 offset:3072
    v_mfma_f32_16x16x32_bf16 v[56:59], v[72:75], v[112:115], v[56:59]
    ds_read_b64 v[152:153], v18 offset:3072
    v_mfma_f32_16x16x32_bf16 v[60:63], v[72:75], v[116:119], v[60:63]
    ds_read_b64 v[154:155], v18 offset:3080
    v_mfma_f32_16x16x32_bf16 v[44:47], v[76:79], v[96:99], v[44:47]
    ds_read_b128 v[188:191], v19 offset:3584
    v_mfma_f32_16x16x32_bf16 v[48:51], v[76:79], v[100:103], v[48:51]
    ds_read_b64 v[156:157], v18 offset:3584
    v_mfma_f32_16x16x32_bf16 v[52:55], v[76:79], v[104:107], v[52:55]
    ds_read_b64 v[158:159], v18 offset:3592
    v_mfma_f32_16x16x32_bf16 v[56:59], v[76:79], v[108:111], v[56:59]
    v_mfma_f32_16x16x32_bf16 v[60:63], v[76:79], v[112:115], v[60:63]
    v_mfma_f32_16x16x32_bf16 v[48:51], v[80:83], v[96:99], v[48:51]
    v_mfma_f32_16x16x32_bf16 v[52:55], v[80:83], v[100:103], v[52:55]
    v_mfma_f32_16x16x32_bf16 v[56:59], v[80:83], v[104:107], v[56:59]
    v_mfma_f32_16x16x32_bf16 v[60:63], v[80:83], v[108:111], v[60:63]
    v_mfma_f32_16x16x32_bf16 v[52:55], v[84:87], v[96:99], v[52:55]
    v_mfma_f32_16x16x32_bf16 v[56:59], v[84:87], v[100:103], v[56:59]
    v_mfma_f32_16x16x32_bf16 v[60:63], v[84:87], v[104:107], v[60:63]
    v_mfma_f32_16x16x32_bf16 v[56:59], v[88:91], v[96:99], v[56:59]
    v_mfma_f32_16x16x32_bf16 v[60:63], v[88:91], v[100:103], v[60:63]
    v_mfma_f32_16x16x32_bf16 v[60:63], v[92:95], v[96:99], v[60:63]
    v_add_u32 v18, 64, v18
    v_subrev_u32 v19, 64, v19
    s_waitcnt lgkmcnt(0)
    v_mfma_f32_16x16x32_bf16 v[32:35], v[128:131], v[160:163], v[32:35]
    ds_read_b128 v[96:99], v19 offset:0
    s_waitcnt vmcnt(0)
    s_barrier
    s_lshl_b32 s53, s2, 2
    s_add_u32 s53, s53, 110592
    s_cmp_lg_u32 s59, 0
    s_cbranch_scc1 L_fs_7
    v_mbcnt_lo_u32_b32 v26, -1, 0
    v_mul_u32_u24 v26, 1024, v26
    v_mov_b32 v27, s3
    s_mov_b64 exec, 65535
    buffer_store_dword v27, v26, s[4:7], s53 offen sc1
    s_mov_b64 exec, -1
L_fs_7:
    v_mfma_f32_16x16x32_bf16 v[36:39], v[128:131], v[164:167], v[36:39]
    ds_read_b64 v[64:65], v18 offset:0
    v_mfma_f32_16x16x32_bf16 v[40:43], v[128:131], v[168:171], v[40:43]
    ds_read_b64 v[66:67], v18 offset:8
    v_mfma_f32_16x16x32_bf16 v[44:47], v[128:131], v[172:175], v[44:47]
    ds_read_b128 v[100:103], v19 offset:512
    v_mfma_f32_16x16x32_bf16 v[48:51], v[128:131], v[176:179], v[48:51]
    ds_read_b64 v[68:69], v18 offset:512
    v_mfma_f32_16x16x32_bf16 v[52:55], v[128:131], v[180:183], v[52:55]
    ds_read_b64 v[70:71], v18 offset:520
    v_mfma_f32_16x16x32_bf16 v[56:59], v[128:131], v[184:187], v[56:59]
    ds_read_b128 v[104:107], v19 offset:1024
    v_mfma_f32_16x16x32_bf16 v[60:63], v[128:131], v[188:191], v[60:63]
    ds_read_b64 v[72:73], v18 offset:1024
    v_mfma_f32_16x16x32_bf16 v[36:39], v[132:135], v[160:163], v[36:39]
    ds_read_b64 v[74:75], v18 offset:1032
    v_mfma_f32_16x16x32_bf16 v[40:43], v[132:135], v[164:167], v[40:43]
    ds_read_b128 v[108:111], v19 offset:1536
    v_mfma_f32_16x16x32_bf16 v[44:47], v[132:135], v[168:171], v[44:47]
    ds_read_b64 v[76:77], v18 offset:1536
    v_mfma_f32_16x16x32_bf16 v[48:51], v[132:135], v[172:175], v[48:51]
    ds_read_b64 v[78:79], v18 offset:1544
    v_mfma_f32_16x16x32_bf16 v[52:55], v[132:135], v[176:179], v[52:55]
    ds_read_b128 v[112:115], v19 offset:2048
    v_mfma_f32_16x16x32_bf16 v[56:59], v[132:135], v[180:183], v[56:59]
    ds_read_b64 v[80:81], v18 offset:2048
    v_mfma_f32_16x16x32_bf16 v[60:63], v[132:135], v[184:187], v[60:63]
    ds_read_b64 v[82:83], v18 offset:2056
    v_mfma_f32_16x16x32_bf16 v[40:43], v[136:139], v[160:163], v[40:43]
    ds_read_b128 v[116:119], v19 offset:2560
    v_mfma_f32_16x16x32_bf16 v[44:47], v[136:139], v[164:167], v[44:47]
    ds_read_b64 v[84:85], v18 offset:2560
    v_mfma_f32_16x16x32_bf16 v[48:51], v[136:139], v[168:171], v[48:51]
    ds_read_b64 v[86:87], v18 offset:2568
    v_mfma_f32_16x16x32_bf16 v[52:55], v[136:139], v[172:175], v[52:55]
    ds_read_b128 v[120:123], v19 offset:3072
    v_mfma_f32_16x16x32_bf16 v[56:59], v[136:139], v[176:179], v[56:59]
    ds_read_b64 v[88:89], v18 offset:3072
    v_mfma_f32_16x16x32_bf16 v[60:63], v[136:139], v[180:183], v[60:63]
    ds_read_b64 v[90:91], v18 offset:3080
    v_mfma_f32_16x16x32_bf16 v[44:47], v[140:143], v[160:163], v[44:47]
    ds_read_b128 v[124:127], v19 offset:3584
    v_mfma_f32_16x16x32_bf16 v[48:51], v[140:143], v[164:167], v[48:51]
    ds_read_b64 v[92:93], v18 offset:3584
    v_mfma_f32_16x16x32_bf16 v[52:55], v[140:143], v[168:171], v[52:55]
    ds_read_b64 v[94:95], v18 offset:3592
    v_mfma_f32_16x16x32_bf16 v[56:59], v[140:143], v[172:175], v[56:59]
    v_mfma_f32_16x16x32_bf16 v[60:63], v[140:143], v[176:179], v[60:63]
    v_mfma_f32_16x16x32_bf16 v[48:51], v[144:147], v[160:163], v[48:51]
    v_mfma_f32_16x16x32_bf16 v[52:55], v[144:147], v[164:167], v[52:55]
    v_mfma_f32_16x16x32_bf16 v[56:59], v[144:147], v[168:171], v[56:59]
    v_mfma_f32_16x16x32_bf16 v[60:63], v[144:147], v[172:175], v[60:63]
    v_mfma_f32_16x16x32_bf16 v[52:55], v[148:151], v[160:163], v[52:55]
    v_mfma_f32_16x16x32_bf16 v[56:59], v[148:151], v[164:167], v[56:59]
    v_mfma_f32_16x16x32_bf16 v[60:63], v[148:151], v[168:171], v[60:63]
    v_mfma_f32_16x16x32_bf16 v[56:59], v[152:155], v[160:163], v[56:59]
    v_mfma_f32_16x16x32_bf16 v[60:63], v[152:155], v[164:167], v[60:63]
    v_mfma_f32_16x16x32_bf16 v[60:63], v[156:159], v[160:163], v[60:63]
    v_add_u32 v18, 64, v18
    v_subrev_u32 v19, 64, v19
    s_waitcnt lgkmcnt(0)
    v_mfma_f32_16x16x32_bf16 v[32:35], v[64:67], v[96:99], v[32:35]
    ds_read_b128 v[160:163], v19 offset:0
    v_mul_u32_u24 v24, 40960, v16
    v_lshl_add_u32 v24, v15, 4, v24
    s_mul_i32 s48, s59, 655360
    s_lshl_b32 s49, s96, 8
    s_add_u32 s48, s48, s49
    s_add_u32 s46, s48, 3670016
    s_add_u32 s49, s48, 11534336
    s_add_u32 s48, s48, 8912896
    s_lshl_b32 s47, s59, 12
    s_add_u32 s47, s47, 6291456
    v_mfma_f32_16x16x32_bf16 v[36:39], v[64:67], v[100:103], v[36:39]
    ds_read_b64 v[128:129], v18 offset:0
    v_mfma_f32_16x16x32_bf16 v[40:43], v[64:67], v[104:107], v[40:43]
    ds_read_b64 v[130:131], v18 offset:8
    v_mfma_f32_16x16x32_bf16 v[44:47], v[64:67], v[108:111], v[44:47]
    ds_read_b128 v[164:167], v19 offset:512
    v_mfma_f32_16x16x32_bf16 v[48:51], v[64:67], v[112:115], v[48:51]
    ds_read_b64 v[132:133], v18 offset:512
    v_mfma_f32_16x16x32_bf16 v[52:55], v[64:67], v[116:119], v[52:55]
    ds_read_b64 v[134:135], v18 offset:520
    v_mfma_f32_16x16x32_bf16 v[56:59], v[64:67], v[120:123], v[56:59]
    ds_read_b128 v[168:171], v19 offset:1024
    v_mfma_f32_16x16x32_bf16 v[60:63], v[64:67], v[124:127], v[60:63]
    ds_read_b64 v[136:137], v18 offset:1024
    v_mfma_f32_16x16x32_bf16 v[36:39], v[68:71], v[96:99], v[36:39]
    ds_read_b64 v[138:139], v18 offset:1032
    v_mfma_f32_16x16x32_bf16 v[40:43], v[68:71], v[100:103], v[40:43]
    ds_read_b128 v[172:175], v19 offset:1536
    v_mfma_f32_16x16x32_bf16 v[44:47], v[68:71], v[104:107], v[44:47]
    ds_read_b64 v[140:141], v18 offset:1536
    v_mfma_f32_16x16x32_bf16 v[48:51], v[68:71], v[108:111], v[48:51]
    ds_read_b64 v[142:143], v18 offset:1544
    v_mfma_f32_16x16x32_bf16 v[52:55], v[68:71], v[112:115], v[52:55]
    ds_read_b128 v[176:179], v19 offset:2048
    v_mfma_f32_16x16x32_bf16 v[56:59], v[68:71], v[116:119], v[56:59]
    ds_read_b64 v[144:145], v18 offset:2048
    v_mfma_f32_16x16x32_bf16 v[60:63], v[68:71], v[120:123], v[60:63]
    ds_read_b64 v[146:147], v18 offset:2056
    v_mfma_f32_16x16x32_bf16 v[40:43], v[72:75], v[96:99], v[40:43]
    ds_read_b128 v[180:183], v19 offset:2560
    v_mfma_f32_16x16x32_bf16 v[44:47], v[72:75], v[100:103], v[44:47]
    ds_read_b64 v[148:149], v18 offset:2560
    v_mfma_f32_16x16x32_bf16 v[48:51], v[72:75], v[104:107], v[48:51]
    ds_read_b64 v[150:151], v18 offset:2568
    v_mfma_f32_16x16x32_bf16 v[52:55], v[72:75], v[108:111], v[52:55]
    ds_read_b128 v[184:187], v19 offset:3072
    v_mfma_f32_16x16x32_bf16 v[56:59], v[72:75], v[112:115], v[56:59]
    ds_read_b64 v[152:153], v18 offset:3072
    v_mfma_f32_16x16x32_bf16 v[60:63], v[72:75], v[116:119], v[60:63]
    ds_read_b64 v[154:155], v18 offset:3080
    v_mfma_f32_16x16x32_bf16 v[44:47], v[76:79], v[96:99], v[44:47]
    ds_read_b128 v[188:191], v19 offset:3584
    v_mfma_f32_16x16x32_bf16 v[48:51], v[76:79], v[100:103], v[48:51]
    ds_read_b64 v[156:157], v18 offset:3584
    v_mfma_f32_16x16x32_bf16 v[52:55], v[76:79], v[104:107], v[52:55]
    ds_read_b64 v[158:159], v18 offset:3592
    v_mfma_f32_16x16x32_bf16 v[56:59], v[76:79], v[108:111], v[56:59]
    v_mfma_f32_16x16x32_bf16 v[60:63], v[76:79], v[112:115], v[60:63]
    v_mfma_f32_16x16x32_bf16 v[48:51], v[80:83], v[96:99], v[48:51]
    v_mfma_f32_16x16x32_bf16 v[52:55], v[80:83], v[100:103], v[52:55]
    v_mfma_f32_16x16x32_bf16 v[56:59], v[80:83], v[104:107], v[56:59]
    v_mfma_f32_16x16x32_bf16 v[60:63], v[80:83], v[108:111], v[60:63]
    v_mfma_f32_16x16x32_bf16 v[52:55], v[84:87], v[96:99], v[52:55]
    v_mfma_f32_16x16x32_bf16 v[56:59], v[84:87], v[100:103], v[56:59]
    v_mfma_f32_16x16x32_bf16 v[60:63], v[84:87], v[104:107], v[60:63]
    v_mfma_f32_16x16x32_bf16 v[56:59], v[88:91], v[96:99], v[56:59]
    v_mfma_f32_16x16x32_bf16 v[60:63], v[88:91], v[100:103], v[60:63]
    v_mfma_f32_16x16x32_bf16 v[60:63], v[92:95], v[96:99], v[60:63]
    v_add_u32 v18, 64, v18
    v_subrev_u32 v19, 64, v19
    s_waitcnt lgkmcnt(0)
    v_mfma_f32_16x16x32_bf16 v[32:35], v[128:131], v[160:163], v[32:35]
    ds_read_b128 v[96:99], v19 offset:0
    s_cmp_lg_u32 s59, 1
    s_cbranch_scc1 L_p1_8
    buffer_load_dwordx4 v[20:23], v6, s[4:7], s45 offen sc1
L_p1_8:
    s_cmp_lg_u32 s59, 1
    s_cbranch_scc1 L_p1_9
    buffer_load_dwordx4 v[8:11], v7, s[4:7], s52 offen sc1
L_p1_9:
    v_mfma_f32_16x16x32_bf16 v[36:39], v[128:131], v[164:167], v[36:39]
    ds_read_b64 v[64:65], v18 offset:0
    v_mfma_f32_16x16x32_bf16 v[40:43], v[128:131], v[168:171], v[40:43]
    ds_read_b64 v[66:67], v18 offset:8
    v_mfma_f32_16x16x32_bf16 v[44:47], v[128:131], v[172:175], v[44:47]
    ds_read_b128 v[100:103], v19 offset:512
    v_mfma_f32_16x16x32_bf16 v[48:51], v[128:131], v[176:179], v[48:51]
    ds_read_b64 v[68:69], v18 offset:512
    v_mfma_f32_16x16x32_bf16 v[52:55], v[128:131], v[180:183], v[52:55]
    ds_read_b64 v[70:71], v18 offset:520
    v_mfma_f32_16x16x32_bf16 v[56:59], v[128:131], v[184:187], v[56:59]
    ds_read_b128 v[104:107], v19 offset:1024
    v_mfma_f32_16x16x32_bf16 v[60:63], v[128:131], v[188:191], v[60:63]
    ds_read_b64 v[72:73], v18 offset:1024
    v_mfma_f32_16x16x32_bf16 v[36:39], v[132:135], v[160:163], v[36:39]
    ds_read_b64 v[74:75], v18 offset:1032
    v_mfma_f32_16x16x32_bf16 v[40:43], v[132:135], v[164:167], v[40:43]
    ds_read_b128 v[108:111], v19 offset:1536
    v_mfma_f32_16x16x32_bf16 v[44:47], v[132:135], v[168:171], v[44:47]
    ds_read_b64 v[76:77], v18 offset:1536
    v_mfma_f32_16x16x32_bf16 v[48:51], v[132:135], v[172:175], v[48:51]
    ds_read_b64 v[78:79], v18 offset:1544
    v_mfma_f32_16x16x32_bf16 v[52:55], v[132:135], v[176:179], v[52:55]
    ds_read_b128 v[112:115], v19 offset:2048
    v_mfma_f32_16x16x32_bf16 v[56:59], v[132:135], v[180:183], v[56:59]
    ds_read_b64 v[80:81], v18 offset:2048
    v_mfma_f32_16x16x32_bf16 v[60:63], v[132:135], v[184:187], v[60:63]
    ds_read_b64 v[82:83], v18 offset:2056
    v_mfma_f32_16x16x32_bf16 v[40:43], v[136:139], v[160:163], v[40:43]
    ds_read_b128 v[116:119], v19 offset:2560
    v_mfma_f32_16x16x32_bf16 v[44:47], v[136:139], v[164:167], v[44:47]
    ds_read_b64 v[84:85], v18 offset:2560
    v_mfma_f32_16x16x32_bf16 v[48:51], v[136:139], v[168:171], v[48:51]
    ds_read_b64 v[86:87], v18 offset:2568
    v_mfma_f32_16x16x32_bf16 v[52:55], v[136:139], v[172:175], v[52:55]
    ds_read_b128 v[120:123], v19 offset:3072
    v_mfma_f32_16x16x32_bf16 v[56:59], v[136:139], v[176:179], v[56:59]
    ds_read_b64 v[88:89], v18 offset:3072
    v_mfma_f32_16x16x32_bf16 v[60:63], v[136:139], v[180:183], v[60:63]
    ds_read_b64 v[90:91], v18 offset:3080
    v_mfma_f32_16x16x32_bf16 v[44:47], v[140:143], v[160:163], v[44:47]
    ds_read_b128 v[124:127], v19 offset:3584
    v_mfma_f32_16x16x32_bf16 v[48:51], v[140:143], v[164:167], v[48:51]
    ds_read_b64 v[92:93], v18 offset:3584
    v_mfma_f32_16x16x32_bf16 v[52:55], v[140:143], v[168:171], v[52:55]
    ds_read_b64 v[94:95], v18 offset:3592
    v_mfma_f32_16x16x32_bf16 v[56:59], v[140:143], v[172:175], v[56:59]
    v_mfma_f32_16x16x32_bf16 v[60:63], v[140:143], v[176:179], v[60:63]
    v_mfma_f32_16x16x32_bf16 v[48:51], v[144:147], v[160:163], v[48:51]
    v_mfma_f32_16x16x32_bf16 v[52:55], v[144:147], v[164:167], v[52:55]
    v_mfma_f32_16x16x32_bf16 v[56:59], v[144:147], v[168:171], v[56:59]
    v_mfma_f32_16x16x32_bf16 v[60:63], v[144:147], v[172:175], v[60:63]
    v_mfma_f32_16x16x32_bf16 v[52:55], v[148:151], v[160:163], v[52:55]
    v_mfma_f32_16x16x32_bf16 v[56:59], v[148:151], v[164:167], v[56:59]
    v_mfma_f32_16x16x32_bf16 v[60:63], v[148:151], v[168:171], v[60:63]
    v_mfma_f32_16x16x32_bf16 v[56:59], v[152:155], v[160:163], v[56:59]
    v_mfma_f32_16x16x32_bf16 v[60:63], v[152:155], v[164:167], v[60:63]
    v_mfma_f32_16x16x32_bf16 v[60:63], v[156:159], v[160:163], v[60:63]
    v_add_u32 v18, 64, v18
    v_subrev_u32 v19, 64, v19
    s_waitcnt lgkmcnt(0)
    v_mfma_f32_16x16x32_bf16 v[32:35], v[64:67], v[96:99], v[32:35]
    ds_read_b128 v[160:163], v19 offset:0
    s_cmp_lg_u32 s59, 1
    s_cbranch_scc1 L_p1c_10
    s_waitcnt vmcnt(0)
    v_xor_b32 v20, s3, v20
    v_xor_b32 v21, s3, v21
    v_xor_b32 v22, s3, v22
    v_xor_b32 v23, s3, v23
    v_or3_b32 v20, v20, v21, v22
    v_or_b32 v20, v20, v23
    v_cmp_ne_u32 vcc, 0, v20
    s_cbranch_vccnz L_spin_11
L_back_12:
L_p1c_10:
    s_cmp_lg_u32 s59, 1
    s_cbranch_scc1 L_p1c_13
    s_waitcnt vmcnt(0)
    v_xor_b32 v8, s3, v8
    v_xor_b32 v9, s3, v9
    v_xor_b32 v10, s3, v10
    v_xor_b32 v11, s3, v11
    v_or3_b32 v8, v8, v9, v10
    v_or_b32 v8, v8, v11
    v_cmp_ne_u32 vcc, 0, v8
    s_cbranch_vccnz L_spin_14
L_back_15:
L_p1c_13:
    s_barrier
    v_mfma_f32_16x16x32_bf16 v[36:39], v[64:67], v[100:103], v[36:39]
    ds_read_b64 v[128:129], v18 offset:0
    v_mfma_f32_16x16x32_bf16 v[40:43], v[64:67], v[104:107], v[40:43]
    ds_read_b64 v[130:131], v18 offset:8
    buffer_load_dwordx4 v[192:195], v24, s[4:7], s46 offen sc1
    buffer_load_dwordx4 v[224:227], v3, s[4:7], s47 offen offset:0 sc1
    v_mfma_f32_16x16x32_bf16 v[44:47], v[64:67], v[108:111], v[44:47]
    ds_read_b128 v[164:167], v19 offset:512
    v_mfma_f32_16x16x32_bf16 v[48:51], v[64:67], v[112:115], v[48:51]
    ds_read_b64 v[132:133], v18 offset:512
    s_add_u32 s46, s46, 163840
    buffer_load_dwordx4 v[196:199], v24, s[4:7], s46 offen sc1
    buffer_load_dwordx4 v[228:231], v3, s[4:7], s47 offen offset:1024 sc1
    v_mfma_f32_16x16x32_bf16 v[52:55], v[64:67], v[116:119], v[52:55]
    ds_read_b64 v[134:135], v18 offset:520
    v_mfma_f32_16x16x32_bf16 v[56:59], v[64:67], v[120:123], v[56:59]
    ds_read_b128 v[168:171], v19 offset:1024
    s_add_u32 s46, s46, 163840
    buffer_load_dwordx4 v[200:203], v24, s[4:7], s46 offen sc1
    buffer_load_dwordx4 v[232:235], v3, s[4:7], s47 offen offset:2048 sc1
    v_mfma_f32_16x16x32_bf16 v[60:63], v[64:67], v[124:127], v[60:63]
    ds_read_b64 v[136:137], v18 offset:1024
    v_mfma_f32_16x16x32_bf16 v[36:39], v[68:71], v[96:99], v[36:39]
    ds_read_b64 v[138:139], v18 offset:1032
    s_add_u32 s46, s46, 163840
    buffer_load_dwordx4 v[204:207], v24, s[4:7], s46 offen sc1
    buffer_load_dwordx4 v[236:239], v3, s[4:7], s47 offen offset:3072 sc1
    v_mfma_f32_16x16x32_bf16 v[40:43], v[68:71], v[100:103], v[40:43]
    ds_read_b128 v[172:175], v19 offset:1536
    v_mfma_f32_16x16x32_bf16 v[44:47], v[68:71], v[104:107], v[44:47]
    ds_read_b64 v[140:141], v18 offset:1536
    s_add_u32 s81, s59, 0
    v_mfma_f32_16x16x32_bf16 v[48:51], v[68:71], v[108:111], v[48:51]
    ds_read_b64 v[142:143], v18 offset:1544
    v_mfma_f32_16x16x32_bf16 v[52:55], v[68:71], v[112:115], v[52:55]
    ds_read_b128 v[176:179], v19 offset:2048
    s_min_u32 s81, s81, 18
    v_mfma_f32_16x16x32_bf16 v[56:59], v[68:71], v[116:119], v[56:59]
    ds_read_b64 v[144:145], v18 offset:2048
    v_mfma_f32_16x16x32_bf16 v[60:63], v[68:71], v[120:123], v[60:63]
    ds_read_b64 v[146:147], v18 offset:2056
    s_mul_i32 s74, s81, 21846
    v_mfma_f32_16x16x32_bf16 v[40:43], v[72:75], v[96:99], v[40:43]
    ds_read_b128 v[180:183], v19 offset:2560
    v_mfma_f32_16x16x32_bf16 v[44:47], v[72:75], v[100:103], v[44:47]
    ds_read_b64 v[148:149], v18 offset:2560
    s_lshr_b32 s74, s74, 16
    v_mfma_f32_16x16x32_bf16 v[48:51], v[72:75], v[104:107], v[48:51]
    ds_read_b64 v[150:151], v18 offset:2568
    v_mfma_f32_16x16x32_bf16 v[52:55], v[72:75], v[108:111], v[52:55]
    ds_read_b128 v[184:187], v19 offset:3072
    s_mul_i32 s75, s74, 3
    v_mfma_f32_16x16x32_bf16 v[56:59], v[72:75], v[112:115], v[56:59]
    ds_read_b64 v[152:153], v18 offset:3072
    v_mfma_f32_16x16x32_bf16 v[60:63], v[72:75], v[116:119], v[60:63]
    ds_read_b64 v[154:155], v18 offset:3080
    s_sub_u32 s75, s81, s75
    v_mfma_f32_16x16x32_bf16 v[44:47], v[76:79], v[96:99], v[44:47]
    ds_read_b128 v[188:191], v19 offset:3584
    v_mfma_f32_16x16x32_bf16 v[48:51], v[76:79], v[100:103], v[48:51]
    ds_read_b64 v[156:157], v18 offset:3584
    s_mul_i32 s75, s75, 40960
    v_mfma_f32_16x16x32_bf16 v[52:55], v[76:79], v[104:107], v[52:55]
    ds_read_b64 v[158:159], v18 offset:3592
    v_mfma_f32_16x16x32_bf16 v[56:59], v[76:79], v[108:111], v[56:59]
    s_lshl_b32 s74, s74, 12
    v_mfma_f32_16x16x32_bf16 v[60:63], v[76:79], v[112:115], v[60:63]
    s_add_u32 s74, s74, s75
    v_mfma_f32_16x16x32_bf16 v[48:51], v[80:83], v[96:99], v[48:51]
    s_lshl_b32 s76, s81, 12
    v_mfma_f32_16x16x32_bf16 v[52:55], v[80:83], v[100:103], v[52:55]
    s_cmp_lt_u32 s81, 30
    v_mfma_f32_16x16x32_bf16 v[56:59], v[80:83], v[104:107], v[56:59]
    s_cselect_b32 s74, s74, s76
    v_mfma_f32_16x16x32_bf16 v[60:63], v[80:83], v[108:111], v[60:63]
    s_add_u32 s74, s74, s67
    v_mfma_f32_16x16x32_bf16 v[52:55], v[84:87], v[96:99], v[52:55]
    s_mov_b32 m0, s76
    v_mfma_f32_16x16x32_bf16 v[56:59], v[84:87], v[100:103], v[56:59]
    buffer_load_dwordx4 v3, s[4:7], s74 offen offset:0 sc1 lds
    v_mfma_f32_16x16x32_bf16 v[60:63], v[84:87], v[104:107], v[60:63]
    buffer_load_dwordx4 v3, s[4:7], s74 offen offset:1024 sc1 lds
    v_mfma_f32_16x16x32_bf16 v[56:59], v[88:91], v[96:99], v[56:59]
    buffer_load_dwordx4 v3, s[4:7], s74 offen offset:2048 sc1 lds
    v_mfma_f32_16x16x32_bf16 v[60:63], v[88:91], v[100:103], v[60:63]
    buffer_load_dwordx4 v3, s[4:7], s74 offen offset:3072 sc1 lds
    v_mfma_f32_16x16x32_bf16 v[60:63], v[92:95], v[96:99], v[60:63]
    v_add_u32 v18, 64, v18
    v_subrev_u32 v19, 64, v19
    s_waitcnt lgkmcnt(0)
    v_mfma_f32_16x16x32_bf16 v[32:35], v[128:131], v[160:163], v[32:35]
    ds_read_b128 v[96:99], v19 offset:0
    s_add_u32 s81, s59, 4
    v_mfma_f32_16x16x32_bf16 v[36:39], v[128:131], v[164:167], v[36:39]
    ds_read_b64 v[64:65], v18 offset:0
    v_mfma_f32_16x16x32_bf16 v[40:43], v[128:131], v[168:171], v[40:43]
    ds_read_b64 v[66:67], v18 offset:8
    s_min_u32 s81, s81, 18
    v_mfma_f32_16x16x32_bf16 v[44:47], v[128:131], v[172:175], v[44:47]
    ds_read_b128 v[100:103], v19 offset:512
    s_mul_i32 s74, s81, 21846
    v_mfma_f32_16x16x32_bf16 v[48:51], v[128:131], v[176:179], v[48:51]
    ds_read_b64 v[68:69], v18 offset:512
    s_lshr_b32 s74, s74, 16
    v_mfma_f32_16x16x32_bf16 v[52:55], v[128:131], v[180:183], v[52:55]
    ds_read_b64 v[70:71], v18 offset:520
    s_mul_i32 s75, s74, 3
    v_mfma_f32_16x16x32_bf16 v[56:59], v[128:131], v[184:187], v[56:59]
    ds_read_b128 v[104:107], v19 offset:1024
    s_sub_u32 s75, s81, s75
    v_mfma_f32_16x16x32_bf16 v[60:63], v[128:131], v[188:191], v[60:63]
    ds_read_b64 v[72:73], v18 offset:1024
    s_mul_i32 s75, s75, 40960
    v_mfma_f32_16x16x32_bf16 v[36:39], v[132:135], v[160:163], v[36:39]
    ds_read_b64 v[74:75], v18 offset:1032
    s_lshl_b32 s74, s74, 12
    v_mfma_f32_16x16x32_bf16 v[40:43], v[132:135], v[164:167], v[40:43]
    ds_read_b128 v[108:111], v19 offset:1536
    s_add_u32 s74, s74, s75
    v_mfma_f32_16x16x32_bf16 v[44:47], v[132:135], v[168:171], v[44:47]
    ds_read_b64 v[76:77], v18 offset:1536
    s_lshl_b32 s76, s81, 12
    v_mfma_f32_16x16x32_bf16 v[48:51], v[132:135], v[172:175], v[48:51]
    ds_read_b64 v[78:79], v18 offset:1544
    s_cmp_lt_u32 s81, 30
    v_mfma_f32_16x16x32_bf16 v[52:55], v[132:135], v[176:179], v[52:55]
    ds_read_b128 v[112:115], v19 offset:2048
    s_cselect_b32 s74, s74, s76
    v_mfma_f32_16x16x32_bf16 v[56:59], v[132:135], v[180:183], v[56:59]
    ds_read_b64 v[80:81], v18 offset:2048
    s_add_u32 s74, s74, s67
    v_mfma_f32_16x16x32_bf16 v[60:63], v[132:135], v[184:187], v[60:63]
    ds_read_b64 v[82:83], v18 offset:2056
    s_mov_b32 m0, s76
    v_mfma_f32_16x16x32_bf16 v[40:43], v[136:139], v[160:163], v[40:43]
    ds_read_b128 v[116:119], v19 offset:2560
    buffer_load_dwordx4 v3, s[4:7], s74 offen offset:0 sc1 lds
    v_mfma_f32_16x16x32_bf16 v[44:47], v[136:139], v[164:167], v[44:47]
    ds_read_b64 v[84:85], v18 offset:2560
    buffer_load_dwordx4 v3, s[4:7], s74 offen offset:1024 sc1 lds
    v_mfma_f32_16x16x32_bf16 v[48:51], v[136:139], v[168:171], v[48:51]
    ds_read_b64 v[86:87], v18 offset:2568
    buffer_load_dwordx4 v3, s[4:7], s74 offen offset:2048 sc1 lds
    v_mfma_f32_16x16x32_bf16 v[52:55], v[136:139], v[172:175], v[52:55]
    ds_read_b128 v[120:123], v19 offset:3072
    buffer_load_dwordx4 v3, s[4:7], s74 offen offset:3072 sc1 lds
    v_mfma_f32_16x16x32_bf16 v[56:59], v[136:139], v[176:179], v[56:59]
    ds_read_b64 v[88:89], v18 offset:3072
    s_add_u32 s81, s59, 8
    v_mfma_f32_16x16x32_bf16 v[60:63], v[136:139], v[180:183], v[60:63]
    ds_read_b64 v[90:91], v18 offset:3080
    s_min_u32 s81, s81, 18
    v_mfma_f32_16x16x32_bf16 v[44:47], v[140:143], v[160:163], v[44:47]
    ds_read_b128 v[124:127], v19 offset:3584
    s_mul_i32 s74, s81, 21846
    v_mfma_f32_16x16x32_bf16 v[48:51], v[140:143], v[164:167], v[48:51]
    ds_read_b64 v[92:93], v18 offset:3584
    s_lshr_b32 s74, s74, 16
    v_mfma_f32_16x16x32_bf16 v[52:55], v[140:143], v[168:171], v[52:55]
    ds_read_b64 v[94:95], v18 offset:3592
    s_mul_i32 s75, s74, 3
    v_mfma_f32_16x16x32_bf16 v[56:59], v[140:143], v[172:175], v[56:59]
    s_sub_u32 s75, s81, s75
    v_mfma_f32_16x16x32_bf16 v[60:63], v[140:143], v[176:179], v[60:63]
    s_mul_i32 s75, s75, 40960
    v_mfma_f32_16x16x32_bf16 v[48:51], v[144:147], v[160:163], v[48:51]
    s_lshl_b32 s74, s74, 12
    v_mfma_f32_16x16x32_bf16 v[52:55], v[144:147], v[164:167], v[52:55]
    s_add_u32 s74, s74, s75
    v_mfma_f32_16x16x32_bf16 v[56:59], v[144:147], v[168:171], v[56:59]
    s_lshl_b32 s76, s81, 12
    v_mfma_f32_16x16x32_bf16 v[60:63], v[144:147], v[172:175], v[60:63]
    s_cmp_lt_u32 s81, 30
    v_mfma_f32_16x16x32_bf16 v[52:55], v[148:151], v[160:163], v[52:55]
    s_cselect_b32 s74, s74, s76
    v_mfma_f32_16x16x32_bf16 v[56:59], v[148:151], v[164:167], v[56:59]
    s_add_u32 s74, s74, s67
    v_mfma_f32_16x16x32_bf16 v[60:63], v[148:151], v[168:171], v[60:63]
    s_mov_b32 m0, s76
    v_mfma_f32_16x16x32_bf16 v[56:59], v[152:155], v[160:163], v[56:59]
    buffer_load_dwordx4 v3, s[4:7], s74 offen offset:0 sc1 lds
    v_mfma_f32_16x16x32_bf16 v[60:63], v[152:155], v[164:167], v[60:63]
    buffer_load_dwordx4 v3, s[4:7], s74 offen offset:1024 sc1 lds
    v_mfma_f32_16x16x32_bf16 v[60:63], v[156:159], v[160:163], v[60:63]
    buffer_load_dwordx4 v3, s[4:7], s74 offen offset:2048 sc1 lds
    buffer_load_dwordx4 v3, s[4:7], s74 offen offset:3072 sc1 lds
    v_add_u32 v18, 64, v18
    v_subrev_u32 v19, 64, v19
    s_waitcnt lgkmcnt(0)
    v_mfma_f32_16x16x32_bf16 v[32:35], v[64:67], v[96:99], v[32:35]
    ds_read_b128 v[160:163], v19 offset:0
    s_add_u32 s81, s59, 12
    v_mfma_f32_16x16x32_bf16 v[36:39], v[64:67], v[100:103], v[36:39]
    ds_read_b64 v[128:129], v18 offset:0
    s_min_u32 s81, s81, 18
    v_mfma_f32_16x16x32_bf16 v[40:43], v[64:67], v[104:107], v[40:43]
    ds_read_b64 v[130:131], v18 offset:8
    s_mul_i32 s74, s81, 21846
    v_mfma_f32_16x16x32_bf16 v[44:47], v[64:67], v[108:111], v[44:47]
    ds_read_b128 v[164:167], v19 offset:512
    s_lshr_b32 s74, s74, 16
    v_mfma_f32_16x16x32_bf16 v[48:51], v[64:67], v[112:115], v[48:51]
    ds_read_b64 v[132:133], v18 offset:512
    s_mul_i32 s75, s74, 3
    v_mfma_f32_16x16x32_bf16 v[52:55], v[64:67], v[116:119], v[52:55]
    ds_read_b64 v[134:135], v18 offset:520
    s_sub_u32 s75, s81, s75
    v_mfma_f32_16x16x32_bf16 v[56:59], v[64:67], v[120:123], v[56:59]
    ds_read_b128 v[168:171], v19 offset:1024
    s_mul_i32 s75, s75, 40960
    v_mfma_f32_16x16x32_bf16 v[60:63], v[64:67], v[124:127], v[60:63]
    ds_read_b64 v[136:137], v18 offset:1024
    s_lshl_b32 s74, s74, 12
    v_mfma_f32_16x16x32_bf16 v[36:39], v[68:71], v[96:99], v[36:39]
    ds_read_b64 v[138:139], v18 offset:1032
    s_add_u32 s74, s74, s75
    v_mfma_f32_16x16x32_bf16 v[40:43], v[68:71], v[100:103], v[40:43]
    ds_read_b128 v[172:175], v19 offset:1536
    s_lshl_b32 s76, s81, 12
    v_mfma_f32_16x16x32_bf16 v[44:47], v[68:71], v[104:107], v[44:47]
    ds_read_b64 v[140:141], v18 offset:1536
    s_cmp_lt_u32 s81, 30
    v_mfma_f32_16x16x32_bf16 v[48:51], v[68:71], v[108:111], v[48:51]
    ds_read_b64 v[142:143], v18 offset:1544
    s_cselect_b32 s74, s74, s76
    v_mfma_f32_16x16x32_bf16 v[52:55], v[68:71], v[112:115], v[52:55]
    ds_read_b128 v[176:179], v19 offset:2048
    s_add_u32 s74, s74, s67
    v_mfma_f32_16x16x32_bf16 v[56:59], v[68:71], v[116:119], v[56:59]
    ds_read_b64 v[144:145], v18 offset:2048
    s_mov_b32 m0, s76
    v_mfma_f32_16x16x32_bf16 v[60:63], v[68:71], v[120:123], v[60:63]
    ds_read_b64 v[146:147], v18 offset:2056
    buffer_load_dwordx4 v3, s[4:7], s74 offen offset:0 sc1 lds
    v_mfma_f32_16x16x32_bf16 v[40:43], v[72:75], v[96:99], v[40:43]
    ds_read_b128 v[180:183], v19 offset:2560
    buffer_load_dwordx4 v3, s[4:7], s74 offen offset:1024 sc1 lds
    v_mfma_f32_16x16x32_bf16 v[44:47], v[72:75], v[100:103], v[44:47]
    ds_read_b64 v[148:149], v18 offset:2560
    buffer_load_dwordx4 v3, s[4:7], s74 offen offset:2048 sc1 lds
    v_mfma_f32_16x16x32_bf16 v[48:51], v[72:75], v[104:107], v[48:51]
    ds_read_b64 v[150:151], v18 offset:2568
    buffer_load_dwordx4 v3, s[4:7], s74 offen offset:3072 sc1 lds
    v_mfma_f32_16x16x32_bf16 v[52:55], v[72:75], v[108:111], v[52:55]
    ds_read_b128 v[184:187], v19 offset:3072
    s_add_u32 s81, s59, 16
    v_mfma_f32_16x16x32_bf16 v[56:59], v[72:75], v[112:115], v[56:59]
    ds_read_b64 v[152:153], v18 offset:3072
    s_min_u32 s81, s81, 18
    v_mfma_f32_16x16x32_bf16 v[60:63], v[72:75], v[116:119], v[60:63]
    ds_read_b64 v[154:155], v18 offset:3080
    s_mul_i32 s74, s81, 21846
    v_mfma_f32_16x16x32_bf16 v[44:47], v[76:79], v[96:99], v[44:47]
    ds_read_b128 v[188:191], v19 offset:3584
    s_lshr_b32 s74, s74, 16
    v_mfma_f32_16x16x32_bf16 v[48:51], v[76:79], v[100:103], v[48:51]
    ds_read_b64 v[156:157], v18 offset:3584
    s_mul_i32 s75, s74, 3
    v_mfma_f32_16x16x32_bf16 v[52:55], v[76:79], v[104:107], v[52:55]
    ds_read_b64 v[158:159], v18 offset:3592
    s_sub_u32 s75, s81, s75
    v_mfma_f32_16x16x32_bf16 v[56:59], v[76:79], v[108:111], v[56:59]
    s_mul_i32 s75, s75, 40960
    v_mfma_f32_16x16x32_bf16 v[60:63], v[76:79], v[112:115], v[60:63]
    s_lshl_b32 s74, s74, 12
    v_mfma_f32_16x16x32_bf16 v[48:51], v[80:83], v[96:99], v[48:51]
    s_add_u32 s74, s74, s75
    v_mfma_f32_16x16x32_bf16 v[52:55], v[80:83], v[100:103], v[52:55]
    s_lshl_b32 s76, s81, 12
    v_mfma_f32_16x16x32_bf16 v[56:59], v[80:83], v[104:107], v[56:59]
    s_cmp_lt_u32 s81, 30
    v_mfma_f32_16x16x32_bf16 v[60:63], v[80:83], v[108:111], v[60:63]
    s_cselect_b32 s74, s74, s76
    v_mfma_f32_16x16x32_bf16 v[52:55], v[84:87], v[96:99], v[52:55]
    s_add_u32 s74, s74, s67
    v_mfma_f32_16x16x32_bf16 v[56:59], v[84:87], v[100:103], v[56:59]
    s_mov_b32 m0, s76
    v_mfma_f32_16x16x32_bf16 v[60:63], v[84:87], v[104:107], v[60:63]
    buffer_load_dwordx4 v3, s[4:7], s74 offen offset:0 sc1 lds
    v_mfma_f32_16x16x32_bf16 v[56:59], v[88:91], v[96:99], v[56:59]
    buffer_load_dwordx4 v3, s[4:7], s74 offen offset:1024 sc1 lds
    v_mfma_f32_16x16x32_bf16 v[60:63], v[88:91], v[100:103], v[60:63]
    buffer_load_dwordx4 v3, s[4:7], s74 offen offset:2048 sc1 lds
    v_mfma_f32_16x16x32_bf16 v[60:63], v[92:95], v[96:99], v[60:63]
    buffer_load_dwordx4 v3, s[4:7], s74 offen offset:3072 sc1 lds
    v_lshrrev_b32 v240, 4, v3
    v_bfe_u32 v241, v240, 3, 1
    s_lshl_b32 s74, s59, 1
    v_add_u32 v241, s74, v241
    v_min_u32 v241, 6, v241
    v_and_b32 v242, 7, v240
    v_lshlrev_b32 v242, 4, v242
    v_lshl_add_u32 v243, v241, 7, v242
    v_lshrrev_b32 v240, 4, v240
    v_mul_u32_u24 v240, 69120, v240
    v_add_u32 v240, v240, v243
    s_lshl_b32 s74, s66, 7
    s_add_u32 s74, s74, 23461888
    buffer_load_dwordx4 a[232:235], v240, s[4:7], s74 offen sc1
    s_add_u32 s74, s74, 13824
    buffer_load_dwordx4 a[236:239], v240, s[4:7], s74 offen sc1
    s_add_u32 s74, s74, 13824
    buffer_load_dwordx4 a[240:243], v240, s[4:7], s74 offen sc1
    s_add_u32 s74, s74, 13824
    buffer_load_dwordx4 a[244:247], v240, s[4:7], s74 offen sc1
    s_add_u32 s74, s74, 13824
    buffer_load_dwordx4 a[248:251], v240, s[4:7], s74 offen sc1
    v_bfe_u32 v243, v242, 6, 1
    v_lshlrev_b32 v243, 4, v243
    v_lshl_add_u32 v243, v241, 7, v243
    v_bfe_u32 v242, v242, 4, 2
    v_lshl_add_u32 v243, v242, 2, v243
    v_add_u32 v243, 159744, v243
    v_add_u32 v18, 64, v18
    v_subrev_u32 v19, 64, v19
    s_waitcnt lgkmcnt(0)
    v_lshlrev_b32 v21, 6, v15
    v_lshl_add_u32 v21, v16, 4, v21
    v_add_u32 v21, s35, v21
    v_mfma_f32_16x16x32_bf16 v[32:35], v[128:131], v[160:163], v[32:35]
    s_waitcnt vmcnt(31)
    v_mfma_f32_16x16x32_bf16 v[36:39], v[128:131], v[164:167], v[36:39]
    v_lshlrev_b32 v208, 16, v192
    v_mfma_f32_16x16x32_bf16 v[40:43], v[128:131], v[168:171], v[40:43]
    v_and_b32 v192, s40, v192
    v_mfma_f32_16x16x32_bf16 v[44:47], v[128:131], v[172:175], v[44:47]
    v_lshlrev_b32 v209, 16, v193
    v_mfma_f32_16x16x32_bf16 v[48:51], v[128:131], v[176:179], v[48:51]
    ds_write_b128 v21, v[32:35] offset:0
    v_and_b32 v193, s40, v193
    v_mfma_f32_16x16x32_bf16 v[52:55], v[128:131], v[180:183], v[52:55]
    v_lshlrev_b32 v210, 16, v194
    v_mfma_f32_16x16x32_bf16 v[56:59], v[128:131], v[184:187], v[56:59]
    v_and_b32 v194, s40, v194
    v_mfma_f32_16x16x32_bf16 v[60:63], v[128:131], v[188:191], v[60:63]
    v_lshlrev_b32 v211, 16, v195
    v_mfma_f32_16x16x32_bf16 v[36:39], v[132:135], v[160:163], v[36:39]
    v_and_b32 v195, s40, v195
    v_mfma_f32_16x16x32_bf16 v[40:43], v[132:135], v[164:167], v[40:43]
    v_fma_f32 v96, v208, v225, v224
    v_mfma_f32_16x16x32_bf16 v[44:47], v[132:135], v[168:171], v[44:47]
    v_fma_f32 v97, v192, v225, v224
    v_mfma_f32_16x16x32_bf16 v[48:51], v[132:135], v[172:175], v[48:51]
    v_fma_f32 v98, v209, v225, v224
    v_mfma_f32_16x16x32_bf16 v[52:55], v[132:135], v[176:179], v[52:55]
    ds_write_b128 v21, v[36:39] offset:1024
    v_fma_f32 v99, v193, v225, v224
    v_mfma_f32_16x16x32_bf16 v[56:59], v[132:135], v[180:183], v[56:59]
    v_fma_f32 v100, v210, v227, v226
    v_mfma_f32_16x16x32_bf16 v[60:63], v[132:135], v[184:187], v[60:63]
    v_fma_f32 v101, v194, v227, v226
    v_mfma_f32_16x16x32_bf16 v[40:43], v[136:139], v[160:163], v[40:43]
    v_fma_f32 v102, v211, v227, v226
    v_mfma_f32_16x16x32_bf16 v[44:47], v[136:139], v[164:167], v[44:47]
    v_fma_f32 v103, v195, v227, v226
    v_mfma_f32_16x16x32_bf16 v[48:51], v[136:139], v[168:171], v[48:51]
    s_waitcnt vmcnt(29)
    v_mfma_f32_16x16x32_bf16 v[52:55], v[136:139], v[172:175], v[52:55]
    v_lshlrev_b32 v212, 16, v196
    v_mfma_f32_16x16x32_bf16 v[56:59], v[136:139], v[176:179], v[56:59]
    ds_write_b128 v21, v[40:43] offset:2048
    v_and_b32 v196, s40, v196
    v_mfma_f32_16x16x32_bf16 v[60:63], v[136:139], v[180:183], v[60:63]
    v_lshlrev_b32 v213, 16, v197
    v_mfma_f32_16x16x32_bf16 v[44:47], v[140:143], v[160:163], v[44:47]
    v_and_b32 v197, s40, v197
    v_mfma_f32_16x16x32_bf16 v[48:51], v[140:143], v[164:167], v[48:51]
    v_lshlrev_b32 v214, 16, v198
    v_mfma_f32_16x16x32_bf16 v[52:55], v[140:143], v[168:171], v[52:55]
    v_and_b32 v198, s40, v198
    v_mfma_f32_16x16x32_bf16 v[56:59], v[140:143], v[172:175], v[56:59]
    v_lshlrev_b32 v215, 16, v199
    v_mfma_f32_16x16x32_bf16 v[60:63], v[140:143], v[176:179], v[60:63]
    ds_write_b128 v21, v[44:47] offset:3072
    v_and_b32 v199, s40, v199
    v_mfma_f32_16x16x32_bf16 v[48:51], v[144:147], v[160:163], v[48:51]
    v_fma_f32 v104, v212, v229, v228
    v_mfma_f32_16x16x32_bf16 v[52:55], v[144:147], v[164:167], v[52:55]
    v_fma_f32 v105, v196, v229, v228
    v_mfma_f32_16x16x32_bf16 v[56:59], v[144:147], v[168:171], v[56:59]
    v_fma_f32 v106, v213, v229, v228
    v_mfma_f32_16x16x32_bf16 v[60:63], v[144:147], v[172:175], v[60:63]
    v_fma_f32 v107, v197, v229, v228
    v_mfma_f32_16x16x32_bf16 v[52:55], v[148:151], v[160:163], v[52:55]
    ds_write_b128 v21, v[48:51] offset:4096
    v_fma_f32 v108, v214, v231, v230
    v_mfma_f32_16x16x32_bf16 v[56:59], v[148:151], v[164:167], v[56:59]
    v_fma_f32 v109, v198, v231, v230
    v_mfma_f32_16x16x32_bf16 v[60:63], v[148:151], v[168:171], v[60:63]
    v_fma_f32 v110, v215, v231, v230
    v_mfma_f32_16x16x32_bf16 v[56:59], v[152:155], v[160:163], v[56:59]
    v_fma_f32 v111, v199, v231, v230
    v_mfma_f32_16x16x32_bf16 v[60:63], v[152:155], v[164:167], v[60:63]
    ds_write_b128 v21, v[52:55] offset:5120
    s_waitcnt vmcnt(27)
    v_mfma_f32_16x16x32_bf16 v[60:63], v[156:159], v[160:163], v[60:63]
    v_lshlrev_b32 v216, 16, v200
    v_and_b32 v200, s40, v200
    v_lshlrev_b32 v217, 16, v201
    v_and_b32 v201, s40, v201
    v_lshlrev_b32 v218, 16, v202
    v_and_b32 v202, s40, v202
    v_lshlrev_b32 v219, 16, v203
    v_and_b32 v203, s40, v203
    v_fma_f32 v112, v216, v233, v232
    v_fma_f32 v113, v200, v233, v232
    v_fma_f32 v114, v217, v233, v232
    v_fma_f32 v115, v201, v233, v232
    v_fma_f32 v116, v218, v235, v234
    v_fma_f32 v117, v202, v235, v234
    v_fma_f32 v118, v219, v235, v234
    v_fma_f32 v119, v203, v235, v234
    s_waitcnt vmcnt(25)
    v_lshlrev_b32 v220, 16, v204
    v_and_b32 v204, s40, v204
    v_lshlrev_b32 v221, 16, v205
    v_and_b32 v205, s40, v205
    v_lshlrev_b32 v222, 16, v206
    v_and_b32 v206, s40, v206
    v_lshlrev_b32 v223, 16, v207
    v_and_b32 v207, s40, v207
    v_fma_f32 v120, v220, v237, v236
    v_fma_f32 v121, v204, v237, v236
    v_fma_f32 v122, v221, v237, v236
    v_fma_f32 v123, v205, v237, v236
    v_fma_f32 v124, v222, v239, v238
    v_fma_f32 v125, v206, v239, v238
    v_fma_f32 v126, v223, v239, v238
    v_fma_f32 v127, v207, v239, v238
    ds_write_b128 v21, v[56:59] offset:6144
    ds_write_b128 v21, v[60:63] offset:7168
    s_lshl_b32 s47, s59, 11
    s_add_u32 s47, s47, 78848
    v_lshl_add_u32 v22, v2, 3, s47
    v_add_u32 v23, 42496, v22
    s_waitcnt lgkmcnt(0)
    s_barrier
    ds_read_b64 v[64:65], v22 offset:0
    ds_read_b64 v[66:67], v22 offset:21248
    ds_read_b64 v[68:69], v23 offset:0
    ds_read_b64 v[70:71], v23 offset:21248
    ds_read_b64 v[72:73], v22 offset:512
    ds_read_b64 v[74:75], v22 offset:21760
    ds_read_b64 v[76:77], v23 offset:512
    ds_read_b64 v[78:79], v23 offset:21760
    ds_read_b64 v[80:81], v22 offset:1024
    ds_read_b64 v[82:83], v22 offset:22272
    ds_read_b64 v[84:85], v23 offset:1024
    ds_read_b64 v[86:87], v23 offset:22272
    ds_read_b64 v[88:89], v22 offset:1536
    ds_read_b64 v[90:91], v22 offset:22784
    ds_read_b64 v[92:93], v23 offset:1536
    ds_read_b64 v[94:95], v23 offset:22784
    s_waitcnt lgkmcnt(12)
    v_fma_f32 v208, v96, v64, v208
    v_fma_f32 v192, v97, v66, v192
    v_fma_f32 v209, v98, v68, v209
    v_fma_f32 v193, v99, v70, v193
    v_fma_f32 v210, v100, v65, v210
    v_fma_f32 v194, v101, v67, v194
    v_fma_f32 v211, v102, v69, v211
    v_fma_f32 v195, v103, v71, v195
    v_cvt_pk_bf16_f32 v128, v208, v192
    v_cvt_pk_bf16_f32 v129, v209, v193
    v_cvt_pk_bf16_f32 v130, v210, v194
    v_cvt_pk_bf16_f32 v131, v211, v195
    buffer_store_dwordx4 v[128:131], v24, s[4:7], s48 offen sc1
    s_add_u32 s48, s48, 163840
    s_waitcnt lgkmcnt(8)
    v_fma_f32 v212, v104, v72, v212
    v_fma_f32 v196, v105, v74, v196
    v_fma_f32 v213, v106, v76, v213
    v_fma_f32 v197, v107, v78, v197
    v_fma_f32 v214, v108, v73, v214
    v_fma_f32 v198, v109, v75, v198
    v_fma_f32 v215, v110, v77, v215
    v_fma_f32 v199, v111, v79, v199
    v_cvt_pk_bf16_f32 v132, v212, v196
    v_cvt_pk_bf16_f32 v133, v213, v197
    v_cvt_pk_bf16_f32 v134, v214, v198
    v_cvt_pk_bf16_f32 v135, v215, v199
    buffer_store_dwordx4 v[132:135], v24, s[4:7], s48 offen sc1
    s_add_u32 s48, s48, 163840
    s_waitcnt lgkmcnt(4)
    v_fma_f32 v216, v112, v80, v216
    v_fma_f32 v200, v113, v82, v200
    v_fma_f32 v217, v114, v84, v217
    v_fma_f32 v201, v115, v86, v201
    v_fma_f32 v218, v116, v81, v218
    v_fma_f32 v202, v117, v83, v202
    v_fma_f32 v219, v118, v85, v219
    v_fma_f32 v203, v119, v87, v203
    v_cvt_pk_bf16_f32 v136, v216, v200
    v_cvt_pk_bf16_f32 v137, v217, v201
    v_cvt_pk_bf16_f32 v138, v218, v202
    v_cvt_pk_bf16_f32 v139, v219, v203
    buffer_store_dwordx4 v[136:139], v24, s[4:7], s48 offen sc1
    s_add_u32 s48, s48, 163840
    s_waitcnt lgkmcnt(0)
    v_fma_f32 v220, v120, v88, v220
    v_fma_f32 v204, v121, v90, v204
    v_fma_f32 v221, v122, v92, v221
    v_fma_f32 v205, v123, v94, v205
    v_fma_f32 v222, v124, v89, v222
    v_fma_f32 v206, v125, v91, v206
    v_fma_f32 v223, v126, v93, v223
    v_fma_f32 v207, v127, v95, v207
    v_cvt_pk_bf16_f32 v140, v220, v204
    v_cvt_pk_bf16_f32 v141, v221, v205
    v_cvt_pk_bf16_f32 v142, v222, v206
    v_cvt_pk_bf16_f32 v143, v223, v207
    buffer_store_dwordx4 v[140:143], v24, s[4:7], s48 offen sc1
    v_cvt_pk_bf16_f32 v48, v64, v66
    v_cvt_pk_bf16_f32 v49, v68, v70
    v_cvt_pk_bf16_f32 v50, v65, v67
    v_cvt_pk_bf16_f32 v51, v69, v71
    v_cvt_pk_bf16_f32 v52, v72, v74
    v_cvt_pk_bf16_f32 v53, v76, v78
    v_cvt_pk_bf16_f32 v54, v73, v75
    v_cvt_pk_bf16_f32 v55, v77, v79
    v_cvt_pk_bf16_f32 v56, v80, v82
    v_cvt_pk_bf16_f32 v57, v84, v86
    v_cvt_pk_bf16_f32 v58, v81, v83
    v_cvt_pk_bf16_f32 v59, v85, v87
    v_cvt_pk_bf16_f32 v60, v88, v90
    v_cvt_pk_bf16_f32 v61, v92, v94
    v_cvt_pk_bf16_f32 v62, v89, v91
    v_cvt_pk_bf16_f32 v63, v93, v95
    s_waitcnt vmcnt(4)
    v_accvgpr_read_b32 v64, a232
    v_accvgpr_read_b32 v65, a233
    v_accvgpr_read_b32 v66, a234
    v_accvgpr_read_b32 v67, a235
    v_accvgpr_read_b32 v68, a236
    v_accvgpr_read_b32 v69, a237
    v_accvgpr_read_b32 v70, a238
    v_accvgpr_read_b32 v71, a239
    v_accvgpr_read_b32 v72, a240
    v_accvgpr_read_b32 v73, a241
    v_accvgpr_read_b32 v74, a242
    v_accvgpr_read_b32 v75, a243
    v_accvgpr_read_b32 v76, a244
    v_accvgpr_read_b32 v77, a245
    v_accvgpr_read_b32 v78, a246
    v_accvgpr_read_b32 v79, a247
    v_accvgpr_read_b32 v80, a248
    v_accvgpr_read_b32 v81, a249
    v_accvgpr_read_b32 v82, a250
    v_accvgpr_read_b32 v83, a251
    v_add_f32 v64, v64, v68
    v_add_f32 v65, v65, v69
    v_add_f32 v66, v66, v70
    v_add_f32 v67, v67, v71
    v_add_f32 v64, v64, v72
    v_add_f32 v65, v65, v73
    v_add_f32 v66, v66, v74
    v_add_f32 v67, v67, v75
    v_add_f32 v64, v64, v76
    v_add_f32 v65, v65, v77
    v_add_f32 v66, v66, v78
    v_add_f32 v67, v67, v79
    v_add_f32 v64, v64, v80
    v_add_f32 v65, v65, v81
    v_add_f32 v66, v66, v82
    v_add_f32 v67, v67, v83
    v_mov_b32 v240, v64
    s_nop 1
    v_permlane16_swap_b32 v240, v64
    v_add_f32 v64, v64, v240
    v_mov_b32 v240, v65
    s_nop 1
    v_permlane16_swap_b32 v240, v65
    v_add_f32 v65, v65, v240
    v_mov_b32 v240, v66
    s_nop 1
    v_permlane16_swap_b32 v240, v66
    v_add_f32 v66, v66, v240
    v_mov_b32 v240, v67
    s_nop 1
    v_permlane16_swap_b32 v240, v67
    v_add_f32 v67, v67, v240
    v_mov_b32 v240, v64
    s_nop 1
    v_permlane32_swap_b32 v240, v64
    v_add_f32 v64, v64, v240
    v_mov_b32 v240, v65
    s_nop 1
    v_permlane32_swap_b32 v240, v65
    v_add_f32 v65, v65, v240
    v_mov_b32 v240, v66
    s_nop 1
    v_permlane32_swap_b32 v240, v66
    v_add_f32 v66, v66, v240
    v_mov_b32 v240, v67
    s_nop 1
    v_permlane32_swap_b32 v240, v67
    v_add_f32 v67, v67, v240
    ds_write_b32 v243, v64 offset:0
    ds_write_b32 v243, v65 offset:64
    ds_write_b32 v243, v66 offset:32
    ds_write_b32 v243, v67 offset:96
    s_waitcnt vmcnt(0)
    s_barrier
    s_lshl_b32 s50, s2, 2
    s_add_u32 s51, s50, 9216
    s_add_u32 s50, s50, 32768
    s_cmp_lg_u32 s59, 0
    s_cbranch_scc1 L_fs_16
    v_mbcnt_lo_u32_b32 v4, -1, 0
    v_mul_u32_u24 v4, 1024, v4
    v_mov_b32 v5, s3
    s_mov_b64 exec, 65535
    buffer_store_dword v5, v4, s[4:7], s50 offen sc1
    s_mov_b64 exec, -1
L_fs_16:
    v_mov_b32 v249, v24
    s_mov_b32 s73, s49
    s_mov_b32 s70, 1
    v_mbcnt_lo_u32_b32 v224, -1, 0
    v_mbcnt_hi_u32_b32 v224, -1, v224
    v_lshlrev_b32 v224, 4, v224
    s_cmp_eq_u32 s59, 1
    s_cbranch_scc1 L_nd_17
    s_min_u32 s81, s59, 1
    s_sub_u32 s81, s59, s81
    s_mul_i32 s82, s81, 40960
    s_add_u32 s82, s82, 65536
    s_cmp_eq_u32 s59, 3
    s_cselect_b32 s82, 28672, s82
    s_add_u32 s82, s82, s67
    s_add_u32 s81, s81, 19
    s_lshl_b32 s81, s81, 12
    s_mov_b32 m0, s81
    s_nop 0
    buffer_load_dwordx4 v224, s[4:7], s82 offen offset:0 sc1 lds
    buffer_load_dwordx4 v224, s[4:7], s82 offen offset:1024 sc1 lds
    buffer_load_dwordx4 v224, s[4:7], s82 offen offset:2048 sc1 lds
    buffer_load_dwordx4 v224, s[4:7], s82 offen offset:3072 sc1 lds
    s_add_u32 s81, s81, 12288
    s_add_u32 s82, s82, 4096
    s_mov_b32 m0, s81
    s_nop 0
    buffer_load_dwordx4 v224, s[4:7], s82 offen offset:0 sc1 lds
    buffer_load_dwordx4 v224, s[4:7], s82 offen offset:1024 sc1 lds
    buffer_load_dwordx4 v224, s[4:7], s82 offen offset:2048 sc1 lds
    buffer_load_dwordx4 v224, s[4:7], s82 offen offset:3072 sc1 lds
    s_add_u32 s81, s81, 12288
    s_add_u32 s82, s82, 4096
    s_mov_b32 m0, s81
    s_nop 0
    buffer_load_dwordx4 v224, s[4:7], s82 offen offset:0 sc1 lds
    buffer_load_dwordx4 v224, s[4:7], s82 offen offset:1024 sc1 lds
    buffer_load_dwordx4 v224, s[4:7], s82 offen offset:2048 sc1 lds
    buffer_load_dwordx4 v224, s[4:7], s82 offen offset:3072 sc1 lds
    s_add_u32 s81, s81, 12288
    s_add_u32 s82, s82, 4096
    s_add_u32 s74, s81, s67
    s_cmp_eq_u32 s59, 3
    s_cselect_b32 s82, s74, s82
    s_mov_b32 m0, s81
    s_nop 0
    buffer_load_dwordx4 v224, s[4:7], s82 offen offset:0 sc1 lds
    buffer_load_dwordx4 v224, s[4:7], s82 offen offset:1024 sc1 lds
    buffer_load_dwordx4 v224, s[4:7], s82 offen offset:2048 sc1 lds
    buffer_load_dwordx4 v224, s[4:7], s82 offen offset:3072 sc1 lds
    s_add_u32 s81, s81, 12288
    s_add_u32 s82, s81, s67
    s_mov_b32 m0, s81
    s_nop 0
    buffer_load_dwordx4 v224, s[4:7], s82 offen offset:0 sc1 lds
    buffer_load_dwordx4 v224, s[4:7], s82 offen offset:1024 sc1 lds
    buffer_load_dwordx4 v224, s[4:7], s82 offen offset:2048 sc1 lds
    buffer_load_dwordx4 v224, s[4:7], s82 offen offset:3072 sc1 lds
    s_add_u32 s81, s81, 12288
    s_add_u32 s82, s81, s67
    s_mov_b32 m0, s81
    s_nop 0
    buffer_load_dwordx4 v224, s[4:7], s82 offen offset:0 sc1 lds
    buffer_load_dwordx4 v224, s[4:7], s82 offen offset:1024 sc1 lds
    buffer_load_dwordx4 v224, s[4:7], s82 offen offset:2048 sc1 lds
    buffer_load_dwordx4 v224, s[4:7], s82 offen offset:3072 sc1 lds
    s_add_u32 s81, s81, 12288
    s_min_u32 s81, s81, 155648
    s_add_u32 s82, s81, s67
    s_mov_b32 m0, s81
    s_nop 0
    buffer_load_dwordx4 v224, s[4:7], s82 offen offset:0 sc1 lds
    buffer_load_dwordx4 v224, s[4:7], s82 offen offset:1024 sc1 lds
    buffer_load_dwordx4 v224, s[4:7], s82 offen offset:2048 sc1 lds
    buffer_load_dwordx4 v224, s[4:7], s82 offen offset:3072 sc1 lds
L_nd_17:
    v_lshrrev_b32 v250, 4, v224
    v_bfe_u32 v251, v250, 2, 1
    v_bfe_u32 v252, v250, 4, 1
    v_lshl_add_u32 v251, v252, 1, v251
    v_bfe_u32 v252, v250, 1, 1
    v_lshrrev_b32 v253, 5, v250
    v_xor_b32 v253, v253, v252
    v_lshl_add_u32 v251, v253, 2, v251
    v_lshl_add_u32 v251, v252, 4, v251
    v_and_b32 v252, 1, v250
    v_lshl_add_u32 v251, v252, 3, v251
    v_bfe_u32 v252, v250, 3, 1
    v_lshl_add_u32 v251, v252, 5, v251
    v_lshlrev_b32 v225, 4, v251
    v_add_u32 v226, 0x10000, v225
    v_add_u32 v227, 0x20000, v225
    v_and_b32 v251, 7, v250
    v_bfe_u32 v252, v250, 4, 1
    v_lshl_add_u32 v251, v251, 1, v252
    v_lshlrev_b32 v251, 4, v251
    v_bfe_u32 v252, v250, 3, 1
    v_mul_u32_u24 v252, 55296, v252
    v_add_u32 v251, v251, v252
    v_lshrrev_b32 v252, 5, v250
    v_lshl_add_u32 v228, v252, 8, v251
    v_lshlrev_b32 v248, 6, v252
    v_add_u32 v248, 159744, v248
    s_branch L_joinA
L_roleP:
    s_load_dwordx2 s[8:9], s[0:1], 56
    s_mov_b32 s10, 2211840
    s_mov_b32 s11, 0x00020000
    s_load_dwordx2 s[12:13], s[0:1], 64
    s_mov_b32 s14, 2211840
    s_mov_b32 s15, 0x00020000
    s_load_dwordx2 s[16:17], s[0:1], 72
    s_mov_b32 s18, 2211840
    s_mov_b32 s19, 0x00020000
    s_load_dwordx2 s[20:21], s[0:1], 0
    s_mov_b32 s22, 2621440
    s_mov_b32 s23, 0x00020000
    s_waitcnt lgkmcnt(0)
    s_load_dword s3, s[4:5], 0
    s_mov_b32 s52, s8
    s_mov_b32 s53, s9
    s_sub_u32 s28, s2, 160
    v_and_b32 v2, 63, v0
    v_and_b32 v3, 15, v2
    v_lshrrev_b32 v4, 4, v2
    s_mov_b32 s36, 0x05040100
    s_mov_b32 s37, 0x07060302
    s_mov_b32 s38, 0x3f803f80
    s_lshl_b32 s50, s28, 2
    s_add_u32 s50, s50, s59
    s_mul_i32 s25, s50, 3
    v_mul_u32_u24 v5, 27648, v4
    v_lshl_add_u32 v5, v3, 3, v5
    v_add_u32 v6, 6912, v5
    v_add_u32 v7, 13824, v5
    v_add_u32 v8, 20736, v5
    v_and_b32 v12, 3, v3
    v_lshlrev_b32 v12, 4, v12
    v_and_b32 v19, 1, v4
    v_lshl_add_u32 v12, v19, 6, v12
    v_lshrrev_b32 v19, 1, v4
    v_lshl_add_u32 v12, v19, 10, v12
    v_lshrrev_b32 v19, 2, v3
    v_mul_u32_u24 v9, 40960, v19
    v_add_u32 v9, v9, v12
    v_xor_b32 v10, 64, v9
    v_lshlrev_b32 v19, 7, v4
    v_mov_b32 v204, s38
    v_mov_b32 v205, s38
    v_mov_b32 v206, s38
    v_mov_b32 v207, s38
    s_cmp_lt_u32 s25, 1080
    s_cselect_b32 s35, 0, 2147483648
    v_or_b32 v5, s35, v5
    v_or_b32 v6, s35, v6
    v_or_b32 v7, s35, v7
    v_or_b32 v8, s35, v8
    v_or_b32 v9, s35, v9
    v_or_b32 v10, s35, v10
    v_or_b32 v19, s35, v19
    v_lshrrev_b32 v240, 1, v4
    v_lshlrev_b32 v240, 4, v240
    v_and_b32 v243, 1, v4
    v_lshl_add_u32 v240, v243, 2, v240
    v_mul_u32_u24 v240, 1280, v240
    v_lshl_add_u32 v240, v3, 3, v240
    v_add_u32 v241, 10240, v240
    v_and_b32 v242, 3, v3
    v_lshlrev_b32 v242, 4, v242
    v_lshl_add_u32 v242, v4, 8, v242
    v_lshrrev_b32 v243, 2, v3
    v_mul_u32_u24 v243, 55296, v243
    v_add_u32 v242, v243, v242
    v_lshrrev_b32 v244, 1, v4
    v_mul_u32_u24 v244, 20480, v244
    s_add_u32 s33, s25, 0
    s_min_u32 s33, s33, 1079
    s_mul_i32 s26, s33, 1214
    s_lshr_b32 s26, s26, 16
    s_mul_i32 s24, s26, 54
    s_sub_u32 s24, s33, s24
    s_cmp_ge_u32 s24, 27
    s_cselect_b32 s8, s12, s52
    s_cselect_b32 s9, s13, s53
    s_cselect_b32 s29, 27, 0
    s_cselect_b32 s30, 512, 0
    s_sub_u32 s24, s24, s29
    s_mul_i32 s31, s26, 110592
    s_lshl_b32 s32, s24, 7
    s_add_u32 s31, s31, s32
    buffer_load_dwordx2 v[20:21], v5, s[8:11], s31 offen offset:0 nt
    buffer_load_dwordx2 v[22:23], v5, s[8:11], s31 offen offset:3456 nt
    buffer_load_dwordx2 v[24:25], v6, s[8:11], s31 offen offset:0 nt
    buffer_load_dwordx2 v[26:27], v6, s[8:11], s31 offen offset:3456 nt
    buffer_load_dwordx2 v[28:29], v7, s[8:11], s31 offen offset:0 nt
    buffer_load_dwordx2 v[30:31], v7, s[8:11], s31 offen offset:3456 nt
    buffer_load_dwordx2 v[32:33], v8, s[8:11], s31 offen offset:0 nt
    buffer_load_dwordx2 v[34:35], v8, s[8:11], s31 offen offset:3456 nt
    s_mul_i32 s31, s24, 163840
    s_lshl_b32 s32, s26, 11
    s_add_u32 s31, s31, s32
    s_add_u32 s31, s31, s30
    s_add_u32 s41, s31, 16777216
    s_mul_i32 s31, s26, 13824
    s_lshl_b32 s32, s24, 9
    s_add_u32 s31, s31, s32
    s_lshr_b32 s30, s30, 3
    s_add_u32 s31, s31, s30
    s_add_u32 s47, s31, 23461888
    s_add_u32 s33, s25, 1
    s_min_u32 s33, s33, 1079
    s_mul_i32 s26, s33, 1214
    s_lshr_b32 s26, s26, 16
    s_mul_i32 s24, s26, 54
    s_sub_u32 s24, s33, s24
    s_cmp_ge_u32 s24, 27
    s_cselect_b32 s8, s12, s52
    s_cselect_b32 s9, s13, s53
    s_cselect_b32 s29, 27, 0
    s_cselect_b32 s30, 512, 0
    s_sub_u32 s24, s24, s29
    s_mul_i32 s31, s26, 110592
    s_lshl_b32 s32, s24, 7
    s_add_u32 s31, s31, s32
    buffer_load_dwordx2 v[36:37], v5, s[8:11], s31 offen offset:0 nt
    buffer_load_dwordx2 v[38:39], v5, s[8:11], s31 offen offset:3456 nt
    buffer_load_dwordx2 v[40:41], v6, s[8:11], s31 offen offset:0 nt
    buffer_load_dwordx2 v[42:43], v6, s[8:11], s31 offen offset:3456 nt
    buffer_load_dwordx2 v[44:45], v7, s[8:11], s31 offen offset:0 nt
    buffer_load_dwordx2 v[46:47], v7, s[8:11], s31 offen offset:3456 nt
    buffer_load_dwordx2 v[48:49], v8, s[8:11], s31 offen offset:0 nt
    buffer_load_dwordx2 v[50:51], v8, s[8:11], s31 offen offset:3456 nt
    s_mul_i32 s31, s24, 163840
    s_lshl_b32 s32, s26, 11
    s_add_u32 s31, s31, s32
    s_add_u32 s31, s31, s30
    s_add_u32 s42, s31, 16777216
    s_mul_i32 s31, s26, 13824
    s_lshl_b32 s32, s24, 9
    s_add_u32 s31, s31, s32
    s_lshr_b32 s30, s30, 3
    s_add_u32 s31, s31, s30
    s_add_u32 s48, s31, 23461888
    s_add_u32 s33, s25, 2
    s_min_u32 s33, s33, 1079
    s_mul_i32 s26, s33, 1214
    s_lshr_b32 s26, s26, 16
    s_mul_i32 s24, s26, 54
    s_sub_u32 s24, s33, s24
    s_cmp_ge_u32 s24, 27
    s_cselect_b32 s8, s12, s52
    s_cselect_b32 s9, s13, s53
    s_cselect_b32 s29, 27, 0
    s_cselect_b32 s30, 512, 0
    s_sub_u32 s24, s24, s29
    s_mul_i32 s31, s26, 110592
    s_lshl_b32 s32, s24, 7
    s_add_u32 s31, s31, s32
    buffer_load_dwordx2 v[52:53], v5, s[8:11], s31 offen offset:0 nt
    buffer_load_dwordx2 v[54:55], v5, s[8:11], s31 offen offset:3456 nt
    buffer_load_dwordx2 v[56:57], v6, s[8:11], s31 offen offset:0 nt
    buffer_load_dwordx2 v[58:59], v6, s[8:11], s31 offen offset:3456 nt
    buffer_load_dwordx2 v[60:61], v7, s[8:11], s31 offen offset:0 nt
    buffer_load_dwordx2 v[62:63], v7, s[8:11], s31 offen offset:3456 nt
    buffer_load_dwordx2 v[64:65], v8, s[8:11], s31 offen offset:0 nt
    buffer_load_dwordx2 v[66:67], v8, s[8:11], s31 offen offset:3456 nt
    s_mul_i32 s31, s24, 163840
    s_lshl_b32 s32, s26, 11
    s_add_u32 s31, s31, s32
    s_add_u32 s31, s31, s30
    s_add_u32 s43, s31, 16777216
    s_mul_i32 s31, s26, 13824
    s_lshl_b32 s32, s24, 9
    s_add_u32 s31, s31, s32
    s_lshr_b32 s30, s30, 3
    s_add_u32 s31, s31, s30
    s_add_u32 s49, s31, 23461888
    s_waitcnt lgkmcnt(0)
    s_mul_i32 s3, s3, 1664525
    s_add_u32 s3, s3, 1013904223
    s_getreg_b32 s89, hwreg(HW_REG_XCC_ID, 0, 4)
    s_cmp_lg_u32 s59, 0
    s_cbranch_scc1 L_xt_18
    s_and_b32 s90, s2, 7
    s_lshl_b32 s90, s90, 8
    s_lshr_b32 s91, s2, 3
    s_lshl_b32 s91, s91, 3
    s_add_u32 s90, s90, s91
    s_add_u32 s90, s90, 28672
    v_mov_b32 v16, 0
    v_mov_b32 v14, s3
    v_mov_b32 v15, s89
    s_mov_b64 exec, 1
    buffer_store_dwordx2 v[14:15], v16, s[4:7], s90 offen sc1
    s_mov_b64 exec, -1
L_xt_18:
    s_waitcnt vmcnt(16)
    v_perm_b32 v116, v22, v20, s36
    v_perm_b32 v117, v26, v24, s36
    v_perm_b32 v118, v30, v28, s36
    v_perm_b32 v119, v34, v32, s36
    v_perm_b32 v120, v22, v20, s37
    v_perm_b32 v121, v26, v24, s37
    v_perm_b32 v122, v30, v28, s37
    v_perm_b32 v123, v34, v32, s37
    v_perm_b32 v124, v23, v21, s36
    v_perm_b32 v125, v27, v25, s36
    v_perm_b32 v126, v31, v29, s36
    v_perm_b32 v127, v35, v33, s36
    v_perm_b32 v128, v23, v21, s37
    v_perm_b32 v129, v27, v25, s37
    v_perm_b32 v130, v31, v29, s37
    v_perm_b32 v131, v35, v33, s37
    v_mfma_f32_16x16x32_bf16 v[208:211], v[116:119], v[204:207], 0
    buffer_store_dwordx4 v[116:119], v9, s[4:7], s41 offen offset:0 sc1
    v_mfma_f32_16x16x32_bf16 v[212:215], v[120:123], v[204:207], 0
    buffer_store_dwordx4 v[120:123], v9, s[4:7], s41 offen offset:128 sc1
    v_mfma_f32_16x16x32_bf16 v[216:219], v[124:127], v[204:207], 0
    buffer_store_dwordx4 v[124:127], v10, s[4:7], s41 offen offset:256 sc1
    v_mfma_f32_16x16x32_bf16 v[220:223], v[128:131], v[204:207], 0
    buffer_store_dwordx4 v[128:131], v10, s[4:7], s41 offen offset:384 sc1
    s_mov_b32 exec_lo, 0x00010001
    s_mov_b32 exec_hi, 0x00010001
    buffer_store_dwordx4 v[208:211], v19, s[4:7], s47 offen offset:0 sc1
    buffer_store_dwordx4 v[212:215], v19, s[4:7], s47 offen offset:16 sc1
    s_nop 0
    buffer_store_dwordx4 v[216:219], v19, s[4:7], s47 offen offset:32 sc1
    s_nop 0
    buffer_store_dwordx4 v[220:223], v19, s[4:7], s47 offen offset:48 sc1
    s_mov_b64 exec, -1
    s_waitcnt vmcnt(16)
    v_perm_b32 v132, v38, v36, s36
    v_perm_b32 v133, v42, v40, s36
    v_perm_b32 v134, v46, v44, s36
    v_perm_b32 v135, v50, v48, s36
    v_perm_b32 v136, v38, v36, s37
    v_perm_b32 v137, v42, v40, s37
    v_perm_b32 v138, v46, v44, s37
    v_perm_b32 v139, v50, v48, s37
    v_perm_b32 v140, v39, v37, s36
    v_perm_b32 v141, v43, v41, s36
    v_perm_b32 v142, v47, v45, s36
    v_perm_b32 v143, v51, v49, s36
    v_perm_b32 v144, v39, v37, s37
    v_perm_b32 v145, v43, v41, s37
    v_perm_b32 v146, v47, v45, s37
    v_perm_b32 v147, v51, v49, s37
    v_mfma_f32_16x16x32_bf16 v[224:227], v[132:135], v[204:207], 0
    buffer_store_dwordx4 v[132:135], v9, s[4:7], s42 offen offset:0 sc1
    v_mfma_f32_16x16x32_bf16 v[228:231], v[136:139], v[204:207], 0
    buffer_store_dwordx4 v[136:139], v9, s[4:7], s42 offen offset:128 sc1
    v_mfma_f32_16x16x32_bf16 v[232:235], v[140:143], v[204:207], 0
    buffer_store_dwordx4 v[140:143], v10, s[4:7], s42 offen offset:256 sc1
    v_mfma_f32_16x16x32_bf16 v[236:239], v[144:147], v[204:207], 0
    buffer_store_dwordx4 v[144:147], v10, s[4:7], s42 offen offset:384 sc1
    s_mov_b32 exec_lo, 0x00010001
    s_mov_b32 exec_hi, 0x00010001
    buffer_store_dwordx4 v[224:227], v19, s[4:7], s48 offen offset:0 sc1
    buffer_store_dwordx4 v[228:231], v19, s[4:7], s48 offen offset:16 sc1
    s_nop 0
    buffer_store_dwordx4 v[232:235], v19, s[4:7], s48 offen offset:32 sc1
    s_nop 0
    buffer_store_dwordx4 v[236:239], v19, s[4:7], s48 offen offset:48 sc1
    s_mov_b64 exec, -1
    s_waitcnt vmcnt(16)
    v_perm_b32 v116, v54, v52, s36
    v_perm_b32 v117, v58, v56, s36
    v_perm_b32 v118, v62, v60, s36
    v_perm_b32 v119, v66, v64, s36
    v_perm_b32 v120, v54, v52, s37
    v_perm_b32 v121, v58, v56, s37
    v_perm_b32 v122, v62, v60, s37
    v_perm_b32 v123, v66, v64, s37
    v_perm_b32 v124, v55, v53, s36
    v_perm_b32 v125, v59, v57, s36
    v_perm_b32 v126, v63, v61, s36
    v_perm_b32 v127, v67, v65, s36
    v_perm_b32 v128, v55, v53, s37
    v_perm_b32 v129, v59, v57, s37
    v_perm_b32 v130, v63, v61, s37
    v_perm_b32 v131, v67, v65, s37
    v_mfma_f32_16x16x32_bf16 v[208:211], v[116:119], v[204:207], 0
    buffer_store_dwordx4 v[116:119], v9, s[4:7], s43 offen offset:0 sc1
    v_mfma_f32_16x16x32_bf16 v[212:215], v[120:123], v[204:207], 0
    buffer_store_dwordx4 v[120:123], v9, s[4:7], s43 offen offset:128 sc1
    v_mfma_f32_16x16x32_bf16 v[216:219], v[124:127], v[204:207], 0
    buffer_store_dwordx4 v[124:127], v10, s[4:7], s43 offen offset:256 sc1
    v_mfma_f32_16x16x32_bf16 v[220:223], v[128:131], v[204:207], 0
    buffer_store_dwordx4 v[128:131], v10, s[4:7], s43 offen offset:384 sc1
    s_mov_b32 exec_lo, 0x00010001
    s_mov_b32 exec_hi, 0x00010001
    buffer_store_dwordx4 v[208:211], v19, s[4:7], s49 offen offset:0 sc1
    buffer_store_dwordx4 v[212:215], v19, s[4:7], s49 offen offset:16 sc1
    s_nop 0
    buffer_store_dwordx4 v[216:219], v19, s[4:7], s49 offen offset:32 sc1
    s_nop 0
    buffer_store_dwordx4 v[220:223], v19, s[4:7], s49 offen offset:48 sc1
    s_mov_b64 exec, -1
    s_min_u32 s29, s50, 539
    s_mul_i32 s30, s29, 6554
    s_lshr_b32 s30, s30, 16
    s_mul_i32 s31, s30, 10
    s_sub_u32 s29, s29, s31
    s_mul_i32 s31, s30, 4682
    s_lshr_b32 s31, s31, 16
    s_mul_i32 s32, s31, 14
    s_sub_u32 s32, s30, s32
    s_mov_b32 s57, s32
    s_mov_b32 s58, 0
    s_mov_b32 s55, 0
    s_sub_u32 s63, s32, 4
    s_lshl_b32 s63, s63, 1
    s_cmp_ge_u32 s32, 4
    s_cselect_b32 s57, s63, s57
    s_cselect_b32 s58, 2, s58
    s_cselect_b32 s55, 1, s55
    s_sub_u32 s63, s32, 6
    s_lshl_b32 s63, s63, 1
    s_cmp_ge_u32 s32, 6
    s_cselect_b32 s57, s63, s57
    s_cselect_b32 s58, 3, s58
    s_cselect_b32 s55, 1, s55
    s_sub_u32 s63, s32, 8
    s_cmp_ge_u32 s32, 8
    s_cselect_b32 s57, s63, s57
    s_cselect_b32 s58, 4, s58
    s_cselect_b32 s55, 0, s55
    s_sub_u32 s63, s32, 12
    s_lshl_b32 s63, s63, 1
    s_cmp_ge_u32 s32, 12
    s_cselect_b32 s57, s63, s57
    s_cselect_b32 s58, 6, s58
    s_cselect_b32 s55, 1, s55
    s_cmp_eq_u32 s31, 3
    s_cselect_b32 s63, 5, 6
    s_mul_i32 s55, s55, s63
    v_mul_u32_u24 v245, s55, v244
    v_add_u32 v246, v241, v245
    v_add_u32 v245, v240, v245
    s_lshl_b32 s31, s31, 2
    s_add_u32 s57, s57, s31
    s_mul_i32 s31, s57, 7
    s_mul_i32 s32, s57, 6
    s_add_u32 s32, s32, 12
    s_cmp_lt_u32 s57, 12
    s_cselect_b32 s31, s31, s32
    s_add_u32 s31, s31, s58
    s_mul_i32 s31, s31, 20480
    s_lshl_b32 s32, s29, 7
    s_add_u32 s31, s31, s32
    buffer_load_dwordx2 v[68:69], v245, s[16:19], s31 offen offset:0 nt
    buffer_load_dwordx2 v[70:71], v245, s[16:19], s31 offen offset:1280 nt
    buffer_load_dwordx2 v[72:73], v245, s[16:19], s31 offen offset:2560 nt
    buffer_load_dwordx2 v[74:75], v245, s[16:19], s31 offen offset:3840 nt
    buffer_load_dwordx2 v[76:77], v246, s[16:19], s31 offen offset:0 nt
    buffer_load_dwordx2 v[78:79], v246, s[16:19], s31 offen offset:1280 nt
    buffer_load_dwordx2 v[80:81], v246, s[16:19], s31 offen offset:2560 nt
    buffer_load_dwordx2 v[82:83], v246, s[16:19], s31 offen offset:3840 nt
    s_mul_i32 s31, s29, 221184
    s_lshl_b32 s32, s30, 10
    s_add_u32 s31, s31, s32
    s_add_u32 s44, s31, 21233664
    s_add_u32 s54, s50, 384
    s_cmp_lt_u32 s50, 156
    s_cselect_b32 s51, 1, 0
    s_waitcnt vmcnt(8)
    s_barrier
    s_lshl_b32 s56, s28, 2
    s_add_u32 s56, s56, 69632
    s_cmp_lg_u32 s59, 0
    s_cbranch_scc1 L_fs_19
    v_mbcnt_lo_u32_b32 v16, -1, 0
    v_mul_u32_u24 v16, 512, v16
    v_mov_b32 v17, s3
    s_mov_b64 exec, 65535
    buffer_store_dword v17, v16, s[4:7], s56 offen sc1
    s_mov_b64 exec, -1
L_fs_19:
    s_cmp_eq_u32 s51, 0
    s_cbranch_scc1 L_gd_20
    s_min_u32 s29, s54, 539
    s_mul_i32 s30, s29, 6554
    s_lshr_b32 s30, s30, 16
    s_mul_i32 s31, s30, 10
    s_sub_u32 s29, s29, s31
    s_mul_i32 s31, s30, 4682
    s_lshr_b32 s31, s31, 16
    s_mul_i32 s32, s31, 14
    s_sub_u32 s32, s30, s32
    s_mov_b32 s57, s32
    s_mov_b32 s58, 0
    s_mov_b32 s55, 0
    s_sub_u32 s63, s32, 4
    s_lshl_b32 s63, s63, 1
    s_cmp_ge_u32 s32, 4
    s_cselect_b32 s57, s63, s57
    s_cselect_b32 s58, 2, s58
    s_cselect_b32 s55, 1, s55
    s_sub_u32 s63, s32, 6
    s_lshl_b32 s63, s63, 1
    s_cmp_ge_u32 s32, 6
    s_cselect_b32 s57, s63, s57
    s_cselect_b32 s58, 3, s58
    s_cselect_b32 s55, 1, s55
    s_sub_u32 s63, s32, 8
    s_cmp_ge_u32 s32, 8
    s_cselect_b32 s57, s63, s57
    s_cselect_b32 s58, 4, s58
    s_cselect_b32 s55, 0, s55
    s_sub_u32 s63, s32, 12
    s_lshl_b32 s63, s63, 1
    s_cmp_ge_u32 s32, 12
    s_cselect_b32 s57, s63, s57
    s_cselect_b32 s58, 6, s58
    s_cselect_b32 s55, 1, s55
    s_cmp_eq_u32 s31, 3
    s_cselect_b32 s63, 5, 6
    s_mul_i32 s55, s55, s63
    v_mul_u32_u24 v245, s55, v244
    v_add_u32 v246, v241, v245
    v_add_u32 v245, v240, v245
    s_lshl_b32 s31, s31, 2
    s_add_u32 s57, s57, s31
    s_mul_i32 s31, s57, 7
    s_mul_i32 s32, s57, 6
    s_add_u32 s32, s32, 12
    s_cmp_lt_u32 s57, 12
    s_cselect_b32 s31, s31, s32
    s_add_u32 s31, s31, s58
    s_mul_i32 s31, s31, 20480
    s_lshl_b32 s32, s29, 7
    s_add_u32 s31, s31, s32
    buffer_load_dwordx2 v[84:85], v245, s[16:19], s31 offen offset:0 nt
    buffer_load_dwordx2 v[86:87], v245, s[16:19], s31 offen offset:1280 nt
    buffer_load_dwordx2 v[88:89], v245, s[16:19], s31 offen offset:2560 nt
    buffer_load_dwordx2 v[90:91], v245, s[16:19], s31 offen offset:3840 nt
    buffer_load_dwordx2 v[92:93], v246, s[16:19], s31 offen offset:0 nt
    buffer_load_dwordx2 v[94:95], v246, s[16:19], s31 offen offset:1280 nt
    buffer_load_dwordx2 v[96:97], v246, s[16:19], s31 offen offset:2560 nt
    buffer_load_dwordx2 v[98:99], v246, s[16:19], s31 offen offset:3840 nt
    s_mul_i32 s31, s29, 221184
    s_lshl_b32 s32, s30, 10
    s_add_u32 s31, s31, s32
    s_add_u32 s45, s31, 21233664
L_gd_20:
    s_waitcnt vmcnt(0)
    v_perm_b32 v116, v70, v68, s36
    v_perm_b32 v117, v74, v72, s36
    v_perm_b32 v118, v78, v76, s36
    v_perm_b32 v119, v82, v80, s36
    v_perm_b32 v120, v70, v68, s37
    v_perm_b32 v121, v74, v72, s37
    v_perm_b32 v122, v78, v76, s37
    v_perm_b32 v123, v82, v80, s37
    v_perm_b32 v124, v71, v69, s36
    v_perm_b32 v125, v75, v73, s36
    v_perm_b32 v126, v79, v77, s36
    v_perm_b32 v127, v83, v81, s36
    v_perm_b32 v128, v71, v69, s37
    v_perm_b32 v129, v75, v73, s37
    v_perm_b32 v130, v79, v77, s37
    v_perm_b32 v131, v83, v81, s37
    buffer_store_dwordx4 v[116:119], v242, s[4:7], s44 offen offset:0 sc1
    buffer_store_dwordx4 v[120:123], v242, s[4:7], s44 offen offset:64 sc1
    buffer_store_dwordx4 v[124:127], v242, s[4:7], s44 offen offset:128 sc1
    buffer_store_dwordx4 v[128:131], v242, s[4:7], s44 offen offset:192 sc1
    s_cmp_eq_u32 s51, 0
    s_cbranch_scc1 L_gd_21
    s_waitcnt vmcnt(0)
    v_perm_b32 v132, v86, v84, s36
    v_perm_b32 v133, v90, v88, s36
    v_perm_b32 v134, v94, v92, s36
    v_perm_b32 v135, v98, v96, s36
    v_perm_b32 v136, v86, v84, s37
    v_perm_b32 v137, v90, v88, s37
    v_perm_b32 v138, v94, v92, s37
    v_perm_b32 v139, v98, v96, s37
    v_perm_b32 v140, v87, v85, s36
    v_perm_b32 v141, v91, v89, s36
    v_perm_b32 v142, v95, v93, s36
    v_perm_b32 v143, v99, v97, s36
    v_perm_b32 v144, v87, v85, s37
    v_perm_b32 v145, v91, v89, s37
    v_perm_b32 v146, v95, v93, s37
    v_perm_b32 v147, v99, v97, s37
    buffer_store_dwordx4 v[132:135], v242, s[4:7], s45 offen offset:0 sc1
    buffer_store_dwordx4 v[136:139], v242, s[4:7], s45 offen offset:64 sc1
    buffer_store_dwordx4 v[140:143], v242, s[4:7], s45 offen offset:128 sc1
    buffer_store_dwordx4 v[144:147], v242, s[4:7], s45 offen offset:192 sc1
L_gd_21:
L_pp_end:
    s_waitcnt vmcnt(0)
    s_barrier
    s_lshl_b32 s56, s28, 2
    s_add_u32 s56, s56, 77824
    s_cmp_lg_u32 s59, 0
    s_cbranch_scc1 L_fs_22
    v_mbcnt_lo_u32_b32 v16, -1, 0
    v_mul_u32_u24 v16, 512, v16
    v_mov_b32 v17, s3
    s_mov_b64 exec, 65535
    buffer_store_dword v17, v16, s[4:7], s56 offen sc1
    s_mov_b64 exec, -1
L_fs_22:
    s_mov_b32 s70, 0
    v_mbcnt_lo_u32_b32 v224, -1, 0
    v_mbcnt_hi_u32_b32 v224, -1, v224
    v_lshlrev_b32 v224, 4, v224
    v_lshrrev_b32 v88, 4, v224
    v_min_u32 v88, 23, v88
    v_lshlrev_b32 v88, 4, v88
    s_and_b32 s45, s2, 15
    s_lshl_b32 s45, s45, 9
    s_add_u32 s45, s45, 69632
    s_cmp_lg_u32 s59, 1
    s_cbranch_scc1 L_pw_23
    buffer_load_dwordx4 v[84:87], v88, s[4:7], s45 offen sc1
    s_waitcnt vmcnt(0)
    v_xor_b32 v84, s3, v84
    v_xor_b32 v85, s3, v85
    v_xor_b32 v86, s3, v86
    v_xor_b32 v87, s3, v87
    v_or3_b32 v84, v84, v85, v86
    v_or_b32 v84, v84, v87
    v_cmp_ne_u32 vcc, 0, v84
    s_cbranch_vccnz L_spin_24
L_back_25:
L_pw_23:
    s_barrier
    s_add_u32 s81, s59, 0
    s_min_u32 s81, s81, 38
    s_mul_i32 s74, s81, 21846
    s_lshr_b32 s74, s74, 16
    s_mul_i32 s75, s74, 3
    s_sub_u32 s75, s81, s75
    s_mul_i32 s75, s75, 40960
    s_lshl_b32 s74, s74, 12
    s_add_u32 s74, s74, s75
    s_lshl_b32 s76, s81, 12
    s_cmp_lt_u32 s81, 30
    s_cselect_b32 s74, s74, s76
    s_add_u32 s74, s74, s67
    s_mov_b32 m0, s76
    s_nop 0
    buffer_load_dwordx4 v224, s[4:7], s74 offen offset:0 sc1 lds
    buffer_load_dwordx4 v224, s[4:7], s74 offen offset:1024 sc1 lds
    buffer_load_dwordx4 v224, s[4:7], s74 offen offset:2048 sc1 lds
    buffer_load_dwordx4 v224, s[4:7], s74 offen offset:3072 sc1 lds
    s_add_u32 s81, s59, 4
    s_min_u32 s81, s81, 38
    s_mul_i32 s74, s81, 21846
    s_lshr_b32 s74, s74, 16
    s_mul_i32 s75, s74, 3
    s_sub_u32 s75, s81, s75
    s_mul_i32 s75, s75, 40960
    s_lshl_b32 s74, s74, 12
    s_add_u32 s74, s74, s75
    s_lshl_b32 s76, s81, 12
    s_cmp_lt_u32 s81, 30
    s_cselect_b32 s74, s74, s76
    s_add_u32 s74, s74, s67
    s_mov_b32 m0, s76
    s_nop 0
    buffer_load_dwordx4 v224, s[4:7], s74 offen offset:0 sc1 lds
    buffer_load_dwordx4 v224, s[4:7], s74 offen offset:1024 sc1 lds
    buffer_load_dwordx4 v224, s[4:7], s74 offen offset:2048 sc1 lds
    buffer_load_dwordx4 v224, s[4:7], s74 offen offset:3072 sc1 lds
    s_add_u32 s81, s59, 8
    s_min_u32 s81, s81, 38
    s_mul_i32 s74, s81, 21846
    s_lshr_b32 s74, s74, 16
    s_mul_i32 s75, s74, 3
    s_sub_u32 s75, s81, s75
    s_mul_i32 s75, s75, 40960
    s_lshl_b32 s74, s74, 12
    s_add_u32 s74, s74, s75
    s_lshl_b32 s76, s81, 12
    s_cmp_lt_u32 s81, 30
    s_cselect_b32 s74, s74, s76
    s_add_u32 s74, s74, s67
    s_mov_b32 m0, s76
    s_nop 0
    buffer_load_dwordx4 v224, s[4:7], s74 offen offset:0 sc1 lds
    buffer_load_dwordx4 v224, s[4:7], s74 offen offset:1024 sc1 lds
    buffer_load_dwordx4 v224, s[4:7], s74 offen offset:2048 sc1 lds
    buffer_load_dwordx4 v224, s[4:7], s74 offen offset:3072 sc1 lds
    s_add_u32 s81, s59, 12
    s_min_u32 s81, s81, 38
    s_mul_i32 s74, s81, 21846
    s_lshr_b32 s74, s74, 16
    s_mul_i32 s75, s74, 3
    s_sub_u32 s75, s81, s75
    s_mul_i32 s75, s75, 40960
    s_lshl_b32 s74, s74, 12
    s_add_u32 s74, s74, s75
    s_lshl_b32 s76, s81, 12
    s_cmp_lt_u32 s81, 30
    s_cselect_b32 s74, s74, s76
    s_add_u32 s74, s74, s67
    s_mov_b32 m0, s76
    s_nop 0
    buffer_load_dwordx4 v224, s[4:7], s74 offen offset:0 sc1 lds
    buffer_load_dwordx4 v224, s[4:7], s74 offen offset:1024 sc1 lds
    buffer_load_dwordx4 v224, s[4:7], s74 offen offset:2048 sc1 lds
    buffer_load_dwordx4 v224, s[4:7], s74 offen offset:3072 sc1 lds
    s_add_u32 s81, s59, 16
    s_min_u32 s81, s81, 38
    s_mul_i32 s74, s81, 21846
    s_lshr_b32 s74, s74, 16
    s_mul_i32 s75, s74, 3
    s_sub_u32 s75, s81, s75
    s_mul_i32 s75, s75, 40960
    s_lshl_b32 s74, s74, 12
    s_add_u32 s74, s74, s75
    s_lshl_b32 s76, s81, 12
    s_cmp_lt_u32 s81, 30
    s_cselect_b32 s74, s74, s76
    s_add_u32 s74, s74, s67
    s_mov_b32 m0, s76
    s_nop 0
    buffer_load_dwordx4 v224, s[4:7], s74 offen offset:0 sc1 lds
    buffer_load_dwordx4 v224, s[4:7], s74 offen offset:1024 sc1 lds
    buffer_load_dwordx4 v224, s[4:7], s74 offen offset:2048 sc1 lds
    buffer_load_dwordx4 v224, s[4:7], s74 offen offset:3072 sc1 lds
    s_add_u32 s81, s59, 20
    s_min_u32 s81, s81, 38
    s_mul_i32 s74, s81, 21846
    s_lshr_b32 s74, s74, 16
    s_mul_i32 s75, s74, 3
    s_sub_u32 s75, s81, s75
    s_mul_i32 s75, s75, 40960
    s_lshl_b32 s74, s74, 12
    s_add_u32 s74, s74, s75
    s_lshl_b32 s76, s81, 12
    s_cmp_lt_u32 s81, 30
    s_cselect_b32 s74, s74, s76
    s_add_u32 s74, s74, s67
    s_mov_b32 m0, s76
    s_nop 0
    buffer_load_dwordx4 v224, s[4:7], s74 offen offset:0 sc1 lds
    buffer_load_dwordx4 v224, s[4:7], s74 offen offset:1024 sc1 lds
    buffer_load_dwordx4 v224, s[4:7], s74 offen offset:2048 sc1 lds
    buffer_load_dwordx4 v224, s[4:7], s74 offen offset:3072 sc1 lds
    s_add_u32 s81, s59, 24
    s_min_u32 s81, s81, 38
    s_mul_i32 s74, s81, 21846
    s_lshr_b32 s74, s74, 16
    s_mul_i32 s75, s74, 3
    s_sub_u32 s75, s81, s75
    s_mul_i32 s75, s75, 40960
    s_lshl_b32 s74, s74, 12
    s_add_u32 s74, s74, s75
    s_lshl_b32 s76, s81, 12
    s_cmp_lt_u32 s81, 30
    s_cselect_b32 s74, s74, s76
    s_add_u32 s74, s74, s67
    s_mov_b32 m0, s76
    s_nop 0
    buffer_load_dwordx4 v224, s[4:7], s74 offen offset:0 sc1 lds
    buffer_load_dwordx4 v224, s[4:7], s74 offen offset:1024 sc1 lds
    buffer_load_dwordx4 v224, s[4:7], s74 offen offset:2048 sc1 lds
    buffer_load_dwordx4 v224, s[4:7], s74 offen offset:3072 sc1 lds
    s_add_u32 s81, s59, 28
    s_min_u32 s81, s81, 38
    s_mul_i32 s74, s81, 21846
    s_lshr_b32 s74, s74, 16
    s_mul_i32 s75, s74, 3
    s_sub_u32 s75, s81, s75
    s_mul_i32 s75, s75, 40960
    s_lshl_b32 s74, s74, 12
    s_add_u32 s74, s74, s75
    s_lshl_b32 s76, s81, 12
    s_cmp_lt_u32 s81, 30
    s_cselect_b32 s74, s74, s76
    s_add_u32 s74, s74, s67
    s_mov_b32 m0, s76
    s_nop 0
    buffer_load_dwordx4 v224, s[4:7], s74 offen offset:0 sc1 lds
    buffer_load_dwordx4 v224, s[4:7], s74 offen offset:1024 sc1 lds
    buffer_load_dwordx4 v224, s[4:7], s74 offen offset:2048 sc1 lds
    buffer_load_dwordx4 v224, s[4:7], s74 offen offset:3072 sc1 lds
    s_add_u32 s81, s59, 32
    s_min_u32 s81, s81, 38
    s_mul_i32 s74, s81, 21846
    s_lshr_b32 s74, s74, 16
    s_mul_i32 s75, s74, 3
    s_sub_u32 s75, s81, s75
    s_mul_i32 s75, s75, 40960
    s_lshl_b32 s74, s74, 12
    s_add_u32 s74, s74, s75
    s_lshl_b32 s76, s81, 12
    s_cmp_lt_u32 s81, 30
    s_cselect_b32 s74, s74, s76
    s_add_u32 s74, s74, s67
    s_mov_b32 m0, s76
    s_nop 0
    buffer_load_dwordx4 v224, s[4:7], s74 offen offset:0 sc1 lds
    buffer_load_dwordx4 v224, s[4:7], s74 offen offset:1024 sc1 lds
    buffer_load_dwordx4 v224, s[4:7], s74 offen offset:2048 sc1 lds
    buffer_load_dwordx4 v224, s[4:7], s74 offen offset:3072 sc1 lds
    s_add_u32 s81, s59, 36
    s_min_u32 s81, s81, 38
    s_mul_i32 s74, s81, 21846
    s_lshr_b32 s74, s74, 16
    s_mul_i32 s75, s74, 3
    s_sub_u32 s75, s81, s75
    s_mul_i32 s75, s75, 40960
    s_lshl_b32 s74, s74, 12
    s_add_u32 s74, s74, s75
    s_lshl_b32 s76, s81, 12
    s_cmp_lt_u32 s81, 30
    s_cselect_b32 s74, s74, s76
    s_add_u32 s74, s74, s67
    s_mov_b32 m0, s76
    s_nop 0
    buffer_load_dwordx4 v224, s[4:7], s74 offen offset:0 sc1 lds
    buffer_load_dwordx4 v224, s[4:7], s74 offen offset:1024 sc1 lds
    buffer_load_dwordx4 v224, s[4:7], s74 offen offset:2048 sc1 lds
    buffer_load_dwordx4 v224, s[4:7], s74 offen offset:3072 sc1 lds
    v_lshrrev_b32 v240, 4, v224
    v_bfe_u32 v241, v240, 3, 1
    s_lshl_b32 s74, s59, 1
    v_add_u32 v241, s74, v241
    v_min_u32 v241, 6, v241
    v_and_b32 v242, 7, v240
    v_lshlrev_b32 v242, 4, v242
    v_lshl_add_u32 v243, v241, 7, v242
    v_lshrrev_b32 v240, 4, v240
    v_mul_u32_u24 v240, 69120, v240
    v_add_u32 v240, v240, v243
    s_lshl_b32 s74, s66, 7
    s_add_u32 s74, s74, 23461888
    buffer_load_dwordx4 a[232:235], v240, s[4:7], s74 offen sc1
    s_add_u32 s74, s74, 13824
    buffer_load_dwordx4 a[236:239], v240, s[4:7], s74 offen sc1
    s_add_u32 s74, s74, 13824
    buffer_load_dwordx4 a[240:243], v240, s[4:7], s74 offen sc1
    s_add_u32 s74, s74, 13824
    buffer_load_dwordx4 a[244:247], v240, s[4:7], s74 offen sc1
    s_add_u32 s74, s74, 13824
    buffer_load_dwordx4 a[248:251], v240, s[4:7], s74 offen sc1
    v_bfe_u32 v243, v242, 6, 1
    v_lshlrev_b32 v243, 4, v243
    v_lshl_add_u32 v243, v241, 7, v243
    v_bfe_u32 v242, v242, 4, 2
    v_lshl_add_u32 v243, v242, 2, v243
    v_add_u32 v243, 159744, v243
    v_lshrrev_b32 v250, 4, v224
    v_bfe_u32 v251, v250, 2, 1
    v_bfe_u32 v252, v250, 4, 1
    v_lshl_add_u32 v251, v252, 1, v251
    v_bfe_u32 v252, v250, 1, 1
    v_lshrrev_b32 v253, 5, v250
    v_xor_b32 v253, v253, v252
    v_lshl_add_u32 v251, v253, 2, v251
    v_lshl_add_u32 v251, v252, 4, v251
    v_and_b32 v252, 1, v250
    v_lshl_add_u32 v251, v252, 3, v251
    v_bfe_u32 v252, v250, 3, 1
    v_lshl_add_u32 v251, v252, 5, v251
    v_lshlrev_b32 v225, 4, v251
    v_add_u32 v226, 0x10000, v225
    v_add_u32 v227, 0x20000, v225
    v_and_b32 v251, 7, v250
    v_bfe_u32 v252, v250, 4, 1
    v_lshl_add_u32 v251, v251, 1, v252
    v_lshlrev_b32 v251, 4, v251
    v_bfe_u32 v252, v250, 3, 1
    v_mul_u32_u24 v252, 55296, v252
    v_add_u32 v251, v251, v252
    v_lshrrev_b32 v252, 5, v250
    v_lshl_add_u32 v228, v252, 8, v251
    v_lshlrev_b32 v248, 6, v252
    v_add_u32 v248, 159744, v248
    s_waitcnt vmcnt(0)
    v_accvgpr_read_b32 v64, a232
    v_accvgpr_read_b32 v65, a233
    v_accvgpr_read_b32 v66, a234
    v_accvgpr_read_b32 v67, a235
    v_accvgpr_read_b32 v68, a236
    v_accvgpr_read_b32 v69, a237
    v_accvgpr_read_b32 v70, a238
    v_accvgpr_read_b32 v71, a239
    v_accvgpr_read_b32 v72, a240
    v_accvgpr_read_b32 v73, a241
    v_accvgpr_read_b32 v74, a242
    v_accvgpr_read_b32 v75, a243
    v_accvgpr_read_b32 v76, a244
    v_accvgpr_read_b32 v77, a245
    v_accvgpr_read_b32 v78, a246
    v_accvgpr_read_b32 v79, a247
    v_accvgpr_read_b32 v80, a248
    v_accvgpr_read_b32 v81, a249
    v_accvgpr_read_b32 v82, a250
    v_accvgpr_read_b32 v83, a251
    v_add_f32 v64, v64, v68
    v_add_f32 v65, v65, v69
    v_add_f32 v66, v66, v70
    v_add_f32 v67, v67, v71
    v_add_f32 v64, v64, v72
    v_add_f32 v65, v65, v73
    v_add_f32 v66, v66, v74
    v_add_f32 v67, v67, v75
    v_add_f32 v64, v64, v76
    v_add_f32 v65, v65, v77
    v_add_f32 v66, v66, v78
    v_add_f32 v67, v67, v79
    v_add_f32 v64, v64, v80
    v_add_f32 v65, v65, v81
    v_add_f32 v66, v66, v82
    v_add_f32 v67, v67, v83
    v_mov_b32 v240, v64
    s_nop 1
    v_permlane16_swap_b32 v240, v64
    v_add_f32 v64, v64, v240
    v_mov_b32 v240, v65
    s_nop 1
    v_permlane16_swap_b32 v240, v65
    v_add_f32 v65, v65, v240
    v_mov_b32 v240, v66
    s_nop 1
    v_permlane16_swap_b32 v240, v66
    v_add_f32 v66, v66, v240
    v_mov_b32 v240, v67
    s_nop 1
    v_permlane16_swap_b32 v240, v67
    v_add_f32 v67, v67, v240
    v_mov_b32 v240, v64
    s_nop 1
    v_permlane32_swap_b32 v240, v64
    v_add_f32 v64, v64, v240
    v_mov_b32 v240, v65
    s_nop 1
    v_permlane32_swap_b32 v240, v65
    v_add_f32 v65, v65, v240
    v_mov_b32 v240, v66
    s_nop 1
    v_permlane32_swap_b32 v240, v66
    v_add_f32 v66, v66, v240
    v_mov_b32 v240, v67
    s_nop 1
    v_permlane32_swap_b32 v240, v67
    v_add_f32 v67, v67, v240
    ds_write_b32 v243, v64 offset:0
    ds_write_b32 v243, v65 offset:64
    ds_write_b32 v243, v66 offset:32
    ds_write_b32 v243, v67 offset:96
L_joinA:
    v_mbcnt_lo_u32_b32 v88, -1, 0
    v_mbcnt_hi_u32_b32 v88, -1, v88
    v_min_u32 v88, 31, v88
    v_lshlrev_b32 v88, 3, v88
    s_and_b32 s90, s2, 7
    s_lshl_b32 s90, s90, 8
    s_add_u32 s90, s90, 28672
    buffer_load_dwordx2 v[84:85], v88, s[4:7], s90 offen sc1
    s_waitcnt vmcnt(0)
    v_cmp_ne_u32 vcc, s3, v84
    s_cbranch_vccnz L_spin_26
L_back_27:
    v_cmp_ne_u32 vcc, s89, v85
    s_cmp_eq_u64 vcc, 0
    s_cselect_b32 s89, 1, 0
    v_lshrrev_b32 v88, 4, v224
    v_min_u32 v88, 39, v88
    v_lshlrev_b32 v88, 4, v88
    s_and_b32 s74, s2, 15
    s_lshl_b32 s74, s74, 10
    s_add_u32 s74, s74, 32768
    s_waitcnt vmcnt(0) lgkmcnt(0)
    s_cmp_lg_u32 s59, 1
    s_cbranch_scc1 L_pw_28
    buffer_load_dwordx4 v[84:87], v88, s[4:7], s74 offen sc1
    s_waitcnt vmcnt(0)
    v_xor_b32 v84, s3, v84
    v_xor_b32 v85, s3, v85
    v_xor_b32 v86, s3, v86
    v_xor_b32 v87, s3, v87
    v_or3_b32 v84, v84, v85, v86
    v_or_b32 v84, v84, v87
    v_cmp_ne_u32 vcc, 0, v84
    s_cbranch_vccnz L_spin_29
L_back_30:
L_pw_28:
    s_barrier
    s_cmp_lg_u32 s2, 0
    s_cbranch_scc1 L_ep_31
    s_mov_b32 s45, 0
    s_cmp_lg_u32 s59, 0
    s_cbranch_scc1 L_fs_32
    v_mov_b32 v4, 0
    v_mov_b32 v5, s3
    s_mov_b64 exec, 1
    buffer_store_dword v5, v4, s[4:7], s45 offen sc1
    s_mov_b64 exec, -1
L_fs_32:
L_ep_31:
    s_lshl_b32 s72, s64, 2
    s_add_u32 s72, s72, s59
    s_mul_i32 s72, s72, 40960
    s_add_u32 s72, s72, 8912896
    buffer_load_dwordx4 v[64:67], v224, s[4:7], s72 offen offset:0 sc1
    buffer_load_dwordx4 v[68:71], v224, s[4:7], s72 offen offset:1024 sc1
    buffer_load_dwordx4 v[72:75], v224, s[4:7], s72 offen offset:2048 sc1
    buffer_load_dwordx4 v[76:79], v224, s[4:7], s72 offen offset:3072 sc1
    v_lshrrev_b32 v250, 6, v224
    v_lshlrev_b32 v250, 8, v250
    v_and_b32 v251, 0x30, v224
    v_or_b32 v250, v250, v251
    v_mov_b32 v252, 2147483648
    v_cmp_le_u32 vcc, 0x200, v224
    s_nop 1
    v_cndmask_b32 v251, 0, v252, vcc
    v_or_b32 v251, v251, v250
    s_lshr_b32 s74, s65, 2
    s_lshl_b32 s75, s64, 2
    s_add_u32 s74, s74, s75
    s_mul_i32 s74, s74, 40960
    s_and_b32 s75, s65, 3
    s_lshl_b32 s75, s75, 6
    s_add_u32 s74, s74, s75
    s_mul_i32 s75, s59, 10240
    s_add_u32 s74, s74, s75
    s_add_u32 s74, s74, 8912896
    buffer_load_dwordx4 v[232:235], v250, s[4:7], s74 offen sc1
    s_add_u32 s74, s74, 4096
    buffer_load_dwordx4 v[236:239], v250, s[4:7], s74 offen sc1
    s_add_u32 s74, s74, 4096
    buffer_load_dwordx4 v[240:243], v251, s[4:7], s74 offen sc1
    s_add_u32 s72, s72, 4096
    buffer_load_dwordx4 v[80:83], v224, s[4:7], s72 offen offset:0 sc1
    buffer_load_dwordx4 v[84:87], v224, s[4:7], s72 offen offset:1024 sc1
    buffer_load_dwordx4 v[88:91], v224, s[4:7], s72 offen offset:2048 sc1
    buffer_load_dwordx4 v[92:95], v224, s[4:7], s72 offen offset:3072 sc1
    s_add_u32 s72, s72, 4096
    buffer_load_dwordx4 v[96:99], v224, s[4:7], s72 offen offset:0 sc1
    buffer_load_dwordx4 v[100:103], v224, s[4:7], s72 offen offset:1024 sc1
    buffer_load_dwordx4 v[104:107], v224, s[4:7], s72 offen offset:2048 sc1
    buffer_load_dwordx4 v[108:111], v224, s[4:7], s72 offen offset:3072 sc1
    s_add_u32 s72, s72, 4096
    buffer_load_dwordx4 v[112:115], v224, s[4:7], s72 offen offset:0 sc1
    buffer_load_dwordx4 v[116:119], v224, s[4:7], s72 offen offset:1024 sc1
    buffer_load_dwordx4 v[120:123], v224, s[4:7], s72 offen offset:2048 sc1
    buffer_load_dwordx4 v[124:127], v224, s[4:7], s72 offen offset:3072 sc1
    ds_read_b128 a[232:235], v225 offset:0
    ds_read_b128 a[236:239], v225 offset:4096
    ds_read_b128 a[240:243], v225 offset:8192
    ds_read_b128 a[244:247], v225 offset:1024
    s_lshl_b32 s75, s64, 2
    s_add_u32 s75, s75, s59
    s_mul_i32 s75, s75, 110592
    s_lshr_b32 s76, s65, 2
    s_mul_i32 s76, s76, 14336
    s_add_u32 s75, s75, s76
    s_add_u32 s77, s75, 23855104
    s_mov_b32 s82, s71
    s_add_u32 s83, s71, 159744
    s_add_u32 s83, s83, s67
    s_mul_i32 s79, s59, 14336
    s_mul_i32 s74, s69, 276480
    s_add_u32 s79, s79, s74
    s_add_u32 s84, s79, 21233664
    s_add_u32 s85, s84, 55296
    s_add_u32 s86, s85, 55296
    s_add_u32 s87, s86, 55296
    s_add_u32 s88, s87, 55296
    s_mov_b32 s78, 0xffff0000
    s_waitcnt vmcnt(18)
    v_permlane16_swap_b32 v64, v66
    v_permlane16_swap_b32 v65, v67
    s_waitcnt lgkmcnt(2)
    s_nop 0
    v_mfma_f32_32x32x16_bf16 v[0:15], a[232:235], v[64:67], 0
    ds_read_b128 a[248:251], v225 offset:5120
    s_add_u32 s72, s72, 4096
    buffer_load_dwordx4 v[128:131], v224, s[4:7], s72 offen offset:0 sc1
    v_mfma_f32_32x32x16_bf16 v[16:31], a[236:239], v[64:67], 0
    ds_read_b128 a[252:255], v225 offset:9216
    s_waitcnt vmcnt(18)
    v_permlane16_swap_b32 v68, v70
    v_permlane16_swap_b32 v69, v71
    s_waitcnt lgkmcnt(2)
    v_mfma_f32_32x32x16_bf16 v[32:47], a[240:243], v[64:67], 0
    ds_read_b128 a[232:235], v225 offset:2048
    v_mfma_f32_32x32x16_bf16 v[0:15], a[244:247], v[68:71], v[0:15]
    ds_read_b128 a[236:239], v225 offset:6144
    buffer_load_dwordx4 v[132:135], v224, s[4:7], s72 offen offset:1024 sc1
    s_waitcnt lgkmcnt(2)
    v_mfma_f32_32x32x16_bf16 v[16:31], a[248:251], v[68:71], v[16:31]
    ds_read_b128 a[240:243], v225 offset:10240
    s_waitcnt vmcnt(18)
    v_permlane16_swap_b32 v72, v74
    v_permlane16_swap_b32 v73, v75
    v_mfma_f32_32x32x16_bf16 v[32:47], a[252:255], v[68:71], v[32:47]
    ds_read_b128 a[244:247], v225 offset:3072
    s_waitcnt lgkmcnt(2)
    v_mfma_f32_32x32x16_bf16 v[0:15], a[232:235], v[72:75], v[0:15]
    ds_read_b128 a[248:251], v225 offset:7168
    buffer_load_dwordx4 v[136:139], v224, s[4:7], s72 offen offset:2048 sc1
    v_mfma_f32_32x32x16_bf16 v[16:31], a[236:239], v[72:75], v[16:31]
    ds_read_b128 a[252:255], v225 offset:11264
    s_waitcnt vmcnt(18)
    v_permlane16_swap_b32 v76, v78
    v_permlane16_swap_b32 v77, v79
    s_waitcnt lgkmcnt(2)
    v_mfma_f32_32x32x16_bf16 v[32:47], a[240:243], v[72:75], v[32:47]
    ds_read_b128 a[232:235], v225 offset:12288
    v_mfma_f32_32x32x16_bf16 v[0:15], a[244:247], v[76:79], v[0:15]
    ds_read_b128 a[236:239], v225 offset:16384
    buffer_load_dwordx4 v[140:143], v224, s[4:7], s72 offen offset:3072 sc1
    s_waitcnt vmcnt(16)
    v_lshlrev_b32 v250, 16, v232
    v_and_b32 v251, s78, v232
    s_waitcnt lgkmcnt(2)
    v_mfma_f32_32x32x16_bf16 v[16:31], a[248:251], v[76:79], v[16:31]
    ds_read_b128 a[240:243], v225 offset:20480
    s_waitcnt vmcnt(15)
    v_permlane16_swap_b32 v80, v82
    v_permlane16_swap_b32 v81, v83
    v_add_f32 v244, v250, v251
    v_mul_f32 v245, v250, v250
    v_mfma_f32_32x32x16_bf16 v[32:47], a[252:255], v[76:79], v[32:47]
    ds_read_b128 a[244:247], v225 offset:13312
    v_fmac_f32 v245, v251, v251
    v_lshlrev_b32 v250, 16, v233
    v_and_b32 v251, s78, v233
    v_add_f32 v244, v244, v250
    s_waitcnt lgkmcnt(2)
    v_mfma_f32_32x32x16_bf16 v[0:15], a[232:235], v[80:83], v[0:15]
    ds_read_b128 a[248:251], v225 offset:17408
    s_add_u32 s72, s72, 4096
    buffer_load_dwordx4 v[144:147], v224, s[4:7], s72 offen offset:0 sc1
    v_fmac_f32 v245, v250, v250
    v_add_f32 v244, v244, v251
    v_fmac_f32 v245, v251, v251
    v_lshlrev_b32 v250, 16, v234
    v_mfma_f32_32x32x16_bf16 v[16:31], a[236:239], v[80:83], v[16:31]
    ds_read_b128 a[252:255], v225 offset:21504
    s_waitcnt vmcnt(15)
    v_permlane16_swap_b32 v84, v86
    v_permlane16_swap_b32 v85, v87
    v_and_b32 v251, s78, v234
    s_waitcnt lgkmcnt(2)
    v_mfma_f32_32x32x16_bf16 v[32:47], a[240:243], v[80:83], v[32:47]
    ds_read_b128 a[232:235], v225 offset:14336
    v_add_f32 v246, v250, v251
    v_mul_f32 v247, v250, v250
    v_fmac_f32 v247, v251, v251
    v_lshlrev_b32 v250, 16, v235
    v_and_b32 v251, s78, v235
    v_mfma_f32_32x32x16_bf16 v[0:15], a[244:247], v[84:87], v[0:15]
    ds_read_b128 a[236:239], v225 offset:18432
    buffer_load_dwordx4 v[148:151], v224, s[4:7], s72 offen offset:1024 sc1
    v_add_f32 v246, v246, v250
    v_fmac_f32 v247, v250, v250
    v_add_f32 v246, v246, v251
    s_waitcnt lgkmcnt(2)
    v_mfma_f32_32x32x16_bf16 v[16:31], a[248:251], v[84:87], v[16:31]
    ds_read_b128 a[240:243], v225 offset:22528
    s_waitcnt vmcnt(15)
    v_permlane16_swap_b32 v88, v90
    v_permlane16_swap_b32 v89, v91
    v_fmac_f32 v247, v251, v251
    v_lshlrev_b32 v250, 16, v236
    v_mfma_f32_32x32x16_bf16 v[32:47], a[252:255], v[84:87], v[32:47]
    ds_read_b128 a[244:247], v225 offset:15360
    v_and_b32 v251, s78, v236
    v_add_f32 v244, v244, v250
    v_fmac_f32 v245, v250, v250
    v_add_f32 v244, v244, v251
    s_waitcnt lgkmcnt(2)
    v_mfma_f32_32x32x16_bf16 v[0:15], a[232:235], v[88:91], v[0:15]
    ds_read_b128 a[248:251], v225 offset:19456
    buffer_load_dwordx4 v[152:155], v224, s[4:7], s72 offen offset:2048 sc1
    v_fmac_f32 v245, v251, v251
    v_lshlrev_b32 v250, 16, v237
    v_and_b32 v251, s78, v237
    v_add_f32 v244, v244, v250
    v_mfma_f32_32x32x16_bf16 v[16:31], a[236:239], v[88:91], v[16:31]
    ds_read_b128 a[252:255], v225 offset:23552
    s_waitcnt vmcnt(15)
    v_permlane16_swap_b32 v92, v94
    v_permlane16_swap_b32 v93, v95
    v_fmac_f32 v245, v250, v250
    s_waitcnt lgkmcnt(2)
    v_mfma_f32_32x32x16_bf16 v[32:47], a[240:243], v[88:91], v[32:47]
    ds_read_b128 a[232:235], v225 offset:24576
    v_add_f32 v244, v244, v251
    v_fmac_f32 v245, v251, v251
    v_lshlrev_b32 v250, 16, v238
    v_and_b32 v251, s78, v238
    v_add_f32 v246, v246, v250
    v_mfma_f32_32x32x16_bf16 v[0:15], a[244:247], v[92:95], v[0:15]
    ds_read_b128 a[236:239], v225 offset:28672
    buffer_load_dwordx4 v[156:159], v224, s[4:7], s72 offen offset:3072 sc1
    v_fmac_f32 v247, v250, v250
    v_add_f32 v246, v246, v251
    v_fmac_f32 v247, v251, v251
    s_waitcnt lgkmcnt(2)
    v_mfma_f32_32x32x16_bf16 v[16:31], a[248:251], v[92:95], v[16:31]
    ds_read_b128 a[240:243], v225 offset:32768
    s_waitcnt vmcnt(15)
    v_permlane16_swap_b32 v96, v98
    v_permlane16_swap_b32 v97, v99
    v_lshlrev_b32 v250, 16, v239
    v_and_b32 v251, s78, v239
    v_mfma_f32_32x32x16_bf16 v[32:47], a[252:255], v[92:95], v[32:47]
    ds_read_b128 a[244:247], v225 offset:25600
    v_add_f32 v246, v246, v250
    v_fmac_f32 v247, v250, v250
    v_add_f32 v246, v246, v251
    v_fmac_f32 v247, v251, v251
    s_waitcnt lgkmcnt(2)
    v_mfma_f32_32x32x16_bf16 v[0:15], a[232:235], v[96:99], v[0:15]
    ds_read_b128 a[248:251], v225 offset:29696
    s_add_u32 s72, s72, 4096
    buffer_load_dwordx4 v[160:163], v224, s[4:7], s72 offen offset:0 sc1
    v_lshlrev_b32 v250, 16, v240
    v_and_b32 v251, s78, v240
    v_add_f32 v244, v244, v250
    v_fmac_f32 v245, v250, v250
    v_mfma_f32_32x32x16_bf16 v[16:31], a[236:239], v[96:99], v[16:31]
    ds_read_b128 a[252:255], v225 offset:33792
    s_waitcnt vmcnt(15)
    v_permlane16_swap_b32 v100, v102
    v_permlane16_swap_b32 v101, v103
    v_add_f32 v244, v244, v251
    s_waitcnt lgkmcnt(2)
    v_mfma_f32_32x32x16_bf16 v[32:47], a[240:243], v[96:99], v[32:47]
    ds_read_b128 a[232:235], v225 offset:26624
    v_fmac_f32 v245, v251, v251
    v_lshlrev_b32 v250, 16, v241
    v_and_b32 v251, s78, v241
    v_add_f32 v244, v244, v250
    v_fmac_f32 v245, v250, v250
    v_mfma_f32_32x32x16_bf16 v[0:15], a[244:247], v[100:103], v[0:15]
    ds_read_b128 a[236:239], v225 offset:30720
    buffer_load_dwordx4 v[164:167], v224, s[4:7], s72 offen offset:1024 sc1
    v_add_f32 v244, v244, v251
    v_fmac_f32 v245, v251, v251
    v_lshlrev_b32 v250, 16, v242
    s_waitcnt lgkmcnt(2)
    v_mfma_f32_32x32x16_bf16 v[16:31], a[248:251], v[100:103], v[16:31]
    ds_read_b128 a[240:243], v225 offset:34816
    s_waitcnt vmcnt(15)
    v_permlane16_swap_b32 v104, v106
    v_permlane16_swap_b32 v105, v107
    v_and_b32 v251, s78, v242
    v_add_f32 v246, v246, v250
    v_mfma_f32_32x32x16_bf16 v[32:47], a[252:255], v[100:103], v[32:47]
    ds_read_b128 a[244:247], v225 offset:27648
    v_fmac_f32 v247, v250, v250
    v_add_f32 v246, v246, v251
    v_fmac_f32 v247, v251, v251
    v_lshlrev_b32 v250, 16, v243
    s_waitcnt lgkmcnt(2)
    v_mfma_f32_32x32x16_bf16 v[0:15], a[232:235], v[104:107], v[0:15]
    ds_read_b128 a[248:251], v225 offset:31744
    buffer_load_dwordx4 v[168:171], v224, s[4:7], s72 offen offset:2048 sc1
    v_and_b32 v251, s78, v243
    v_add_f32 v246, v246, v250
    v_fmac_f32 v247, v250, v250
    v_add_f32 v246, v246, v251
    v_mfma_f32_32x32x16_bf16 v[16:31], a[236:239], v[104:107], v[16:31]
    ds_read_b128 a[252:255], v225 offset:35840
    s_waitcnt vmcnt(15)
    v_permlane16_swap_b32 v108, v110
    v_permlane16_swap_b32 v109, v111
    v_fmac_f32 v247, v251, v251
    s_waitcnt lgkmcnt(2)
    v_mfma_f32_32x32x16_bf16 v[32:47], a[240:243], v[104:107], v[32:47]
    ds_read_b128 a[232:235], v225 offset:36864
    v_add_f32_dpp v244, v244, v244 row_ror:4 row_mask:0xf bank_mask:0xf
    v_add_f32_dpp v245, v245, v245 row_ror:4 row_mask:0xf bank_mask:0xf
    v_add_f32_dpp v246, v246, v246 row_ror:4 row_mask:0xf bank_mask:0xf
    v_add_f32_dpp v247, v247, v247 row_ror:4 row_mask:0xf bank_mask:0xf
    v_add_f32_dpp v244, v244, v244 row_ror:8 row_mask:0xf bank_mask:0xf
    v_mfma_f32_32x32x16_bf16 v[0:15], a[244:247], v[108:111], v[0:15]
    ds_read_b128 a[236:239], v225 offset:40960
    buffer_load_dwordx4 v[172:175], v224, s[4:7], s72 offen offset:3072 sc1
    v_add_f32_dpp v245, v245, v245 row_ror:8 row_mask:0xf bank_mask:0xf
    v_add_f32_dpp v246, v246, v246 row_ror:8 row_mask:0xf bank_mask:0xf
    v_add_f32_dpp v247, v247, v247 row_ror:8 row_mask:0xf bank_mask:0xf
    s_waitcnt lgkmcnt(2)
    v_mfma_f32_32x32x16_bf16 v[16:31], a[248:251], v[108:111], v[16:31]
    ds_read_b128 a[240:243], v225 offset:45056
    s_waitcnt vmcnt(15)
    v_permlane16_swap_b32 v112, v114
    v_permlane16_swap_b32 v113, v115
    v_mov_b32 v250, v244
    v_mov_b32 v251, v245
    v_mfma_f32_32x32x16_bf16 v[32:47], a[252:255], v[108:111], v[32:47]
    ds_read_b128 a[244:247], v225 offset:37888
    v_mov_b32 v252, v246
    v_mov_b32 v253, v247
    v_permlane16_swap_b32 v250, v244
    v_permlane16_swap_b32 v251, v245
    s_waitcnt lgkmcnt(2)
    v_mfma_f32_32x32x16_bf16 v[0:15], a[232:235], v[112:115], v[0:15]
    ds_read_b128 a[248:251], v225 offset:41984
    s_add_u32 s72, s72, 4096
    buffer_load_dwordx4 v[176:179], v224, s[4:7], s72 offen offset:0 sc1
    v_permlane16_swap_b32 v252, v246
    v_permlane16_swap_b32 v253, v247
    v_add_f32 v244, v244, v250
    v_add_f32 v245, v245, v251
    v_mfma_f32_32x32x16_bf16 v[16:31], a[236:239], v[112:115], v[16:31]
    ds_read_b128 a[252:255], v225 offset:46080
    s_waitcnt vmcnt(15)
    v_permlane16_swap_b32 v116, v118
    v_permlane16_swap_b32 v117, v119
    v_add_f32 v246, v246, v252
    s_waitcnt lgkmcnt(2)
    v_mfma_f32_32x32x16_bf16 v[32:47], a[240:243], v[112:115], v[32:47]
    ds_read_b128 a[232:235], v225 offset:38912
    v_add_f32 v247, v247, v253
    v_mov_b32 v250, v244
    v_mov_b32 v251, v245
    v_mov_b32 v252, v246
    v_mov_b32 v253, v247
    v_mfma_f32_32x32x16_bf16 v[0:15], a[244:247], v[116:119], v[0:15]
    ds_read_b128 a[236:239], v225 offset:43008
    buffer_load_dwordx4 v[180:183], v224, s[4:7], s72 offen offset:1024 sc1
    v_permlane32_swap_b32 v250, v244
    v_permlane32_swap_b32 v251, v245
    v_permlane32_swap_b32 v252, v246
    s_waitcnt lgkmcnt(2)
    v_mfma_f32_32x32x16_bf16 v[16:31], a[248:251], v[116:119], v[16:31]
    ds_read_b128 a[240:243], v225 offset:47104
    s_waitcnt vmcnt(15)
    v_permlane16_swap_b32 v120, v122
    v_permlane16_swap_b32 v121, v123
    v_permlane32_swap_b32 v253, v247
    v_add_f32 v244, v244, v250
    v_mfma_f32_32x32x16_bf16 v[32:47], a[252:255], v[116:119], v[32:47]
    ds_read_b128 a[244:247], v225 offset:39936
    v_add_f32 v245, v245, v251
    v_add_f32 v246, v246, v252
    v_add_f32 v247, v247, v253
    v_and_b32 v254, 0x40, v224
    s_waitcnt lgkmcnt(2)
    v_mfma_f32_32x32x16_bf16 v[0:15], a[232:235], v[120:123], v[0:15]
    ds_read_b128 a[248:251], v225 offset:44032
    buffer_load_dwordx4 v[184:187], v224, s[4:7], s72 offen offset:2048 sc1
    v_cmp_ne_u32 vcc, 0, v254
    s_lshr_b32 s74, s65, 2
    s_lshl_b32 s74, s74, 9
    v_cndmask_b32 v250, v244, v246, vcc
    v_mfma_f32_32x32x16_bf16 v[16:31], a[236:239], v[120:123], v[16:31]
    ds_read_b128 a[252:255], v225 offset:48128
    s_waitcnt vmcnt(15)
    v_permlane16_swap_b32 v124, v126
    v_permlane16_swap_b32 v125, v127
    v_cndmask_b32 v252, v245, v247, vcc
    s_waitcnt lgkmcnt(2)
    v_mfma_f32_32x32x16_bf16 v[32:47], a[240:243], v[120:123], v[32:47]
    ds_read_b128 a[232:235], v225 offset:49152
    v_mov_b32 v251, s3
    v_mov_b32 v253, s3
    v_lshlrev_b32 v254, 2, v254
    v_and_b32 v244, 0x30, v224
    v_add_u32 v254, v254, v244
    v_mfma_f32_32x32x16_bf16 v[0:15], a[244:247], v[124:127], v[0:15]
    ds_read_b128 a[236:239], v225 offset:53248
    buffer_load_dwordx4 v[188:191], v224, s[4:7], s72 offen offset:3072 sc1
    s_and_b32 s75, s65, 3
    s_lshl_b32 s75, s75, 6
    s_add_u32 s74, s74, s75
    s_waitcnt lgkmcnt(2)
    v_mfma_f32_32x32x16_bf16 v[16:31], a[248:251], v[124:127], v[16:31]
    ds_read_b128 a[240:243], v225 offset:57344
    s_waitcnt vmcnt(15)
    v_permlane16_swap_b32 v128, v130
    v_permlane16_swap_b32 v129, v131
    s_lshl_b32 s75, s59, 11
    s_add_u32 s74, s74, s75
    v_mfma_f32_32x32x16_bf16 v[32:47], a[252:255], v[124:127], v[32:47]
    ds_read_b128 a[244:247], v225 offset:50176
    s_lshl_b32 s75, s64, 13
    s_add_u32 s74, s74, s75
    s_add_u32 s74, s74, 38010880
    s_mov_b64 exec, 0xff
    buffer_store_dwordx4 v[250:253], v254, s[4:7], s74 offen sc1
    s_mov_b64 exec, -1
    s_waitcnt lgkmcnt(2)
    v_mfma_f32_32x32x16_bf16 v[0:15], a[232:235], v[128:131], v[0:15]
    ds_read_b128 a[248:251], v225 offset:54272
    s_add_u32 s72, s72, 4096
    buffer_load_dwordx4 v[192:195], v224, s[4:7], s72 offen offset:0 sc1
    s_mul_i32 s79, s59, 14336
    s_add_u32 s79, s79, 23855104
    s_add_u32 s90, s59, 0
    s_and_b32 s90, s90, 3
    v_mfma_f32_32x32x16_bf16 v[16:31], a[236:239], v[128:131], v[16:31]
    ds_read_b128 a[252:255], v225 offset:58368
    s_waitcnt vmcnt(16)
    v_permlane16_swap_b32 v132, v134
    v_permlane16_swap_b32 v133, v135
    s_lshl_b32 s63, s68, 2
    s_waitcnt lgkmcnt(2)
    v_mfma_f32_32x32x16_bf16 v[32:47], a[240:243], v[128:131], v[32:47]
    ds_read_b128 a[232:235], v225 offset:51200
    s_add_u32 s90, s90, s63
    s_mul_i32 s90, s90, 55296
    s_add_u32 s90, s90, s79
    s_add_u32 s91, s59, 1
    s_and_b32 s91, s91, 3
    v_mfma_f32_32x32x16_bf16 v[0:15], a[244:247], v[132:135], v[0:15]
    ds_read_b128 a[236:239], v225 offset:55296
    buffer_load_dwordx4 v[196:199], v224, s[4:7], s72 offen offset:1024 sc1
    s_lshl_b32 s63, s68, 2
    s_add_u32 s91, s91, s63
    s_mul_i32 s91, s91, 55296
    s_waitcnt lgkmcnt(2)
    v_mfma_f32_32x32x16_bf16 v[16:31], a[248:251], v[132:135], v[16:31]
    ds_read_b128 a[240:243], v225 offset:59392
    s_waitcnt vmcnt(16)
    v_permlane16_swap_b32 v136, v138
    v_permlane16_swap_b32 v137, v139
    s_add_u32 s91, s91, s79
    s_add_u32 s92, s59, 2
    v_mfma_f32_32x32x16_bf16 v[32:47], a[252:255], v[132:135], v[32:47]
    ds_read_b128 a[244:247], v225 offset:52224
    s_and_b32 s92, s92, 3
    s_lshl_b32 s63, s68, 2
    s_add_u32 s92, s92, s63
    s_mul_i32 s92, s92, 55296
    s_waitcnt lgkmcnt(2)
    v_mfma_f32_32x32x16_bf16 v[0:15], a[232:235], v[136:139], v[0:15]
    ds_read_b128 a[248:251], v225 offset:56320
    buffer_load_dwordx4 v[200:203], v224, s[4:7], s72 offen offset:2048 sc1
    s_add_u32 s92, s92, s79
    s_add_u32 s93, s59, 3
    s_and_b32 s93, s93, 3
    s_lshl_b32 s63, s68, 2
    v_mfma_f32_32x32x16_bf16 v[16:31], a[236:239], v[136:139], v[16:31]
    ds_read_b128 a[252:255], v225 offset:60416
    s_waitcnt vmcnt(16)
    v_permlane16_swap_b32 v140, v142
    v_permlane16_swap_b32 v141, v143
    s_add_u32 s93, s93, s63
    s_waitcnt lgkmcnt(2)
    v_mfma_f32_32x32x16_bf16 v[32:47], a[240:243], v[136:139], v[32:47]
    ds_read_b128 a[232:235], v225 offset:61440
    s_mul_i32 s93, s93, 55296
    s_add_u32 s93, s93, s79
    s_lshr_b32 s81, s68, 1
    s_lshl_b32 s81, s81, 2
    s_add_u32 s81, s81, s59
    v_mfma_f32_32x32x16_bf16 v[0:15], a[244:247], v[140:143], v[0:15]
    ds_read_b128 a[236:239], v226 offset:0
    buffer_load_dwordx4 v[204:207], v224, s[4:7], s72 offen offset:3072 sc1
    s_lshl_b32 s81, s81, 7
    s_add_u32 s81, s81, 90112
    s_waitcnt lgkmcnt(2)
    v_mfma_f32_32x32x16_bf16 v[16:31], a[248:251], v[140:143], v[16:31]
    ds_read_b128 a[240:243], v226 offset:4096
    s_waitcnt vmcnt(16)
    v_permlane16_swap_b32 v144, v146
    v_permlane16_swap_b32 v145, v147
    v_mfma_f32_32x32x16_bf16 v[32:47], a[252:255], v[140:143], v[32:47]
    ds_read_b128 a[244:247], v225 offset:62464
    s_waitcnt lgkmcnt(2)
    v_mfma_f32_32x32x16_bf16 v[0:15], a[232:235], v[144:147], v[0:15]
    ds_read_b128 a[248:251], v226 offset:1024
    s_add_u32 s72, s72, 4096
    buffer_load_dwordx4 v[208:211], v224, s[4:7], s72 offen offset:0 sc1
    v_mfma_f32_32x32x16_bf16 v[16:31], a[236:239], v[144:147], v[16:31]
    ds_read_b128 a[252:255], v226 offset:5120
    s_waitcnt vmcnt(16)
    v_permlane16_swap_b32 v148, v150
    v_permlane16_swap_b32 v149, v151
    s_waitcnt lgkmcnt(2)
    v_mfma_f32_32x32x16_bf16 v[32:47], a[240:243], v[144:147], v[32:47]
    ds_read_b128 a[232:235], v225 offset:63488
    v_mfma_f32_32x32x16_bf16 v[0:15], a[244:247], v[148:151], v[0:15]
    ds_read_b128 a[236:239], v226 offset:2048
    buffer_load_dwordx4 v[212:215], v224, s[4:7], s72 offen offset:1024 sc1
    s_waitcnt lgkmcnt(2)
    v_mfma_f32_32x32x16_bf16 v[16:31], a[248:251], v[148:151], v[16:31]
    ds_read_b128 a[240:243], v226 offset:6144
    s_waitcnt vmcnt(16)
    v_permlane16_swap_b32 v152, v154
    v_permlane16_swap_b32 v153, v155
    v_mfma_f32_32x32x16_bf16 v[32:47], a[252:255], v[148:151], v[32:47]
    ds_read_b128 a[244:247], v225 offset:64512
    s_waitcnt lgkmcnt(2)
    v_mfma_f32_32x32x16_bf16 v[0:15], a[232:235], v[152:155], v[0:15]
    ds_read_b128 a[248:251], v226 offset:3072
    buffer_load_dwordx4 v[216:219], v224, s[4:7], s72 offen offset:2048 sc1
    v_mfma_f32_32x32x16_bf16 v[16:31], a[236:239], v[152:155], v[16:31]
    ds_read_b128 a[252:255], v226 offset:7168
    s_waitcnt vmcnt(16)
    v_permlane16_swap_b32 v156, v158
    v_permlane16_swap_b32 v157, v159
    s_waitcnt lgkmcnt(2)
    v_mfma_f32_32x32x16_bf16 v[32:47], a[240:243], v[152:155], v[32:47]
    ds_read_b128 a[232:235], v226 offset:8192
    v_mfma_f32_32x32x16_bf16 v[0:15], a[244:247], v[156:159], v[0:15]
    ds_read_b128 a[236:239], v226 offset:12288
    buffer_load_dwordx4 v[220:223], v224, s[4:7], s72 offen offset:3072 sc1
    s_waitcnt lgkmcnt(2)
    v_mfma_f32_32x32x16_bf16 v[16:31], a[248:251], v[156:159], v[16:31]
    ds_read_b128 a[240:243], v226 offset:16384
    s_waitcnt vmcnt(16)
    v_permlane16_swap_b32 v160, v162
    v_permlane16_swap_b32 v161, v163
    v_mfma_f32_32x32x16_bf16 v[32:47], a[252:255], v[156:159], v[32:47]
    ds_read_b128 a[244:247], v226 offset:9216
    s_waitcnt lgkmcnt(2)
    v_mfma_f32_32x32x16_bf16 v[0:15], a[232:235], v[160:163], v[0:15]
    ds_read_b128 a[248:251], v226 offset:13312
    v_mfma_f32_32x32x16_bf16 v[16:31], a[236:239], v[160:163], v[16:31]
    ds_read_b128 a[252:255], v226 offset:17408
    s_waitcnt vmcnt(15)
    v_permlane16_swap_b32 v164, v166
    v_permlane16_swap_b32 v165, v167
    s_waitcnt lgkmcnt(2)
    v_mfma_f32_32x32x16_bf16 v[32:47], a[240:243], v[160:163], v[32:47]
    ds_read_b128 a[232:235], v226 offset:10240
    v_mfma_f32_32x32x16_bf16 v[0:15], a[244:247], v[164:167], v[0:15]
    ds_read_b128 a[236:239], v226 offset:14336
    s_waitcnt lgkmcnt(2)
    v_mfma_f32_32x32x16_bf16 v[16:31], a[248:251], v[164:167], v[16:31]
    ds_read_b128 a[240:243], v226 offset:18432
    s_waitcnt vmcnt(14)
    v_permlane16_swap_b32 v168, v170
    v_permlane16_swap_b32 v169, v171
    v_mfma_f32_32x32x16_bf16 v[32:47], a[252:255], v[164:167], v[32:47]
    ds_read_b128 a[244:247], v226 offset:11264
    s_cmp_eq_u32 s70, 0
    s_cbranch_scc1 L_gd_33
    buffer_store_dwordx4 v[48:51], v249, s[4:7], s73 offen sc1
    s_add_u32 s73, s73, 163840
    buffer_store_dwordx4 v[52:55], v249, s[4:7], s73 offen sc1
    s_add_u32 s73, s73, 163840
    buffer_store_dwordx4 v[56:59], v249, s[4:7], s73 offen sc1
    s_add_u32 s73, s73, 163840
    buffer_store_dwordx4 v[60:63], v249, s[4:7], s73 offen sc1
L_gd_33:
    s_waitcnt lgkmcnt(2)
    v_mfma_f32_32x32x16_bf16 v[0:15], a[232:235], v[168:171], v[0:15]
    ds_read_b128 a[248:251], v226 offset:15360
    v_mfma_f32_32x32x16_bf16 v[16:31], a[236:239], v[168:171], v[16:31]
    ds_read_b128 a[252:255], v226 offset:19456
    s_waitcnt vmcnt(13)
    v_permlane16_swap_b32 v172, v174
    v_permlane16_swap_b32 v173, v175
    s_waitcnt lgkmcnt(2)
    v_mfma_f32_32x32x16_bf16 v[32:47], a[240:243], v[168:171], v[32:47]
    ds_read_b128 a[232:235], v226 offset:20480
    v_mfma_f32_32x32x16_bf16 v[0:15], a[244:247], v[172:175], v[0:15]
    ds_read_b128 a[236:239], v226 offset:24576
    v_lshrrev_b32 v249, 4, v224
    v_min_u32 v249, 23, v249
    v_lshlrev_b32 v249, 4, v249
    s_and_b32 s80, s2, 15
    s_lshl_b32 s80, s80, 9
    s_add_u32 s80, s80, 77824
    s_cmp_lg_u32 s59, 1
    s_cbranch_scc1 L_p1_34
    buffer_load_dwordx4 v[240:243], v249, s[4:7], s80 offen sc1
L_p1_34:
    s_waitcnt lgkmcnt(2)
    v_mfma_f32_32x32x16_bf16 v[16:31], a[248:251], v[172:175], v[16:31]
    ds_read_b128 a[240:243], v226 offset:28672
    s_waitcnt vmcnt(12)
    v_permlane16_swap_b32 v176, v178
    v_permlane16_swap_b32 v177, v179
    v_mfma_f32_32x32x16_bf16 v[32:47], a[252:255], v[172:175], v[32:47]
    ds_read_b128 a[244:247], v226 offset:21504
    s_waitcnt lgkmcnt(2)
    v_mfma_f32_32x32x16_bf16 v[0:15], a[232:235], v[176:179], v[0:15]
    ds_read_b128 a[248:251], v226 offset:25600
    v_and_b32 v254, 0x1f0, v224
    v_lshrrev_b32 v250, 9, v224
    v_lshl_add_u32 v254, v250, 12, v254
    s_lshl_b32 s74, s64, 13
    s_lshl_b32 s75, s59, 9
    v_mfma_f32_32x32x16_bf16 v[16:31], a[236:239], v[176:179], v[16:31]
    ds_read_b128 a[252:255], v226 offset:29696
    s_waitcnt vmcnt(11)
    v_permlane16_swap_b32 v180, v182
    v_permlane16_swap_b32 v181, v183
    s_add_u32 s74, s74, s75
    s_waitcnt lgkmcnt(2)
    v_mfma_f32_32x32x16_bf16 v[32:47], a[240:243], v[176:179], v[32:47]
    ds_read_b128 a[232:235], v226 offset:22528
    s_add_u32 s74, s74, 38010880
    buffer_load_dwordx4 v[232:235], v254, s[4:7], s74 offen sc1
    buffer_load_dwordx4 v[236:239], v254, s[4:7], s74 offen offset:2048 sc1
    v_mfma_f32_32x32x16_bf16 v[0:15], a[244:247], v[180:183], v[0:15]
    ds_read_b128 a[236:239], v226 offset:26624
    s_waitcnt lgkmcnt(2)
    v_mfma_f32_32x32x16_bf16 v[16:31], a[248:251], v[180:183], v[16:31]
    ds_read_b128 a[240:243], v226 offset:30720
    s_waitcnt vmcnt(12)
    v_permlane16_swap_b32 v184, v186
    v_permlane16_swap_b32 v185, v187
    v_mfma_f32_32x32x16_bf16 v[32:47], a[252:255], v[180:183], v[32:47]
    ds_read_b128 a[244:247], v226 offset:23552
    s_waitcnt lgkmcnt(2)
    v_mfma_f32_32x32x16_bf16 v[0:15], a[232:235], v[184:187], v[0:15]
    ds_read_b128 a[248:251], v226 offset:27648
    v_mfma_f32_32x32x16_bf16 v[16:31], a[236:239], v[184:187], v[16:31]
    ds_read_b128 a[252:255], v226 offset:31744
    s_waitcnt vmcnt(11)
    v_permlane16_swap_b32 v188, v190
    v_permlane16_swap_b32 v189, v191
    s_waitcnt lgkmcnt(2)
    v_mfma_f32_32x32x16_bf16 v[32:47], a[240:243], v[184:187], v[32:47]
    ds_read_b128 a[232:235], v226 offset:32768
    v_mfma_f32_32x32x16_bf16 v[0:15], a[244:247], v[188:191], v[0:15]
    ds_read_b128 a[236:239], v226 offset:36864
    s_waitcnt lgkmcnt(2)
    v_mfma_f32_32x32x16_bf16 v[16:31], a[248:251], v[188:191], v[16:31]
    ds_read_b128 a[240:243], v226 offset:40960
    s_waitcnt vmcnt(9)
    v_permlane16_swap_b32 v192, v194
    v_permlane16_swap_b32 v193, v195
    v_mfma_f32_32x32x16_bf16 v[32:47], a[252:255], v[188:191], v[32:47]
    ds_read_b128 a[244:247], v226 offset:33792
    s_cmp_lg_u32 s59, 1
    s_cbranch_scc1 L_p1c_35
    s_waitcnt vmcnt(2)
    v_xor_b32 v240, s3, v240
    v_xor_b32 v241, s3, v241
    v_xor_b32 v242, s3, v242
    v_xor_b32 v243, s3, v243
    v_or3_b32 v240, v240, v241, v242
    v_or_b32 v240, v240, v243
    v_cmp_ne_u32 vcc, 0, v240
    s_cbranch_vccnz L_spin_36
L_back_37:
L_p1c_35:
    s_barrier
    s_waitcnt lgkmcnt(2)
    v_mfma_f32_32x32x16_bf16 v[0:15], a[232:235], v[192:195], v[0:15]
    ds_read_b128 a[248:251], v226 offset:37888
    s_mov_b32 m0, s82
    s_nop 0
    buffer_load_dwordx4 v224, s[4:7], s83 offen offset:0 sc1 lds
    v_mfma_f32_32x32x16_bf16 v[16:31], a[236:239], v[192:195], v[16:31]
    ds_read_b128 a[252:255], v226 offset:41984
    s_waitcnt vmcnt(9)
    v_permlane16_swap_b32 v196, v198
    v_permlane16_swap_b32 v197, v199
    s_waitcnt lgkmcnt(2)
    v_mfma_f32_32x32x16_bf16 v[32:47], a[240:243], v[192:195], v[32:47]
    ds_read_b128 a[232:235], v226 offset:34816
    buffer_load_dwordx4 v224, s[4:7], s83 offen offset:1024 sc1 lds
    v_mfma_f32_32x32x16_bf16 v[0:15], a[244:247], v[196:199], v[0:15]
    ds_read_b128 a[236:239], v226 offset:38912
    v_mov_b32 v249, 2147483648
    s_cmp_eq_u32 s59, 3
    s_cselect_b32 s62, -1, 0
    v_and_b32 v249, s62, v249
    v_or_b32 v249, v249, v224
    s_waitcnt lgkmcnt(2)
    v_mfma_f32_32x32x16_bf16 v[16:31], a[248:251], v[196:199], v[16:31]
    ds_read_b128 a[240:243], v226 offset:43008
    s_waitcnt vmcnt(9)
    v_permlane16_swap_b32 v200, v202
    v_permlane16_swap_b32 v201, v203
    buffer_load_dwordx4 v224, s[4:7], s83 offen offset:2048 sc1 lds
    v_mfma_f32_32x32x16_bf16 v[32:47], a[252:255], v[196:199], v[32:47]
    ds_read_b128 a[244:247], v226 offset:35840
    s_waitcnt lgkmcnt(2)
    v_mfma_f32_32x32x16_bf16 v[0:15], a[232:235], v[200:203], v[0:15]
    ds_read_b128 a[248:251], v226 offset:39936
    buffer_load_dwordx4 v224, s[4:7], s83 offen offset:3072 sc1 lds
    s_add_u32 s82, s82, 16384
    s_add_u32 s83, s83, 16384
    v_mfma_f32_32x32x16_bf16 v[16:31], a[236:239], v[200:203], v[16:31]
    ds_read_b128 a[252:255], v226 offset:44032
    s_waitcnt vmcnt(10)
    v_permlane16_swap_b32 v204, v206
    v_permlane16_swap_b32 v205, v207
    s_waitcnt lgkmcnt(2)
    v_mfma_f32_32x32x16_bf16 v[32:47], a[240:243], v[200:203], v[32:47]
    ds_read_b128 a[232:235], v226 offset:45056
    s_mov_b32 m0, s82
    s_nop 0
    buffer_load_dwordx4 v224, s[4:7], s83 offen offset:0 sc1 lds
    v_mfma_f32_32x32x16_bf16 v[0:15], a[244:247], v[204:207], v[0:15]
    ds_read_b128 a[236:239], v226 offset:49152
    s_waitcnt lgkmcnt(2)
    v_mfma_f32_32x32x16_bf16 v[16:31], a[248:251], v[204:207], v[16:31]
    ds_read_b128 a[240:243], v226 offset:53248
    s_waitcnt vmcnt(10)
    v_permlane16_swap_b32 v208, v210
    v_permlane16_swap_b32 v209, v211
    buffer_load_dwordx4 v224, s[4:7], s83 offen offset:1024 sc1 lds
    v_mfma_f32_32x32x16_bf16 v[32:47], a[252:255], v[204:207], v[32:47]
    ds_read_b128 a[244:247], v226 offset:46080
    s_waitcnt lgkmcnt(2)
    v_mfma_f32_32x32x16_bf16 v[0:15], a[232:235], v[208:211], v[0:15]
    ds_read_b128 a[248:251], v226 offset:50176
    buffer_load_dwordx4 v224, s[4:7], s83 offen offset:2048 sc1 lds
    v_mfma_f32_32x32x16_bf16 v[16:31], a[236:239], v[208:211], v[16:31]
    ds_read_b128 a[252:255], v226 offset:54272
    s_waitcnt vmcnt(11)
    v_permlane16_swap_b32 v212, v214
    v_permlane16_swap_b32 v213, v215
    s_waitcnt lgkmcnt(2)
    v_mfma_f32_32x32x16_bf16 v[32:47], a[240:243], v[208:211], v[32:47]
    ds_read_b128 a[232:235], v226 offset:47104
    buffer_load_dwordx4 v224, s[4:7], s83 offen offset:3072 sc1 lds
    s_add_u32 s82, s82, 16384
    s_add_u32 s83, s83, 16384
    v_mfma_f32_32x32x16_bf16 v[0:15], a[244:247], v[212:215], v[0:15]
    ds_read_b128 a[236:239], v226 offset:51200
    s_waitcnt lgkmcnt(2)
    v_mfma_f32_32x32x16_bf16 v[16:31], a[248:251], v[212:215], v[16:31]
    ds_read_b128 a[240:243], v226 offset:55296
    s_waitcnt vmcnt(11)
    v_permlane16_swap_b32 v216, v218
    v_permlane16_swap_b32 v217, v219
    s_mov_b32 m0, s82
    s_nop 0
    buffer_load_dwordx4 v224, s[4:7], s83 offen offset:0 sc1 lds
    v_mfma_f32_32x32x16_bf16 v[32:47], a[252:255], v[212:215], v[32:47]
    ds_read_b128 a[244:247], v226 offset:48128
    s_waitcnt vmcnt(9)
    v_xor_b32 v250, s3, v233
    v_xor_b32 v251, s3, v235
    v_xor_b32 v252, s3, v237
    v_xor_b32 v253, s3, v239
    v_or3_b32 v250, v250, v251, v252
    v_or_b32 v250, v250, v253
    v_cmp_ne_u32 vcc, 0, v250
    s_cbranch_vccnz L_spin_38
L_back_39:
    v_add_f32 v232, v232, v236
    v_add_f32 v234, v234, v238
    s_mov_b32 s74, 0x3acccccd
    s_waitcnt lgkmcnt(2)
    v_mfma_f32_32x32x16_bf16 v[0:15], a[232:235], v[216:219], v[0:15]
    ds_read_b128 a[248:251], v226 offset:52224
    buffer_load_dwordx4 v224, s[4:7], s83 offen offset:1024 sc1 lds
    s_mov_b32 s75, 0x3727c5ac
    v_mov_b32 v250, v232
    v_mov_b32 v251, v234
    s_mov_b32 s76, 0xbfb8aa3b
    v_mfma_f32_32x32x16_bf16 v[16:31], a[236:239], v[216:219], v[16:31]
    ds_read_b128 a[252:255], v226 offset:56320
    v_permlane16_swap_b32 v220, v222
    v_permlane16_swap_b32 v221, v223
    s_nop 0
    s_waitcnt lgkmcnt(2)
    v_mfma_f32_32x32x16_bf16 v[32:47], a[240:243], v[216:219], v[32:47]
    ds_read_b128 a[232:235], v226 offset:57344
    buffer_load_dwordx4 v224, s[4:7], s83 offen offset:2048 sc1 lds
    v_permlane32_swap_b32 v250, v232
    v_permlane32_swap_b32 v251, v234
    v_add_f32 v232, v232, v250
    v_add_f32 v234, v234, v251
    v_mfma_f32_32x32x16_bf16 v[0:15], a[244:247], v[220:223], v[0:15]
    ds_read_b128 a[236:239], v226 offset:58368
    v_mul_f32 v229, s74, v232
    v_mul_f32 v231, s74, v234
    v_fma_f32 v231, -v229, v229, v231
    v_max_f32 v231, 0, v231
    s_waitcnt lgkmcnt(2)
    v_mfma_f32_32x32x16_bf16 v[16:31], a[248:251], v[220:223], v[16:31]
    ds_read_b128 a[240:243], v226 offset:59392
    buffer_load_dwordx4 v224, s[4:7], s83 offen offset:3072 sc1 lds
    s_add_u32 s82, s82, 16384
    s_add_u32 s83, s83, 16384
    v_add_f32 v231, s75, v231
    v_rsq_f32 v230, v231
    v_mfma_f32_32x32x16_bf16 v[32:47], a[252:255], v[220:223], v[32:47]
    ds_read_b128 a[244:247], v226 offset:60416
    v_sub_f32 v229, 0, v229
    v_mul_f32 v230, s76, v230
    s_waitcnt lgkmcnt(2)
    v_mfma_f32_32x32x16_bf16 v[48:63], a[232:235], v[64:67], 0
    ds_read_b128 a[248:251], v226 offset:61440
    s_mov_b32 m0, s82
    s_nop 0
    buffer_load_dwordx4 v224, s[4:7], s83 offen offset:0 sc1 lds
    ds_read_b128 v[232:235], v248 offset:0
    ds_read_b128 v[236:239], v248 offset:16
    v_mfma_f32_32x32x16_bf16 v[48:63], a[236:239], v[68:71], v[48:63]
    ds_read_b128 a[252:255], v226 offset:62464
    ds_read_b128 v[240:243], v248 offset:32
    ds_read_b128 v[244:247], v248 offset:48
    s_waitcnt lgkmcnt(3)
    v_fmac_f32 v0, v229, v232
    v_fmac_f32 v1, v229, v233
    v_mfma_f32_32x32x16_bf16 v[48:63], a[240:243], v[72:75], v[48:63]
    ds_read_b128 a[232:235], v226 offset:63488
    buffer_load_dwordx4 v224, s[4:7], s83 offen offset:1024 sc1 lds
    v_fmac_f32 v2, v229, v234
    v_fmac_f32 v3, v229, v235
    v_fmac_f32 v4, v229, v236
    v_mfma_f32_32x32x16_bf16 v[48:63], a[244:247], v[76:79], v[48:63]
    ds_read_b128 a[236:239], v226 offset:64512
    v_fmac_f32 v5, v229, v237
    v_fmac_f32 v6, v229, v238
    v_fmac_f32 v7, v229, v239
    s_waitcnt lgkmcnt(4)
    v_mfma_f32_32x32x16_bf16 v[48:63], a[248:251], v[80:83], v[48:63]
    ds_read_b128 a[240:243], v227 offset:0
    buffer_load_dwordx4 v224, s[4:7], s83 offen offset:2048 sc1 lds
    v_mul_f32 v232, v230, v0
    v_mul_f32 v233, v230, v1
    v_mul_f32 v234, v230, v2
    v_mfma_f32_32x32x16_bf16 v[48:63], a[252:255], v[84:87], v[48:63]
    ds_read_b128 a[244:247], v227 offset:1024
    v_mul_f32 v235, v230, v3
    v_exp_f32 v232, v232
    v_mul_f32 v0, v0, v4
    s_waitcnt lgkmcnt(2)
    v_mfma_f32_32x32x16_bf16 v[48:63], a[232:235], v[88:91], v[48:63]
    ds_read_b128 a[248:251], v227 offset:2048
    buffer_load_dwordx4 v224, s[4:7], s83 offen offset:3072 sc1 lds
    s_add_u32 s82, s82, 16384
    s_add_u32 s83, s83, 16384
    v_exp_f32 v233, v233
    v_mfma_f32_32x32x16_bf16 v[48:63], a[236:239], v[92:95], v[48:63]
    ds_read_b128 a[252:255], v227 offset:3072
    v_mul_f32 v1, v1, v5
    v_exp_f32 v234, v234
    v_mul_f32 v2, v2, v6
    s_waitcnt lgkmcnt(2)
    v_mfma_f32_32x32x16_bf16 v[48:63], a[240:243], v[96:99], v[48:63]
    ds_read_b128 a[232:235], v227 offset:4096
    s_mov_b32 m0, s82
    s_nop 0
    buffer_load_dwordx4 v224, s[4:7], s83 offen offset:0 sc1 lds
    v_exp_f32 v235, v235
    v_mul_f32 v3, v3, v7
    v_mfma_f32_32x32x16_bf16 v[48:63], a[244:247], v[100:103], v[48:63]
    ds_read_b128 a[236:239], v227 offset:5120
    v_fma_f32 v232, v232, v231, v231
    v_fma_f32 v233, v233, v231, v231
    v_fma_f32 v234, v234, v231, v231
    s_waitcnt lgkmcnt(2)
    v_mfma_f32_32x32x16_bf16 v[48:63], a[248:251], v[104:107], v[48:63]
    ds_read_b128 a[240:243], v227 offset:6144
    buffer_load_dwordx4 v224, s[4:7], s83 offen offset:1024 sc1 lds
    v_fma_f32 v235, v235, v231, v231
    v_rcp_f32 v232, v232
    v_mfma_f32_32x32x16_bf16 v[48:63], a[252:255], v[108:111], v[48:63]
    ds_read_b128 a[244:247], v227 offset:7168
    v_rcp_f32 v233, v233
    v_rcp_f32 v234, v234
    s_waitcnt lgkmcnt(2)
    v_mfma_f32_32x32x16_bf16 v[48:63], a[232:235], v[112:115], v[48:63]
    ds_read_b128 a[248:251], v227 offset:8192
    buffer_load_dwordx4 v224, s[4:7], s83 offen offset:2048 sc1 lds
    v_rcp_f32 v235, v235
    v_mul_f32 v0, v0, v232
    v_mul_f32 v1, v1, v233
    v_mfma_f32_32x32x16_bf16 v[48:63], a[236:239], v[116:119], v[48:63]
    ds_read_b128 a[252:255], v227 offset:9216
    v_mul_f32 v2, v2, v234
    v_mul_f32 v3, v3, v235
    v_cvt_pk_bf16_f32 v4, v0, v1
    s_waitcnt lgkmcnt(2)
    v_mfma_f32_32x32x16_bf16 v[48:63], a[240:243], v[120:123], v[48:63]
    ds_read_b128 a[232:235], v227 offset:10240
    buffer_load_dwordx4 v224, s[4:7], s83 offen offset:3072 sc1 lds
    s_add_u32 s82, s82, 16384
    s_add_u32 s83, s83, 16384
    v_cvt_pk_bf16_f32 v5, v2, v3
    v_fmac_f32 v8, v229, v240
    v_mfma_f32_32x32x16_bf16 v[48:63], a[244:247], v[124:127], v[48:63]
    ds_read_b128 a[236:239], v227 offset:11264
    v_fmac_f32 v9, v229, v241
    v_fmac_f32 v10, v229, v242
    v_fmac_f32 v11, v229, v243
    s_waitcnt lgkmcnt(2)
    v_mfma_f32_32x32x16_bf16 v[48:63], a[248:251], v[128:131], v[48:63]
    ds_read_b128 a[240:243], v227 offset:12288
    s_mov_b32 m0, s82
    s_nop 0
    buffer_load_dwordx4 v224, s[4:7], s83 offen offset:0 sc1 lds
    v_fmac_f32 v12, v229, v244
    v_fmac_f32 v13, v229, v245
    v_fmac_f32 v14, v229, v246
    v_mfma_f32_32x32x16_bf16 v[48:63], a[252:255], v[132:135], v[48:63]
    ds_read_b128 a[244:247], v227 offset:13312
    v_fmac_f32 v15, v229, v247
    v_mul_f32 v240, v230, v8
    v_mul_f32 v241, v230, v9
    s_waitcnt lgkmcnt(2)
    v_mfma_f32_32x32x16_bf16 v[48:63], a[232:235], v[136:139], v[48:63]
    ds_read_b128 a[248:251], v227 offset:14336
    buffer_load_dwordx4 v224, s[4:7], s83 offen offset:1024 sc1 lds
    v_mul_f32 v242, v230, v10
    v_mul_f32 v243, v230, v11
    v_exp_f32 v240, v240
    v_mfma_f32_32x32x16_bf16 v[48:63], a[236:239], v[140:143], v[48:63]
    ds_read_b128 a[252:255], v227 offset:15360
    v_mul_f32 v8, v8, v12
    v_exp_f32 v241, v241
    v_mul_f32 v9, v9, v13
    s_waitcnt lgkmcnt(2)
    v_mfma_f32_32x32x16_bf16 v[48:63], a[240:243], v[144:147], v[48:63]
    ds_read_b128 a[232:235], v227 offset:16384
    buffer_load_dwordx4 v224, s[4:7], s83 offen offset:2048 sc1 lds
    v_exp_f32 v242, v242
    v_mul_f32 v10, v10, v14
    v_mfma_f32_32x32x16_bf16 v[48:63], a[244:247], v[148:151], v[48:63]
    ds_read_b128 a[236:239], v227 offset:17408
    v_exp_f32 v243, v243
    v_mul_f32 v11, v11, v15
    v_fma_f32 v240, v240, v231, v231
    s_waitcnt lgkmcnt(2)
    v_mfma_f32_32x32x16_bf16 v[48:63], a[248:251], v[152:155], v[48:63]
    ds_read_b128 a[240:243], v227 offset:18432
    buffer_load_dwordx4 v224, s[4:7], s83 offen offset:3072 sc1 lds
    s_add_u32 s82, s82, 16384
    s_add_u32 s83, s83, 16384
    v_fma_f32 v241, v241, v231, v231
    v_fma_f32 v242, v242, v231, v231
    v_mfma_f32_32x32x16_bf16 v[48:63], a[252:255], v[156:159], v[48:63]
    ds_read_b128 a[244:247], v227 offset:19456
    v_fma_f32 v243, v243, v231, v231
    v_rcp_f32 v240, v240
    s_waitcnt lgkmcnt(2)
    v_mfma_f32_32x32x16_bf16 v[48:63], a[232:235], v[160:163], v[48:63]
    ds_read_b128 a[248:251], v227 offset:20480
    s_add_u32 s98, s84, 12288
    buffer_load_dwordx4 a[192:195], v249, s[4:7], s98 offen offset:0 sc1
    v_rcp_f32 v241, v241
    v_mfma_f32_32x32x16_bf16 v[48:63], a[236:239], v[164:167], v[48:63]
    ds_read_b128 a[252:255], v227 offset:21504
    v_rcp_f32 v242, v242
    v_rcp_f32 v243, v243
    s_waitcnt lgkmcnt(2)
    v_mfma_f32_32x32x16_bf16 v[48:63], a[240:243], v[168:171], v[48:63]
    ds_read_b128 a[232:235], v227 offset:22528
    s_add_u32 s98, s85, 12288
    buffer_load_dwordx4 a[196:199], v249, s[4:7], s98 offen offset:0 sc1
    v_mul_f32 v8, v8, v240
    v_mul_f32 v9, v9, v241
    v_mul_f32 v10, v10, v242
    v_mfma_f32_32x32x16_bf16 v[48:63], a[244:247], v[172:175], v[48:63]
    ds_read_b128 a[236:239], v227 offset:23552
    v_mul_f32 v11, v11, v243
    v_cvt_pk_bf16_f32 v6, v8, v9
    v_cvt_pk_bf16_f32 v7, v10, v11
    s_waitcnt vmcnt(14)
    s_barrier
    s_cmp_eq_u32 s70, 0
    s_cbranch_scc1 L_gd_40
    s_lshl_b32 s74, s2, 2
    s_add_u32 s74, s74, 9216
    s_cmp_lg_u32 s59, 0
    s_cbranch_scc1 L_fs_41
    v_mov_b32 v250, 0
    v_mov_b32 v251, s3
    s_mov_b64 exec, 1
    buffer_store_dword v251, v250, s[4:7], s74 offen sc1
    s_mov_b64 exec, -1
L_fs_41:
L_gd_40:
    s_waitcnt lgkmcnt(2)
    v_mfma_f32_32x32x16_bf16 v[48:63], a[248:251], v[176:179], v[48:63]
    ds_read_b128 a[240:243], v227 offset:24576
    s_mov_b32 m0, s82
    s_nop 0
    buffer_load_dwordx4 v224, s[4:7], s83 offen offset:0 sc1 lds
    s_and_b32 s74, s65, 3
    s_lshl_b32 s74, s74, 10
    s_add_u32 s74, s74, s77
    buffer_store_dwordx4 v[4:7], v228, s[4:7], s74 offen offset:0 sc1
    v_mfma_f32_32x32x16_bf16 v[48:63], a[252:255], v[180:183], v[48:63]
    ds_read_b128 a[244:247], v227 offset:25600
    ds_read_b128 v[232:235], v248 offset:128
    ds_read_b128 v[236:239], v248 offset:144
    ds_read_b128 v[240:243], v248 offset:160
    ds_read_b128 v[244:247], v248 offset:176
    s_waitcnt lgkmcnt(2)
    v_mfma_f32_32x32x16_bf16 v[48:63], a[232:235], v[184:187], v[48:63]
    ds_read_b128 a[248:251], v227 offset:26624
    buffer_load_dwordx4 v224, s[4:7], s83 offen offset:1024 sc1 lds
    v_fmac_f32 v16, v229, v232
    v_fmac_f32 v17, v229, v233
    v_fmac_f32 v18, v229, v234
    v_mfma_f32_32x32x16_bf16 v[48:63], a[236:239], v[188:191], v[48:63]
    ds_read_b128 a[252:255], v227 offset:27648
    v_fmac_f32 v19, v229, v235
    v_fmac_f32 v20, v229, v236
    v_fmac_f32 v21, v229, v237
    v_mfma_f32_32x32x16_bf16 v[48:63], a[240:243], v[192:195], v[48:63]
    ds_read_b128 a[232:235], v225 offset:0
    buffer_load_dwordx4 v224, s[4:7], s83 offen offset:2048 sc1 lds
    v_fmac_f32 v22, v229, v238
    v_fmac_f32 v23, v229, v239
    v_mul_f32 v232, v230, v16
    v_mfma_f32_32x32x16_bf16 v[48:63], a[244:247], v[196:199], v[48:63]
    ds_read_b128 a[236:239], v225 offset:1024
    v_mul_f32 v233, v230, v17
    v_mul_f32 v234, v230, v18
    v_mul_f32 v235, v230, v19
    s_waitcnt lgkmcnt(2)
    v_mfma_f32_32x32x16_bf16 v[48:63], a[248:251], v[200:203], v[48:63]
    ds_read_b128 a[240:243], v225 offset:2048
    buffer_load_dwordx4 v224, s[4:7], s83 offen offset:3072 sc1 lds
    v_exp_f32 v232, v232
    v_mul_f32 v16, v16, v20
    v_mfma_f32_32x32x16_bf16 v[48:63], a[252:255], v[204:207], v[48:63]
    ds_read_b128 a[244:247], v225 offset:3072
    v_exp_f32 v233, v233
    v_mul_f32 v17, v17, v21
    s_waitcnt lgkmcnt(2)
    v_mfma_f32_32x32x16_bf16 v[48:63], a[232:235], v[208:211], v[48:63]
    ds_read_b128 a[248:251], v225 offset:4096
    s_min_u32 s74, s71, 8192
    s_add_u32 s82, s74, 114688
    s_add_u32 s83, s74, 274432
    s_add_u32 s83, s83, s67
    s_mov_b32 m0, s82
    s_nop 0
    buffer_load_dwordx4 v224, s[4:7], s83 offen offset:0 sc1 lds
    v_mfma_f32_32x32x16_bf16 v[48:63], a[236:239], v[212:215], v[48:63]
    ds_read_b128 a[252:255], v225 offset:5120
    v_exp_f32 v234, v234
    v_mul_f32 v18, v18, v22
    s_waitcnt lgkmcnt(2)
    v_mfma_f32_32x32x16_bf16 v[48:63], a[240:243], v[216:219], v[48:63]
    ds_read_b128 a[232:235], v225 offset:6144
    buffer_load_dwordx4 v224, s[4:7], s83 offen offset:1024 sc1 lds
    v_exp_f32 v235, v235
    v_mul_f32 v19, v19, v23
    v_fma_f32 v232, v232, v231, v231
    v_mfma_f32_32x32x16_bf16 v[48:63], a[244:247], v[220:223], v[48:63]
    ds_read_b128 a[236:239], v225 offset:7168
    v_fma_f32 v233, v233, v231, v231
    v_fma_f32 v234, v234, v231, v231
    v_fma_f32 v235, v235, v231, v231
    s_waitcnt lgkmcnt(2)
    v_mfma_f32_32x32x16_bf16 v[0:15], a[248:251], v[64:67], 0
    ds_read_b128 a[240:243], v225 offset:8192
    buffer_load_dwordx4 v224, s[4:7], s83 offen offset:2048 sc1 lds
    v_rcp_f32 v232, v232
    v_rcp_f32 v233, v233
    v_mfma_f32_32x32x16_bf16 v[0:15], a[252:255], v[68:71], v[0:15]
    ds_read_b128 a[244:247], v225 offset:9216
    v_rcp_f32 v234, v234
    v_rcp_f32 v235, v235
    s_waitcnt lgkmcnt(2)
    v_mfma_f32_32x32x16_bf16 v[0:15], a[232:235], v[72:75], v[0:15]
    ds_read_b128 a[248:251], v225 offset:10240
    buffer_load_dwordx4 v224, s[4:7], s83 offen offset:3072 sc1 lds
    v_mul_f32 v16, v16, v232
    v_mul_f32 v17, v17, v233
    v_mul_f32 v18, v18, v234
    v_mfma_f32_32x32x16_bf16 v[0:15], a[236:239], v[76:79], v[0:15]
    ds_read_b128 a[252:255], v225 offset:11264
    v_mul_f32 v19, v19, v235
    v_cvt_pk_bf16_f32 v20, v16, v17
    v_cvt_pk_bf16_f32 v21, v18, v19
    s_waitcnt lgkmcnt(2)
    v_mfma_f32_32x32x16_bf16 v[0:15], a[240:243], v[80:83], v[0:15]
    ds_read_b128 a[232:235], v225 offset:12288
    s_add_u32 s98, s86, 12288
    buffer_load_dwordx4 a[200:203], v249, s[4:7], s98 offen offset:0 sc1
    v_fmac_f32 v24, v229, v240
    v_fmac_f32 v25, v229, v241
    v_fmac_f32 v26, v229, v242
    v_mfma_f32_32x32x16_bf16 v[0:15], a[244:247], v[84:87], v[0:15]
    ds_read_b128 a[236:239], v225 offset:13312
    v_fmac_f32 v27, v229, v243
    v_fmac_f32 v28, v229, v244
    v_fmac_f32 v29, v229, v245
    s_waitcnt lgkmcnt(2)
    v_mfma_f32_32x32x16_bf16 v[0:15], a[248:251], v[88:91], v[0:15]
    ds_read_b128 a[240:243], v225 offset:14336
    s_add_u32 s98, s87, 12288
    buffer_load_dwordx4 a[204:207], v249, s[4:7], s98 offen offset:0 sc1
    v_fmac_f32 v30, v229, v246
    v_fmac_f32 v31, v229, v247
    v_mul_f32 v240, v230, v24
    v_mfma_f32_32x32x16_bf16 v[0:15], a[252:255], v[92:95], v[0:15]
    ds_read_b128 a[244:247], v225 offset:15360
    v_mul_f32 v241, v230, v25
    v_mul_f32 v242, v230, v26
    v_mul_f32 v243, v230, v27
    s_waitcnt lgkmcnt(2)
    v_mfma_f32_32x32x16_bf16 v[0:15], a[232:235], v[96:99], v[0:15]
    ds_read_b128 a[248:251], v225 offset:16384
    s_add_u32 s98, s88, 12288
    buffer_load_dwordx4 a[208:211], v249, s[4:7], s98 offen offset:0 sc1
    v_exp_f32 v240, v240
    v_mul_f32 v24, v24, v28
    v_mfma_f32_32x32x16_bf16 v[0:15], a[236:239], v[100:103], v[0:15]
    ds_read_b128 a[252:255], v225 offset:17408
    v_exp_f32 v241, v241
    v_mul_f32 v25, v25, v29
    s_waitcnt lgkmcnt(2)
    v_mfma_f32_32x32x16_bf16 v[0:15], a[240:243], v[104:107], v[0:15]
    ds_read_b128 a[232:235], v225 offset:18432
    s_add_u32 s98, s84, 12288
    buffer_load_dwordx4 a[212:215], v249, s[4:7], s98 offen offset:1024 sc1
    v_exp_f32 v242, v242
    v_mul_f32 v26, v26, v30
    v_mfma_f32_32x32x16_bf16 v[0:15], a[244:247], v[108:111], v[0:15]
    ds_read_b128 a[236:239], v225 offset:19456
    v_exp_f32 v243, v243
    v_mul_f32 v27, v27, v31
    v_fma_f32 v240, v240, v231, v231
    s_waitcnt lgkmcnt(2)
    v_mfma_f32_32x32x16_bf16 v[0:15], a[248:251], v[112:115], v[0:15]
    ds_read_b128 a[240:243], v225 offset:20480
    s_add_u32 s98, s85, 12288
    buffer_load_dwordx4 a[216:219], v249, s[4:7], s98 offen offset:1024 sc1
    v_fma_f32 v241, v241, v231, v231
    v_fma_f32 v242, v242, v231, v231
    v_fma_f32 v243, v243, v231, v231
    v_mfma_f32_32x32x16_bf16 v[0:15], a[252:255], v[116:119], v[0:15]
    ds_read_b128 a[244:247], v225 offset:21504
    v_rcp_f32 v240, v240
    v_rcp_f32 v241, v241
    s_waitcnt lgkmcnt(2)
    v_mfma_f32_32x32x16_bf16 v[0:15], a[232:235], v[120:123], v[0:15]
    ds_read_b128 a[248:251], v225 offset:22528
    s_add_u32 s98, s86, 12288
    buffer_load_dwordx4 a[220:223], v249, s[4:7], s98 offen offset:1024 sc1
    v_rcp_f32 v242, v242
    v_mfma_f32_32x32x16_bf16 v[0:15], a[236:239], v[124:127], v[0:15]
    ds_read_b128 a[252:255], v225 offset:23552
    v_rcp_f32 v243, v243
    v_mul_f32 v24, v24, v240
    v_mul_f32 v25, v25, v241
    s_waitcnt lgkmcnt(2)
    v_mfma_f32_32x32x16_bf16 v[0:15], a[240:243], v[128:131], v[0:15]
    ds_read_b128 a[232:235], v225 offset:24576
    s_add_u32 s98, s87, 12288
    buffer_load_dwordx4 a[224:227], v249, s[4:7], s98 offen offset:1024 sc1
    v_mul_f32 v26, v26, v242
    v_mul_f32 v27, v27, v243
    v_cvt_pk_bf16_f32 v22, v24, v25
    v_mfma_f32_32x32x16_bf16 v[0:15], a[244:247], v[132:135], v[0:15]
    ds_read_b128 a[236:239], v225 offset:25600
    v_cvt_pk_bf16_f32 v23, v26, v27
    s_and_b32 s74, s65, 3
    s_lshl_b32 s74, s74, 10
    s_add_u32 s74, s74, s77
    buffer_store_dwordx4 v[20:23], v228, s[4:7], s74 offen offset:512 sc1
    s_waitcnt lgkmcnt(2)
    v_mfma_f32_32x32x16_bf16 v[0:15], a[248:251], v[136:139], v[0:15]
    ds_read_b128 a[240:243], v225 offset:26624
    s_add_u32 s98, s88, 12288
    buffer_load_dwordx4 a[228:231], v249, s[4:7], s98 offen offset:1024 sc1
    ds_read_b128 v[232:235], v248 offset:256
    ds_read_b128 v[236:239], v248 offset:272
    v_mfma_f32_32x32x16_bf16 v[0:15], a[252:255], v[140:143], v[0:15]
    ds_read_b128 a[244:247], v225 offset:27648
    ds_read_b128 v[240:243], v248 offset:288
    ds_read_b128 v[244:247], v248 offset:304
    s_waitcnt lgkmcnt(3)
    v_fmac_f32 v32, v229, v232
    v_fmac_f32 v33, v229, v233
    v_mfma_f32_32x32x16_bf16 v[0:15], a[232:235], v[144:147], v[0:15]
    ds_read_b128 a[248:251], v225 offset:28672
    buffer_load_dwordx4 a[0:3], v224, s[4:7], s84 offen offset:0 sc1
    v_fmac_f32 v34, v229, v234
    v_fmac_f32 v35, v229, v235
    v_fmac_f32 v36, v229, v236
    v_mfma_f32_32x32x16_bf16 v[0:15], a[236:239], v[148:151], v[0:15]
    ds_read_b128 a[252:255], v225 offset:29696
    v_fmac_f32 v37, v229, v237
    v_fmac_f32 v38, v229, v238
    v_fmac_f32 v39, v229, v239
    s_waitcnt lgkmcnt(4)
    v_mfma_f32_32x32x16_bf16 v[0:15], a[240:243], v[152:155], v[0:15]
    ds_read_b128 a[232:235], v225 offset:30720
    buffer_load_dwordx4 a[4:7], v224, s[4:7], s85 offen offset:0 sc1
    v_mul_f32 v232, v230, v32
    v_mul_f32 v233, v230, v33
    v_mul_f32 v234, v230, v34
    v_mfma_f32_32x32x16_bf16 v[0:15], a[244:247], v[156:159], v[0:15]
    ds_read_b128 a[236:239], v225 offset:31744
    v_mul_f32 v235, v230, v35
    v_exp_f32 v232, v232
    v_mul_f32 v32, v32, v36
    s_waitcnt lgkmcnt(2)
    v_mfma_f32_32x32x16_bf16 v[0:15], a[248:251], v[160:163], v[0:15]
    ds_read_b128 a[240:243], v225 offset:32768
    buffer_load_dwordx4 a[8:11], v224, s[4:7], s86 offen offset:0 sc1
    v_exp_f32 v233, v233
    v_mul_f32 v33, v33, v37
    v_mfma_f32_32x32x16_bf16 v[0:15], a[252:255], v[164:167], v[0:15]
    ds_read_b128 a[244:247], v225 offset:33792
    v_exp_f32 v234, v234
    v_mul_f32 v34, v34, v38
    s_waitcnt lgkmcnt(2)
    v_mfma_f32_32x32x16_bf16 v[0:15], a[232:235], v[168:171], v[0:15]
    ds_read_b128 a[248:251], v225 offset:34816
    buffer_load_dwordx4 a[12:15], v224, s[4:7], s87 offen offset:0 sc1
    v_exp_f32 v235, v235
    v_mul_f32 v35, v35, v39
    v_fma_f32 v232, v232, v231, v231
    v_mfma_f32_32x32x16_bf16 v[0:15], a[236:239], v[172:175], v[0:15]
    ds_read_b128 a[252:255], v225 offset:35840
    v_fma_f32 v233, v233, v231, v231
    v_fma_f32 v234, v234, v231, v231
    v_fma_f32 v235, v235, v231, v231
    s_waitcnt lgkmcnt(2)
    v_mfma_f32_32x32x16_bf16 v[0:15], a[240:243], v[176:179], v[0:15]
    ds_read_b128 a[232:235], v225 offset:36864
    buffer_load_dwordx4 a[16:19], v224, s[4:7], s88 offen offset:0 sc1
    v_rcp_f32 v232, v232
    v_rcp_f32 v233, v233
    v_mfma_f32_32x32x16_bf16 v[0:15], a[244:247], v[180:183], v[0:15]
    ds_read_b128 a[236:239], v225 offset:37888
    v_rcp_f32 v234, v234
    v_rcp_f32 v235, v235
    s_waitcnt lgkmcnt(2)
    v_mfma_f32_32x32x16_bf16 v[0:15], a[248:251], v[184:187], v[0:15]
    ds_read_b128 a[240:243], v225 offset:38912
    buffer_load_dwordx4 a[20:23], v224, s[4:7], s84 offen offset:1024 sc1
    v_mul_f32 v32, v32, v232
    v_mul_f32 v33, v33, v233
    v_mul_f32 v34, v34, v234
    v_mfma_f32_32x32x16_bf16 v[0:15], a[252:255], v[188:191], v[0:15]
    ds_read_b128 a[244:247], v225 offset:39936
    v_mul_f32 v35, v35, v235
    v_cvt_pk_bf16_f32 v36, v32, v33
    v_cvt_pk_bf16_f32 v37, v34, v35
    s_waitcnt lgkmcnt(2)
    v_mfma_f32_32x32x16_bf16 v[0:15], a[232:235], v[192:195], v[0:15]
    ds_read_b128 a[248:251], v225 offset:40960
    buffer_load_dwordx4 a[24:27], v224, s[4:7], s85 offen offset:1024 sc1
    v_fmac_f32 v40, v229, v240
    v_fmac_f32 v41, v229, v241
    v_fmac_f32 v42, v229, v242
    v_mfma_f32_32x32x16_bf16 v[0:15], a[236:239], v[196:199], v[0:15]
    ds_read_b128 a[252:255], v225 offset:41984
    v_fmac_f32 v43, v229, v243
    v_fmac_f32 v44, v229, v244
    v_fmac_f32 v45, v229, v245
    s_waitcnt lgkmcnt(2)
    v_mfma_f32_32x32x16_bf16 v[0:15], a[240:243], v[200:203], v[0:15]
    ds_read_b128 a[232:235], v225 offset:43008
    buffer_load_dwordx4 a[28:31], v224, s[4:7], s86 offen offset:1024 sc1
    v_fmac_f32 v46, v229, v246
    v_fmac_f32 v47, v229, v247
    v_mul_f32 v240, v230, v40
    v_mfma_f32_32x32x16_bf16 v[0:15], a[244:247], v[204:207], v[0:15]
    ds_read_b128 a[236:239], v225 offset:44032
    v_mul_f32 v241, v230, v41
    v_mul_f32 v242, v230, v42
    v_mul_f32 v243, v230, v43
    s_waitcnt vmcnt(28)
    s_barrier
    s_waitcnt lgkmcnt(2)
    v_mfma_f32_32x32x16_bf16 v[0:15], a[248:251], v[208:211], v[0:15]
    ds_read_b128 a[240:243], v225 offset:45056
    buffer_load_dwordx4 a[32:35], v224, s[4:7], s87 offen offset:1024 sc1
    v_exp_f32 v240, v240
    v_mul_f32 v40, v40, v44
    v_mfma_f32_32x32x16_bf16 v[0:15], a[252:255], v[212:215], v[0:15]
    ds_read_b128 a[244:247], v225 offset:46080
    v_exp_f32 v241, v241
    v_mul_f32 v41, v41, v45
    s_waitcnt lgkmcnt(2)
    v_mfma_f32_32x32x16_bf16 v[0:15], a[232:235], v[216:219], v[0:15]
    ds_read_b128 a[248:251], v225 offset:47104
    buffer_load_dwordx4 a[36:39], v224, s[4:7], s88 offen offset:1024 sc1
    v_exp_f32 v242, v242
    v_mul_f32 v42, v42, v46
    v_mfma_f32_32x32x16_bf16 v[0:15], a[236:239], v[220:223], v[0:15]
    ds_read_b128 a[252:255], v225 offset:48128
    v_exp_f32 v243, v243
    v_mul_f32 v43, v43, v47
    v_fma_f32 v240, v240, v231, v231
    s_waitcnt lgkmcnt(2)
    v_mfma_f32_32x32x16_bf16 v[16:31], a[240:243], v[64:67], 0
    ds_read_b128 a[232:235], v225 offset:49152
    buffer_load_dwordx4 a[40:43], v224, s[4:7], s84 offen offset:2048 sc1
    v_fma_f32 v241, v241, v231, v231
    v_fma_f32 v242, v242, v231, v231
    v_fma_f32 v243, v243, v231, v231
    v_mfma_f32_32x32x16_bf16 v[16:31], a[244:247], v[68:71], v[16:31]
    ds_read_b128 a[236:239], v225 offset:50176
    v_rcp_f32 v240, v240
    v_rcp_f32 v241, v241
    s_waitcnt lgkmcnt(2)
    v_mfma_f32_32x32x16_bf16 v[16:31], a[248:251], v[72:75], v[16:31]
    ds_read_b128 a[240:243], v225 offset:51200
    buffer_load_dwordx4 a[44:47], v224, s[4:7], s85 offen offset:2048 sc1
    v_rcp_f32 v242, v242
    v_rcp_f32 v243, v243
    v_mfma_f32_32x32x16_bf16 v[16:31], a[252:255], v[76:79], v[16:31]
    ds_read_b128 a[244:247], v225 offset:52224
    v_mul_f32 v40, v40, v240
    v_mul_f32 v41, v41, v241
    v_mul_f32 v42, v42, v242
    s_waitcnt lgkmcnt(2)
    v_mfma_f32_32x32x16_bf16 v[16:31], a[232:235], v[80:83], v[16:31]
    ds_read_b128 a[248:251], v225 offset:53248
    buffer_load_dwordx4 a[48:51], v224, s[4:7], s86 offen offset:2048 sc1
    v_mul_f32 v43, v43, v243
    v_cvt_pk_bf16_f32 v38, v40, v41
    v_cvt_pk_bf16_f32 v39, v42, v43
    v_mfma_f32_32x32x16_bf16 v[16:31], a[236:239], v[84:87], v[16:31]
    ds_read_b128 a[252:255], v225 offset:54272
    s_and_b32 s74, s65, 3
    s_lshl_b32 s74, s74, 9
    s_add_u32 s74, s74, s77
    s_add_u32 s74, s74, 4096
    buffer_store_dwordx4 v[36:39], v228, s[4:7], s74 offen offset:0 sc1
    s_waitcnt lgkmcnt(2)
    v_mfma_f32_32x32x16_bf16 v[16:31], a[240:243], v[88:91], v[16:31]
    ds_read_b128 a[232:235], v225 offset:55296
    buffer_load_dwordx4 a[52:55], v224, s[4:7], s87 offen offset:2048 sc1
    ds_read_b128 v[232:235], v248 offset:384
    ds_read_b128 v[236:239], v248 offset:400
    ds_read_b128 v[240:243], v248 offset:416
    ds_read_b128 v[244:247], v248 offset:432
    s_waitcnt lgkmcnt(2)
    v_mfma_f32_32x32x16_bf16 v[16:31], a[244:247], v[92:95], v[16:31]
    ds_read_b128 a[236:239], v225 offset:56320
    v_fmac_f32 v48, v229, v232
    v_fmac_f32 v49, v229, v233
    v_fmac_f32 v50, v229, v234
    v_mfma_f32_32x32x16_bf16 v[16:31], a[248:251], v[96:99], v[16:31]
    ds_read_b128 a[240:243], v225 offset:57344
    buffer_load_dwordx4 a[56:59], v224, s[4:7], s88 offen offset:2048 sc1
    v_fmac_f32 v51, v229, v235
    v_fmac_f32 v52, v229, v236
    v_fmac_f32 v53, v229, v237
    v_mfma_f32_32x32x16_bf16 v[16:31], a[252:255], v[100:103], v[16:31]
    ds_read_b128 a[244:247], v225 offset:58368
    v_fmac_f32 v54, v229, v238
    v_fmac_f32 v55, v229, v239
    v_mul_f32 v232, v230, v48
    s_waitcnt lgkmcnt(2)
    v_mfma_f32_32x32x16_bf16 v[16:31], a[232:235], v[104:107], v[16:31]
    ds_read_b128 a[248:251], v225 offset:59392
    buffer_load_dwordx4 a[60:63], v224, s[4:7], s84 offen offset:3072 sc1
    v_mul_f32 v233, v230, v49
    v_mul_f32 v234, v230, v50
    v_mul_f32 v235, v230, v51
    v_mfma_f32_32x32x16_bf16 v[16:31], a[236:239], v[108:111], v[16:31]
    ds_read_b128 a[252:255], v225 offset:60416
    v_exp_f32 v232, v232
    v_mul_f32 v48, v48, v52
    s_waitcnt lgkmcnt(2)
    v_mfma_f32_32x32x16_bf16 v[16:31], a[240:243], v[112:115], v[16:31]
    ds_read_b128 a[232:235], v225 offset:61440
    buffer_load_dwordx4 a[64:67], v224, s[4:7], s85 offen offset:3072 sc1
    v_exp_f32 v233, v233
    v_mul_f32 v49, v49, v53
    v_mfma_f32_32x32x16_bf16 v[16:31], a[244:247], v[116:119], v[16:31]
    ds_read_b128 a[236:239], v225 offset:62464
    v_exp_f32 v234, v234
    v_mul_f32 v50, v50, v54
    s_waitcnt lgkmcnt(2)
    v_mfma_f32_32x32x16_bf16 v[16:31], a[248:251], v[120:123], v[16:31]
    ds_read_b128 a[240:243], v225 offset:63488
    buffer_load_dwordx4 a[68:71], v224, s[4:7], s86 offen offset:3072 sc1
    v_exp_f32 v235, v235
    v_mul_f32 v51, v51, v55
    v_fma_f32 v232, v232, v231, v231
    v_mfma_f32_32x32x16_bf16 v[16:31], a[252:255], v[124:127], v[16:31]
    ds_read_b128 a[244:247], v225 offset:64512
    v_fma_f32 v233, v233, v231, v231
    v_fma_f32 v234, v234, v231, v231
    v_fma_f32 v235, v235, v231, v231
    s_waitcnt lgkmcnt(2)
    v_mfma_f32_32x32x16_bf16 v[16:31], a[232:235], v[128:131], v[16:31]
    ds_read_b128 a[248:251], v226 offset:0
    buffer_load_dwordx4 a[72:75], v224, s[4:7], s87 offen offset:3072 sc1
    v_rcp_f32 v232, v232
    v_rcp_f32 v233, v233
    v_mfma_f32_32x32x16_bf16 v[16:31], a[236:239], v[132:135], v[16:31]
    ds_read_b128 a[252:255], v226 offset:1024
    v_rcp_f32 v234, v234
    v_rcp_f32 v235, v235
    s_waitcnt lgkmcnt(2)
    v_mfma_f32_32x32x16_bf16 v[16:31], a[240:243], v[136:139], v[16:31]
    ds_read_b128 a[232:235], v226 offset:2048
    buffer_load_dwordx4 a[76:79], v224, s[4:7], s88 offen offset:3072 sc1
    v_mul_f32 v48, v48, v232
    v_mul_f32 v49, v49, v233
    v_mul_f32 v50, v50, v234
    v_mfma_f32_32x32x16_bf16 v[16:31], a[244:247], v[140:143], v[16:31]
    ds_read_b128 a[236:239], v226 offset:3072
    v_mul_f32 v51, v51, v235
    v_cvt_pk_bf16_f32 v52, v48, v49
    v_cvt_pk_bf16_f32 v53, v50, v51
    s_waitcnt lgkmcnt(2)
    v_mfma_f32_32x32x16_bf16 v[16:31], a[248:251], v[144:147], v[16:31]
    ds_read_b128 a[240:243], v226 offset:4096
    s_add_u32 s98, s84, 4096
    buffer_load_dwordx4 a[80:83], v224, s[4:7], s98 offen offset:0 sc1
    v_fmac_f32 v56, v229, v240
    v_fmac_f32 v57, v229, v241
    v_fmac_f32 v58, v229, v242
    v_mfma_f32_32x32x16_bf16 v[16:31], a[252:255], v[148:151], v[16:31]
    ds_read_b128 a[244:247], v226 offset:5120
    v_fmac_f32 v59, v229, v243
    v_fmac_f32 v60, v229, v244
    v_fmac_f32 v61, v229, v245
    s_waitcnt lgkmcnt(2)
    v_mfma_f32_32x32x16_bf16 v[16:31], a[232:235], v[152:155], v[16:31]
    ds_read_b128 a[248:251], v226 offset:6144
    s_add_u32 s98, s85, 4096
    buffer_load_dwordx4 a[84:87], v224, s[4:7], s98 offen offset:0 sc1
    v_fmac_f32 v62, v229, v246
    v_fmac_f32 v63, v229, v247
    v_mul_f32 v240, v230, v56
    v_mfma_f32_32x32x16_bf16 v[16:31], a[236:239], v[156:159], v[16:31]
    ds_read_b128 a[252:255], v226 offset:7168
    v_mul_f32 v241, v230, v57
    v_mul_f32 v242, v230, v58
    v_mul_f32 v243, v230, v59
    s_waitcnt lgkmcnt(2)
    v_mfma_f32_32x32x16_bf16 v[16:31], a[240:243], v[160:163], v[16:31]
    ds_read_b128 a[232:235], v226 offset:8192
    s_add_u32 s98, s86, 4096
    buffer_load_dwordx4 a[88:91], v224, s[4:7], s98 offen offset:0 sc1
    v_exp_f32 v240, v240
    v_mul_f32 v56, v56, v60
    v_mfma_f32_32x32x16_bf16 v[16:31], a[244:247], v[164:167], v[16:31]
    ds_read_b128 a[236:239], v226 offset:9216
    v_exp_f32 v241, v241
    v_mul_f32 v57, v57, v61
    s_waitcnt lgkmcnt(2)
    v_mfma_f32_32x32x16_bf16 v[16:31], a[248:251], v[168:171], v[16:31]
    ds_read_b128 a[240:243], v226 offset:10240
    s_add_u32 s98, s87, 4096
    buffer_load_dwordx4 a[92:95], v224, s[4:7], s98 offen offset:0 sc1
    v_exp_f32 v242, v242
    v_mul_f32 v58, v58, v62
    v_mfma_f32_32x32x16_bf16 v[16:31], a[252:255], v[172:175], v[16:31]
    ds_read_b128 a[244:247], v226 offset:11264
    v_exp_f32 v243, v243
    v_mul_f32 v59, v59, v63
    v_fma_f32 v240, v240, v231, v231
    s_waitcnt lgkmcnt(2)
    v_mfma_f32_32x32x16_bf16 v[16:31], a[232:235], v[176:179], v[16:31]
    ds_read_b128 a[248:251], v226 offset:12288
    s_add_u32 s98, s88, 4096
    buffer_load_dwordx4 a[96:99], v224, s[4:7], s98 offen offset:0 sc1
    v_fma_f32 v241, v241, v231, v231
    v_fma_f32 v242, v242, v231, v231
    v_fma_f32 v243, v243, v231, v231
    v_mfma_f32_32x32x16_bf16 v[16:31], a[236:239], v[180:183], v[16:31]
    ds_read_b128 a[252:255], v226 offset:13312
    v_rcp_f32 v240, v240
    v_rcp_f32 v241, v241
    s_waitcnt lgkmcnt(2)
    v_mfma_f32_32x32x16_bf16 v[16:31], a[240:243], v[184:187], v[16:31]
    ds_read_b128 a[232:235], v226 offset:14336
    s_add_u32 s98, s84, 4096
    buffer_load_dwordx4 a[100:103], v224, s[4:7], s98 offen offset:1024 sc1
    v_rcp_f32 v242, v242
    v_mfma_f32_32x32x16_bf16 v[16:31], a[244:247], v[188:191], v[16:31]
    ds_read_b128 a[236:239], v226 offset:15360
    v_rcp_f32 v243, v243
    v_mul_f32 v56, v56, v240
    v_mul_f32 v57, v57, v241
    v_lshrrev_b32 v249, 4, v224
    v_min_u32 v249, 39, v249
    v_lshlrev_b32 v249, 4, v249
    s_mov_b32 s80, 9216
    s_cmp_lg_u32 s59, 1
    s_cbranch_scc1 L_p1_42
    buffer_load_dwordx4 v[250:253], v249, s[4:7], s80 offen sc1
L_p1_42:
    s_waitcnt lgkmcnt(2)
    v_mfma_f32_32x32x16_bf16 v[16:31], a[248:251], v[192:195], v[16:31]
    ds_read_b128 a[240:243], v226 offset:16384
    s_add_u32 s98, s85, 4096
    buffer_load_dwordx4 a[104:107], v224, s[4:7], s98 offen offset:1024 sc1
    v_mul_f32 v58, v58, v242
    v_mul_f32 v59, v59, v243
    v_cvt_pk_bf16_f32 v54, v56, v57
    v_mfma_f32_32x32x16_bf16 v[16:31], a[252:255], v[196:199], v[16:31]
    ds_read_b128 a[244:247], v226 offset:17408
    v_cvt_pk_bf16_f32 v55, v58, v59
    s_and_b32 s74, s65, 3
    s_lshl_b32 s74, s74, 9
    s_add_u32 s74, s74, s77
    s_add_u32 s74, s74, 6144
    buffer_store_dwordx4 v[52:55], v228, s[4:7], s74 offen offset:0 sc1
    s_waitcnt lgkmcnt(2)
    v_mfma_f32_32x32x16_bf16 v[16:31], a[232:235], v[200:203], v[16:31]
    ds_read_b128 a[248:251], v226 offset:18432
    s_add_u32 s98, s86, 4096
    buffer_load_dwordx4 a[108:111], v224, s[4:7], s98 offen offset:1024 sc1
    ds_read_b128 v[232:235], v248 offset:512
    ds_read_b128 v[236:239], v248 offset:528
    v_mfma_f32_32x32x16_bf16 v[16:31], a[236:239], v[204:207], v[16:31]
    ds_read_b128 a[252:255], v226 offset:19456
    ds_read_b128 v[240:243], v248 offset:544
    ds_read_b128 v[244:247], v248 offset:560
    s_waitcnt lgkmcnt(3)
    v_fmac_f32 v0, v229, v232
    v_fmac_f32 v1, v229, v233
    v_mfma_f32_32x32x16_bf16 v[16:31], a[240:243], v[208:211], v[16:31]
    ds_read_b128 a[232:235], v226 offset:20480
    s_add_u32 s98, s84, 8192
    buffer_load_dwordx4 a[112:115], v224, s[4:7], s98 offen offset:0 sc1
    v_fmac_f32 v2, v229, v234
    v_fmac_f32 v3, v229, v235
    v_fmac_f32 v4, v229, v236
    v_mfma_f32_32x32x16_bf16 v[16:31], a[244:247], v[212:215], v[16:31]
    ds_read_b128 a[236:239], v226 offset:21504
    v_fmac_f32 v5, v229, v237
    v_fmac_f32 v6, v229, v238
    v_fmac_f32 v7, v229, v239
    s_waitcnt lgkmcnt(4)
    v_mfma_f32_32x32x16_bf16 v[16:31], a[248:251], v[216:219], v[16:31]
    ds_read_b128 a[240:243], v226 offset:22528
    s_add_u32 s98, s85, 8192
    buffer_load_dwordx4 a[116:119], v224, s[4:7], s98 offen offset:0 sc1
    v_mul_f32 v232, v230, v0
    v_mul_f32 v233, v230, v1
    v_mul_f32 v234, v230, v2
    v_mfma_f32_32x32x16_bf16 v[16:31], a[252:255], v[220:223], v[16:31]
    ds_read_b128 a[244:247], v226 offset:23552
    v_mul_f32 v235, v230, v3
    v_exp_f32 v232, v232
    v_mul_f32 v0, v0, v4
    s_waitcnt lgkmcnt(2)
    v_mfma_f32_32x32x16_bf16 v[32:47], a[232:235], v[64:67], 0
    ds_read_b128 a[248:251], v226 offset:24576
    s_add_u32 s98, s86, 8192
    buffer_load_dwordx4 a[120:123], v224, s[4:7], s98 offen offset:0 sc1
    v_exp_f32 v233, v233
    v_mul_f32 v1, v1, v5
    v_mfma_f32_32x32x16_bf16 v[32:47], a[236:239], v[68:71], v[32:47]
    ds_read_b128 a[252:255], v226 offset:25600
    v_exp_f32 v234, v234
    v_mul_f32 v2, v2, v6
    s_waitcnt lgkmcnt(2)
    v_mfma_f32_32x32x16_bf16 v[32:47], a[240:243], v[72:75], v[32:47]
    ds_read_b128 a[232:235], v226 offset:26624
    s_add_u32 s98, s87, 8192
    buffer_load_dwordx4 a[124:127], v224, s[4:7], s98 offen offset:0 sc1
    v_exp_f32 v235, v235
    v_mul_f32 v3, v3, v7
    v_mfma_f32_32x32x16_bf16 v[32:47], a[244:247], v[76:79], v[32:47]
    ds_read_b128 a[236:239], v226 offset:27648
    v_fma_f32 v232, v232, v231, v231
    v_fma_f32 v233, v233, v231, v231
    v_fma_f32 v234, v234, v231, v231
    s_waitcnt vmcnt(43)
    s_cmp_lg_u32 s59, 1
    s_cbranch_scc1 L_p1c_43
    s_waitcnt vmcnt(7)
    v_xor_b32 v250, s3, v250
    v_xor_b32 v251, s3, v251
    v_xor_b32 v252, s3, v252
    v_xor_b32 v253, s3, v253
    v_or3_b32 v250, v250, v251, v252
    v_or_b32 v250, v250, v253
    v_cmp_ne_u32 vcc, 0, v250
    s_cbranch_vccnz L_spin_44
L_back_45:
L_p1c_43:
    s_waitcnt vmcnt(5)
    s_barrier
    s_lshl_b32 s74, s64, 9
    s_lshl_b32 s75, s65, 2
    s_add_u32 s74, s74, s75
    s_add_u32 s74, s74, 12288
    s_cmp_lg_u32 s59, 0
    s_cbranch_scc1 L_fs_46
    v_mbcnt_lo_u32_b32 v250, -1, 0
    v_mul_u32_u24 v250, 128, v250
    v_mov_b32 v251, s3
    s_mov_b64 exec, 15
    buffer_store_dword v251, v250, s[4:7], s74 offen sc1
    s_mov_b64 exec, -1
L_fs_46:
    s_waitcnt lgkmcnt(2)
    v_mfma_f32_32x32x16_bf16 v[32:47], a[248:251], v[80:83], v[32:47]
    ds_read_b128 a[240:243], v226 offset:28672
    s_add_u32 s98, s88, 8192
    buffer_load_dwordx4 a[128:131], v224, s[4:7], s98 offen offset:0 sc1
    v_fma_f32 v235, v235, v231, v231
    v_rcp_f32 v232, v232
    v_mfma_f32_32x32x16_bf16 v[32:47], a[252:255], v[84:87], v[32:47]
    ds_read_b128 a[244:247], v226 offset:29696
    v_rcp_f32 v233, v233
    v_rcp_f32 v234, v234
    s_waitcnt lgkmcnt(2)
    v_mfma_f32_32x32x16_bf16 v[32:47], a[232:235], v[88:91], v[32:47]
    ds_read_b128 a[248:251], v226 offset:30720
    s_add_u32 s98, s84, 8192
    buffer_load_dwordx4 a[132:135], v224, s[4:7], s98 offen offset:1024 sc1
    v_rcp_f32 v235, v235
    v_mul_f32 v0, v0, v232
    v_mfma_f32_32x32x16_bf16 v[32:47], a[236:239], v[92:95], v[32:47]
    ds_read_b128 a[252:255], v226 offset:31744
    v_mul_f32 v1, v1, v233
    v_mul_f32 v2, v2, v234
    v_mul_f32 v3, v3, v235
    s_waitcnt lgkmcnt(2)
    v_mfma_f32_32x32x16_bf16 v[32:47], a[240:243], v[96:99], v[32:47]
    ds_read_b128 a[232:235], v226 offset:32768
    s_add_u32 s98, s85, 8192
    buffer_load_dwordx4 a[136:139], v224, s[4:7], s98 offen offset:1024 sc1
    v_cvt_pk_bf16_f32 v4, v0, v1
    v_cvt_pk_bf16_f32 v5, v2, v3
    v_fmac_f32 v8, v229, v240
    v_mfma_f32_32x32x16_bf16 v[32:47], a[244:247], v[100:103], v[32:47]
    ds_read_b128 a[236:239], v226 offset:33792
    v_fmac_f32 v9, v229, v241
    v_fmac_f32 v10, v229, v242
    v_fmac_f32 v11, v229, v243
    s_waitcnt lgkmcnt(2)
    v_mfma_f32_32x32x16_bf16 v[32:47], a[248:251], v[104:107], v[32:47]
    ds_read_b128 a[240:243], v226 offset:34816
    s_add_u32 s98, s86, 8192
    buffer_load_dwordx4 a[140:143], v224, s[4:7], s98 offen offset:1024 sc1
    v_fmac_f32 v12, v229, v244
    v_fmac_f32 v13, v229, v245
    v_fmac_f32 v14, v229, v246
    v_mfma_f32_32x32x16_bf16 v[32:47], a[252:255], v[108:111], v[32:47]
    ds_read_b128 a[244:247], v226 offset:35840
    v_fmac_f32 v15, v229, v247
    v_mul_f32 v240, v230, v8
    v_mul_f32 v241, v230, v9
    s_waitcnt lgkmcnt(2)
    v_mfma_f32_32x32x16_bf16 v[32:47], a[232:235], v[112:115], v[32:47]
    ds_read_b128 a[248:251], v226 offset:36864
    s_add_u32 s98, s87, 8192
    buffer_load_dwordx4 a[144:147], v224, s[4:7], s98 offen offset:1024 sc1
    v_mul_f32 v242, v230, v10
    v_mul_f32 v243, v230, v11
    v_mfma_f32_32x32x16_bf16 v[32:47], a[236:239], v[116:119], v[32:47]
    ds_read_b128 a[252:255], v226 offset:37888
    v_exp_f32 v240, v240
    v_mul_f32 v8, v8, v12
    s_waitcnt lgkmcnt(2)
    v_mfma_f32_32x32x16_bf16 v[32:47], a[240:243], v[120:123], v[32:47]
    ds_read_b128 a[232:235], v226 offset:38912
    s_add_u32 s98, s88, 8192
    buffer_load_dwordx4 a[148:151], v224, s[4:7], s98 offen offset:1024 sc1
    v_exp_f32 v241, v241
    v_mul_f32 v9, v9, v13
    v_mfma_f32_32x32x16_bf16 v[32:47], a[244:247], v[124:127], v[32:47]
    ds_read_b128 a[236:239], v226 offset:39936
    v_exp_f32 v242, v242
    v_mul_f32 v10, v10, v14
    s_waitcnt lgkmcnt(2)
    v_mfma_f32_32x32x16_bf16 v[32:47], a[248:251], v[128:131], v[32:47]
    ds_read_b128 a[240:243], v226 offset:40960
    s_add_u32 s98, s84, 8192
    buffer_load_dwordx4 a[152:155], v224, s[4:7], s98 offen offset:2048 sc1
    v_exp_f32 v243, v243
    v_mul_f32 v11, v11, v15
    v_mfma_f32_32x32x16_bf16 v[32:47], a[252:255], v[132:135], v[32:47]
    ds_read_b128 a[244:247], v226 offset:41984
    v_fma_f32 v240, v240, v231, v231
    v_fma_f32 v241, v241, v231, v231
    v_fma_f32 v242, v242, v231, v231
    s_waitcnt lgkmcnt(2)
    v_mfma_f32_32x32x16_bf16 v[32:47], a[232:235], v[136:139], v[32:47]
    ds_read_b128 a[248:251], v226 offset:43008
    s_add_u32 s98, s85, 8192
    buffer_load_dwordx4 a[156:159], v224, s[4:7], s98 offen offset:2048 sc1
    v_fma_f32 v243, v243, v231, v231
    v_rcp_f32 v240, v240
    v_mfma_f32_32x32x16_bf16 v[32:47], a[236:239], v[140:143], v[32:47]
    ds_read_b128 a[252:255], v226 offset:44032
    v_rcp_f32 v241, v241
    v_rcp_f32 v242, v242
    s_waitcnt lgkmcnt(2)
    v_mfma_f32_32x32x16_bf16 v[32:47], a[240:243], v[144:147], v[32:47]
    ds_read_b128 a[232:235], v226 offset:45056
    s_add_u32 s98, s86, 8192
    buffer_load_dwordx4 a[160:163], v224, s[4:7], s98 offen offset:2048 sc1
    v_rcp_f32 v243, v243
    v_mul_f32 v8, v8, v240
    v_mfma_f32_32x32x16_bf16 v[32:47], a[244:247], v[148:151], v[32:47]
    ds_read_b128 a[236:239], v226 offset:46080
    v_mul_f32 v9, v9, v241
    v_mul_f32 v10, v10, v242
    v_mul_f32 v11, v11, v243
    s_waitcnt lgkmcnt(2)
    v_mfma_f32_32x32x16_bf16 v[32:47], a[248:251], v[152:155], v[32:47]
    ds_read_b128 a[240:243], v226 offset:47104
    s_add_u32 s98, s87, 8192
    buffer_load_dwordx4 a[164:167], v224, s[4:7], s98 offen offset:2048 sc1
    v_cvt_pk_bf16_f32 v6, v8, v9
    v_cvt_pk_bf16_f32 v7, v10, v11
    s_and_b32 s74, s65, 3
    s_lshl_b32 s74, s74, 10
    s_add_u32 s74, s74, s77
    s_add_u32 s74, s74, 8192
    buffer_store_dwordx4 v[4:7], v228, s[4:7], s74 offen offset:0 sc1
    v_mfma_f32_32x32x16_bf16 v[32:47], a[252:255], v[156:159], v[32:47]
    ds_read_b128 a[244:247], v226 offset:48128
    ds_read_b128 v[232:235], v248 offset:640
    ds_read_b128 v[236:239], v248 offset:656
    ds_read_b128 v[240:243], v248 offset:672
    ds_read_b128 v[244:247], v248 offset:688
    s_waitcnt lgkmcnt(2)
    v_mfma_f32_32x32x16_bf16 v[32:47], a[232:235], v[160:163], v[32:47]
    ds_read_b128 a[248:251], v226 offset:49152
    s_add_u32 s98, s88, 8192
    buffer_load_dwordx4 a[168:171], v224, s[4:7], s98 offen offset:2048 sc1
    v_fmac_f32 v16, v229, v232
    v_fmac_f32 v17, v229, v233
    v_fmac_f32 v18, v229, v234
    v_mfma_f32_32x32x16_bf16 v[32:47], a[236:239], v[164:167], v[32:47]
    ds_read_b128 a[252:255], v226 offset:50176
    v_fmac_f32 v19, v229, v235
    v_fmac_f32 v20, v229, v236
    v_fmac_f32 v21, v229, v237
    v_mfma_f32_32x32x16_bf16 v[32:47], a[240:243], v[168:171], v[32:47]
    ds_read_b128 a[232:235], v226 offset:51200
    s_add_u32 s98, s84, 8192
    buffer_load_dwordx4 a[172:175], v224, s[4:7], s98 offen offset:3072 sc1
    v_fmac_f32 v22, v229, v238
    v_fmac_f32 v23, v229, v239
    v_mul_f32 v232, v230, v16
    v_mfma_f32_32x32x16_bf16 v[32:47], a[244:247], v[172:175], v[32:47]
    ds_read_b128 a[236:239], v226 offset:52224
    v_mul_f32 v233, v230, v17
    v_mul_f32 v234, v230, v18
    v_mul_f32 v235, v230, v19
    s_waitcnt lgkmcnt(2)
    v_mfma_f32_32x32x16_bf16 v[32:47], a[248:251], v[176:179], v[32:47]
    ds_read_b128 a[240:243], v226 offset:53248
    s_add_u32 s98, s85, 8192
    buffer_load_dwordx4 a[176:179], v224, s[4:7], s98 offen offset:3072 sc1
    v_exp_f32 v232, v232
    v_mul_f32 v16, v16, v20
    v_mfma_f32_32x32x16_bf16 v[32:47], a[252:255], v[180:183], v[32:47]
    ds_read_b128 a[244:247], v226 offset:54272
    v_exp_f32 v233, v233
    v_mul_f32 v17, v17, v21
    s_waitcnt lgkmcnt(2)
    v_mfma_f32_32x32x16_bf16 v[32:47], a[232:235], v[184:187], v[32:47]
    ds_read_b128 a[248:251], v226 offset:55296
    s_add_u32 s98, s86, 8192
    buffer_load_dwordx4 a[180:183], v224, s[4:7], s98 offen offset:3072 sc1
    v_exp_f32 v234, v234
    v_mul_f32 v18, v18, v22
    v_mfma_f32_32x32x16_bf16 v[32:47], a[236:239], v[188:191], v[32:47]
    ds_read_b128 a[252:255], v226 offset:56320
    v_exp_f32 v235, v235
    v_mul_f32 v19, v19, v23
    v_fma_f32 v232, v232, v231, v231
    s_waitcnt lgkmcnt(2)
    v_mfma_f32_32x32x16_bf16 v[32:47], a[240:243], v[192:195], v[32:47]
    ds_read_b128 a[232:235], v226 offset:57344
    s_add_u32 s98, s87, 8192
    buffer_load_dwordx4 a[184:187], v224, s[4:7], s98 offen offset:3072 sc1
    v_fma_f32 v233, v233, v231, v231
    v_fma_f32 v234, v234, v231, v231
    v_fma_f32 v235, v235, v231, v231
    v_mfma_f32_32x32x16_bf16 v[32:47], a[244:247], v[196:199], v[32:47]
    ds_read_b128 a[236:239], v226 offset:58368
    v_rcp_f32 v232, v232
    v_rcp_f32 v233, v233
    s_waitcnt lgkmcnt(2)
    v_mfma_f32_32x32x16_bf16 v[32:47], a[248:251], v[200:203], v[32:47]
    ds_read_b128 a[240:243], v226 offset:59392
    s_add_u32 s98, s88, 8192
    buffer_load_dwordx4 a[188:191], v224, s[4:7], s98 offen offset:3072 sc1
    v_rcp_f32 v234, v234
    v_mfma_f32_32x32x16_bf16 v[32:47], a[252:255], v[204:207], v[32:47]
    ds_read_b128 a[244:247], v226 offset:60416
    v_rcp_f32 v235, v235
    v_mul_f32 v16, v16, v232
    v_mul_f32 v17, v17, v233
    s_waitcnt lgkmcnt(2)
    v_mfma_f32_32x32x16_bf16 v[32:47], a[232:235], v[208:211], v[32:47]
    v_mul_f32 v18, v18, v234
    v_mul_f32 v19, v19, v235
    v_cvt_pk_bf16_f32 v20, v16, v17
    v_mfma_f32_32x32x16_bf16 v[32:47], a[236:239], v[212:215], v[32:47]
    v_cvt_pk_bf16_f32 v21, v18, v19
    v_fmac_f32 v24, v229, v240
    v_fmac_f32 v25, v229, v241
    s_waitcnt lgkmcnt(0)
    v_mfma_f32_32x32x16_bf16 v[32:47], a[240:243], v[216:219], v[32:47]
    v_fmac_f32 v26, v229, v242
    v_fmac_f32 v27, v229, v243
    v_fmac_f32 v28, v229, v244
    v_mfma_f32_32x32x16_bf16 v[32:47], a[244:247], v[220:223], v[32:47]
    v_fmac_f32 v29, v229, v245
    v_fmac_f32 v30, v229, v246
    v_fmac_f32 v31, v229, v247
    v_lshrrev_b32 v249, 4, v224
    v_min_u32 v249, 3, v249
    s_lshl_b32 s75, s59, 2
    v_add_u32 v249, s75, v249
    v_lshlrev_b32 v249, 2, v249
    s_lshr_b32 s80, s68, 1
    s_lshl_b32 s80, s80, 2
    s_add_u32 s80, s80, s59
    s_lshl_b32 s80, s80, 7
    s_add_u32 s80, s80, 12288
    buffer_load_dword v250, v249, s[4:7], s80 offen sc1
    v_mul_f32 v240, v230, v24
    v_mul_f32 v241, v230, v25
    v_mul_f32 v242, v230, v26
    v_mul_f32 v243, v230, v27
    v_exp_f32 v240, v240
    v_mul_f32 v24, v24, v28
    v_exp_f32 v241, v241
    v_mul_f32 v25, v25, v29
    v_exp_f32 v242, v242
    v_mul_f32 v26, v26, v30
    v_exp_f32 v243, v243
    v_mul_f32 v27, v27, v31
    v_fma_f32 v240, v240, v231, v231
    v_fma_f32 v241, v241, v231, v231
    v_fma_f32 v242, v242, v231, v231
    v_fma_f32 v243, v243, v231, v231
    v_rcp_f32 v240, v240
    v_rcp_f32 v241, v241
    v_rcp_f32 v242, v242
    v_rcp_f32 v243, v243
    v_mul_f32 v24, v24, v240
    v_mul_f32 v25, v25, v241
    v_mul_f32 v26, v26, v242
    v_mul_f32 v27, v27, v243
    v_cvt_pk_bf16_f32 v22, v24, v25
    v_cvt_pk_bf16_f32 v23, v26, v27
    s_and_b32 s74, s65, 3
    s_lshl_b32 s74, s74, 10
    s_add_u32 s74, s74, s77
    s_add_u32 s74, s74, 8704
    buffer_store_dwordx4 v[20:23], v228, s[4:7], s74 offen offset:0 sc1
    ds_read_b128 v[232:235], v248 offset:768
    ds_read_b128 v[236:239], v248 offset:784
    ds_read_b128 v[240:243], v248 offset:800
    ds_read_b128 v[244:247], v248 offset:816
    s_waitcnt lgkmcnt(2)
    v_fmac_f32 v32, v229, v232
    v_fmac_f32 v33, v229, v233
    v_fmac_f32 v34, v229, v234
    v_fmac_f32 v35, v229, v235
    v_fmac_f32 v36, v229, v236
    v_fmac_f32 v37, v229, v237
    v_fmac_f32 v38, v229, v238
    v_fmac_f32 v39, v229, v239
    v_mul_f32 v232, v230, v32
    v_mul_f32 v233, v230, v33
    v_mul_f32 v234, v230, v34
    v_mul_f32 v235, v230, v35
    v_exp_f32 v232, v232
    v_mul_f32 v32, v32, v36
    v_exp_f32 v233, v233
    v_mul_f32 v33, v33, v37
    v_exp_f32 v234, v234
    v_mul_f32 v34, v34, v38
    v_exp_f32 v235, v235
    v_mul_f32 v35, v35, v39
    v_fma_f32 v232, v232, v231, v231
    v_fma_f32 v233, v233, v231, v231
    v_fma_f32 v234, v234, v231, v231
    v_fma_f32 v235, v235, v231, v231
    v_rcp_f32 v232, v232
    v_rcp_f32 v233, v233
    v_rcp_f32 v234, v234
    v_rcp_f32 v235, v235
    v_mul_f32 v32, v32, v232
    v_mul_f32 v33, v33, v233
    v_mul_f32 v34, v34, v234
    v_mul_f32 v35, v35, v235
    v_cvt_pk_bf16_f32 v36, v32, v33
    v_cvt_pk_bf16_f32 v37, v34, v35
    s_waitcnt lgkmcnt(0)
    v_fmac_f32 v40, v229, v240
    v_fmac_f32 v41, v229, v241
    v_fmac_f32 v42, v229, v242
    v_fmac_f32 v43, v229, v243
    v_fmac_f32 v44, v229, v244
    v_fmac_f32 v45, v229, v245
    v_fmac_f32 v46, v229, v246
    v_fmac_f32 v47, v229, v247
    v_mul_f32 v240, v230, v40
    v_mul_f32 v241, v230, v41
    v_mul_f32 v242, v230, v42
    v_mul_f32 v243, v230, v43
    v_exp_f32 v240, v240
    v_mul_f32 v40, v40, v44
    v_exp_f32 v241, v241
    v_mul_f32 v41, v41, v45
    v_exp_f32 v242, v242
    v_mul_f32 v42, v42, v46
    v_exp_f32 v243, v243
    v_mul_f32 v43, v43, v47
    v_fma_f32 v240, v240, v231, v231
    v_fma_f32 v241, v241, v231, v231
    v_fma_f32 v242, v242, v231, v231
    v_fma_f32 v243, v243, v231, v231
    v_rcp_f32 v240, v240
    v_rcp_f32 v241, v241
    v_rcp_f32 v242, v242
    v_rcp_f32 v243, v243
    v_mul_f32 v40, v40, v240
    v_mul_f32 v41, v41, v241
    v_mul_f32 v42, v42, v242
    v_mul_f32 v43, v43, v243
    v_cvt_pk_bf16_f32 v38, v40, v41
    v_cvt_pk_bf16_f32 v39, v42, v43
    s_and_b32 s74, s65, 3
    s_lshl_b32 s74, s74, 9
    s_add_u32 s74, s74, s77
    s_add_u32 s74, s74, 12288
    s_cmp_ge_u32 s65, 12
    s_cselect_b32 s75, 2147483648, 0
    v_or_b32 v254, s75, v228
    buffer_store_dwordx4 v[36:39], v254, s[4:7], s74 offen offset:0 sc1
    s_lshl_b32 s79, s64, 9
    s_lshl_b32 s75, s65, 2
    s_add_u32 s79, s79, s75
    s_add_u32 s79, s79, 12352
    v_mov_b32 v242, 2147483648
    s_cmp_eq_u32 s59, 3
    s_cselect_b32 s74, -1, 0
    v_and_b32 v242, s74, v242
    v_or_b32 v242, v242, v224
    v_lshrrev_b32 v244, 8, v224
    v_lshlrev_b32 v244, 8, v244
    v_bfe_u32 v243, v224, 4, 4
    v_lshl_add_u32 v243, v243, 3, v244
    s_lshl_b32 s75, s68, 1
    s_lshr_b32 s76, s59, 1
    s_add_u32 s75, s75, s76
    s_mul_i32 s75, s75, 40960
    s_mul_i32 s76, s69, 5120
    s_add_u32 s75, s75, s76
    s_and_b32 s76, s59, 1
    s_lshl_b32 s76, s76, 7
    s_add_u32 s94, s75, s76
    s_waitcnt vmcnt(2)
    v_cmp_ne_u32 vcc, s3, v250
    s_cbranch_vccnz L_spin_47
L_back_48:
    buffer_load_dwordx4 v[64:67], v224, s[4:7], s90 offen offset:0 sc1
    buffer_load_dwordx4 v[68:71], v224, s[4:7], s91 offen offset:0 sc1
    buffer_load_dwordx4 v[72:75], v224, s[4:7], s92 offen offset:0 sc1
    buffer_load_dwordx4 v[76:79], v224, s[4:7], s93 offen offset:0 sc1
    buffer_load_dwordx4 v[80:83], v224, s[4:7], s90 offen offset:1024 sc1
    buffer_load_dwordx4 v[84:87], v224, s[4:7], s91 offen offset:1024 sc1
    buffer_load_dwordx4 v[88:91], v224, s[4:7], s92 offen offset:1024 sc1
    buffer_load_dwordx4 v[92:95], v224, s[4:7], s93 offen offset:1024 sc1
    s_waitcnt vmcnt(8)
    s_barrier
    s_cmp_lg_u32 s59, 0
    s_cbranch_scc1 L_fs_49
    v_mbcnt_lo_u32_b32 v251, -1, 0
    v_mul_u32_u24 v251, 128, v251
    v_mov_b32 v252, s3
    s_mov_b64 exec, 15
    buffer_store_dword v252, v251, s[4:7], s79 offen sc1
    s_mov_b64 exec, -1
L_fs_49:
    buffer_load_dwordx4 v[96:99], v224, s[4:7], s90 offen offset:2048 sc1
    buffer_load_dwordx4 v[100:103], v224, s[4:7], s91 offen offset:2048 sc1
    buffer_load_dwordx4 v[104:107], v224, s[4:7], s92 offen offset:2048 sc1
    buffer_load_dwordx4 v[108:111], v224, s[4:7], s93 offen offset:2048 sc1
    buffer_load_dwordx4 v[112:115], v224, s[4:7], s90 offen offset:3072 sc1
    buffer_load_dwordx4 v[116:119], v224, s[4:7], s91 offen offset:3072 sc1
    buffer_load_dwordx4 v[120:123], v224, s[4:7], s92 offen offset:3072 sc1
    buffer_load_dwordx4 v[124:127], v224, s[4:7], s93 offen offset:3072 sc1
    s_waitcnt vmcnt(15)
    v_mfma_f32_16x16x32_bf16 v[144:147], a[0:3], v[64:67], 0
    s_add_u32 s90, s90, 4096
    buffer_load_dwordx4 v[128:131], v224, s[4:7], s90 offen offset:0 sc1
    v_mfma_f32_16x16x32_bf16 v[148:151], a[4:7], v[64:67], 0
    v_mfma_f32_16x16x32_bf16 v[152:155], a[8:11], v[64:67], 0
    s_add_u32 s74, s84, 4096
    buffer_load_dwordx4 v[0:3], v224, s[4:7], s74 offen offset:2048 sc1
    v_mfma_f32_16x16x32_bf16 v[156:159], a[12:15], v[64:67], 0
    v_mfma_f32_16x16x32_bf16 v[160:163], a[16:19], v[64:67], 0
    s_add_u32 s74, s85, 4096
    buffer_load_dwordx4 v[4:7], v224, s[4:7], s74 offen offset:2048 sc1
    s_waitcnt vmcnt(17)
    v_mfma_f32_16x16x32_bf16 v[164:167], a[0:3], v[68:71], 0
    s_add_u32 s91, s91, 4096
    buffer_load_dwordx4 v[132:135], v224, s[4:7], s91 offen offset:0 sc1
    v_mfma_f32_16x16x32_bf16 v[168:171], a[4:7], v[68:71], 0
    v_mfma_f32_16x16x32_bf16 v[172:175], a[8:11], v[68:71], 0
    s_add_u32 s74, s86, 4096
    buffer_load_dwordx4 v[8:11], v224, s[4:7], s74 offen offset:2048 sc1
    v_mfma_f32_16x16x32_bf16 v[176:179], a[12:15], v[68:71], 0
    v_mfma_f32_16x16x32_bf16 v[180:183], a[16:19], v[68:71], 0
    s_add_u32 s74, s87, 4096
    buffer_load_dwordx4 v[12:15], v224, s[4:7], s74 offen offset:2048 sc1
    s_waitcnt vmcnt(19)
    v_mfma_f32_16x16x32_bf16 v[184:187], a[0:3], v[72:75], 0
    s_add_u32 s92, s92, 4096
    buffer_load_dwordx4 v[136:139], v224, s[4:7], s92 offen offset:0 sc1
    v_mfma_f32_16x16x32_bf16 v[188:191], a[4:7], v[72:75], 0
    v_mfma_f32_16x16x32_bf16 v[192:195], a[8:11], v[72:75], 0
    s_add_u32 s74, s88, 4096
    buffer_load_dwordx4 v[16:19], v224, s[4:7], s74 offen offset:2048 sc1
    v_mfma_f32_16x16x32_bf16 v[196:199], a[12:15], v[72:75], 0
    v_mfma_f32_16x16x32_bf16 v[200:203], a[16:19], v[72:75], 0
    s_add_u32 s74, s84, 4096
    buffer_load_dwordx4 v[20:23], v224, s[4:7], s74 offen offset:3072 sc1
    s_waitcnt vmcnt(21)
    v_mfma_f32_16x16x32_bf16 v[204:207], a[0:3], v[76:79], 0
    s_add_u32 s93, s93, 4096
    buffer_load_dwordx4 v[140:143], v224, s[4:7], s93 offen offset:0 sc1
    v_mfma_f32_16x16x32_bf16 v[208:211], a[4:7], v[76:79], 0
    v_mfma_f32_16x16x32_bf16 v[212:215], a[8:11], v[76:79], 0
    s_add_u32 s74, s85, 4096
    buffer_load_dwordx4 v[24:27], v224, s[4:7], s74 offen offset:3072 sc1
    v_mfma_f32_16x16x32_bf16 v[216:219], a[12:15], v[76:79], 0
    v_mfma_f32_16x16x32_bf16 v[220:223], a[16:19], v[76:79], 0
    s_add_u32 s74, s86, 4096
    buffer_load_dwordx4 v[28:31], v224, s[4:7], s74 offen offset:3072 sc1
    s_waitcnt vmcnt(23)
    v_mfma_f32_16x16x32_bf16 v[144:147], a[20:23], v[80:83], v[144:147]
    buffer_load_dwordx4 v[64:67], v224, s[4:7], s90 offen offset:2048 sc1
    v_mfma_f32_16x16x32_bf16 v[148:151], a[24:27], v[80:83], v[148:151]
    v_mfma_f32_16x16x32_bf16 v[152:155], a[28:31], v[80:83], v[152:155]
    s_add_u32 s74, s87, 4096
    buffer_load_dwordx4 v[32:35], v224, s[4:7], s74 offen offset:3072 sc1
    v_mfma_f32_16x16x32_bf16 v[156:159], a[32:35], v[80:83], v[156:159]
    v_mfma_f32_16x16x32_bf16 v[160:163], a[36:39], v[80:83], v[160:163]
    s_add_u32 s74, s88, 4096
    buffer_load_dwordx4 v[36:39], v224, s[4:7], s74 offen offset:3072 sc1
    s_waitcnt vmcnt(25)
    v_mfma_f32_16x16x32_bf16 v[164:167], a[20:23], v[84:87], v[164:167]
    buffer_load_dwordx4 v[68:71], v224, s[4:7], s91 offen offset:2048 sc1
    v_mfma_f32_16x16x32_bf16 v[168:171], a[24:27], v[84:87], v[168:171]
    v_mfma_f32_16x16x32_bf16 v[172:175], a[28:31], v[84:87], v[172:175]
    s_add_u32 s74, s87, 4096
    buffer_load_dwordx4 v[40:43], v224, s[4:7], s74 offen offset:1024 sc1
    v_mfma_f32_16x16x32_bf16 v[176:179], a[32:35], v[84:87], v[176:179]
    v_mfma_f32_16x16x32_bf16 v[180:183], a[36:39], v[84:87], v[180:183]
    s_add_u32 s74, s88, 4096
    buffer_load_dwordx4 v[44:47], v224, s[4:7], s74 offen offset:1024 sc1
    s_waitcnt vmcnt(27)
    v_mfma_f32_16x16x32_bf16 v[184:187], a[20:23], v[88:91], v[184:187]
    buffer_load_dwordx4 v[72:75], v224, s[4:7], s92 offen offset:2048 sc1
    v_mfma_f32_16x16x32_bf16 v[188:191], a[24:27], v[88:91], v[188:191]
    v_mfma_f32_16x16x32_bf16 v[192:195], a[28:31], v[88:91], v[192:195]
    v_mfma_f32_16x16x32_bf16 v[196:199], a[32:35], v[88:91], v[196:199]
    v_mfma_f32_16x16x32_bf16 v[200:203], a[36:39], v[88:91], v[200:203]
    s_waitcnt vmcnt(27)
    v_mfma_f32_16x16x32_bf16 v[204:207], a[20:23], v[92:95], v[204:207]
    buffer_load_dwordx4 v[76:79], v224, s[4:7], s93 offen offset:2048 sc1
    v_mfma_f32_16x16x32_bf16 v[208:211], a[24:27], v[92:95], v[208:211]
    v_mfma_f32_16x16x32_bf16 v[212:215], a[28:31], v[92:95], v[212:215]
    v_mfma_f32_16x16x32_bf16 v[216:219], a[32:35], v[92:95], v[216:219]
    v_mfma_f32_16x16x32_bf16 v[220:223], a[36:39], v[92:95], v[220:223]
    s_waitcnt vmcnt(27)
    v_mfma_f32_16x16x32_bf16 v[144:147], a[40:43], v[96:99], v[144:147]
    buffer_load_dwordx4 v[80:83], v224, s[4:7], s90 offen offset:3072 sc1
    v_mfma_f32_16x16x32_bf16 v[148:151], a[44:47], v[96:99], v[148:151]
    v_mfma_f32_16x16x32_bf16 v[152:155], a[48:51], v[96:99], v[152:155]
    v_mfma_f32_16x16x32_bf16 v[156:159], a[52:55], v[96:99], v[156:159]
    v_mfma_f32_16x16x32_bf16 v[160:163], a[56:59], v[96:99], v[160:163]
    s_waitcnt vmcnt(27)
    v_mfma_f32_16x16x32_bf16 v[164:167], a[40:43], v[100:103], v[164:167]
    buffer_load_dwordx4 v[84:87], v224, s[4:7], s91 offen offset:3072 sc1
    v_mfma_f32_16x16x32_bf16 v[168:171], a[44:47], v[100:103], v[168:171]
    v_mfma_f32_16x16x32_bf16 v[172:175], a[48:51], v[100:103], v[172:175]
    v_mfma_f32_16x16x32_bf16 v[176:179], a[52:55], v[100:103], v[176:179]
    v_mfma_f32_16x16x32_bf16 v[180:183], a[56:59], v[100:103], v[180:183]
    s_waitcnt vmcnt(27)
    v_mfma_f32_16x16x32_bf16 v[184:187], a[40:43], v[104:107], v[184:187]
    buffer_load_dwordx4 v[88:91], v224, s[4:7], s92 offen offset:3072 sc1
    v_mfma_f32_16x16x32_bf16 v[188:191], a[44:47], v[104:107], v[188:191]
    v_mfma_f32_16x16x32_bf16 v[192:195], a[48:51], v[104:107], v[192:195]
    v_mfma_f32_16x16x32_bf16 v[196:199], a[52:55], v[104:107], v[196:199]
    v_mfma_f32_16x16x32_bf16 v[200:203], a[56:59], v[104:107], v[200:203]
    s_waitcnt vmcnt(27)
    v_mfma_f32_16x16x32_bf16 v[204:207], a[40:43], v[108:111], v[204:207]
    buffer_load_dwordx4 v[92:95], v224, s[4:7], s93 offen offset:3072 sc1
    v_mfma_f32_16x16x32_bf16 v[208:211], a[44:47], v[108:111], v[208:211]
    v_mfma_f32_16x16x32_bf16 v[212:215], a[48:51], v[108:111], v[212:215]
    v_mfma_f32_16x16x32_bf16 v[216:219], a[52:55], v[108:111], v[216:219]
    v_mfma_f32_16x16x32_bf16 v[220:223], a[56:59], v[108:111], v[220:223]
    s_waitcnt vmcnt(27)
    v_mfma_f32_16x16x32_bf16 v[144:147], a[60:63], v[112:115], v[144:147]
    buffer_load_dwordx4 v[96:99], v224, s[4:7], s90 offen offset:1024 sc1
    v_mfma_f32_16x16x32_bf16 v[148:151], a[64:67], v[112:115], v[148:151]
    v_mfma_f32_16x16x32_bf16 v[152:155], a[68:71], v[112:115], v[152:155]
    v_mfma_f32_16x16x32_bf16 v[156:159], a[72:75], v[112:115], v[156:159]
    v_mfma_f32_16x16x32_bf16 v[160:163], a[76:79], v[112:115], v[160:163]
    s_waitcnt vmcnt(27)
    v_mfma_f32_16x16x32_bf16 v[164:167], a[60:63], v[116:119], v[164:167]
    buffer_load_dwordx4 v[100:103], v224, s[4:7], s91 offen offset:1024 sc1
    v_mfma_f32_16x16x32_bf16 v[168:171], a[64:67], v[116:119], v[168:171]
    v_mfma_f32_16x16x32_bf16 v[172:175], a[68:71], v[116:119], v[172:175]
    v_mfma_f32_16x16x32_bf16 v[176:179], a[72:75], v[116:119], v[176:179]
    v_mfma_f32_16x16x32_bf16 v[180:183], a[76:79], v[116:119], v[180:183]
    s_waitcnt vmcnt(27)
    v_mfma_f32_16x16x32_bf16 v[184:187], a[60:63], v[120:123], v[184:187]
    buffer_load_dwordx4 v[104:107], v224, s[4:7], s92 offen offset:1024 sc1
    v_mfma_f32_16x16x32_bf16 v[188:191], a[64:67], v[120:123], v[188:191]
    v_mfma_f32_16x16x32_bf16 v[192:195], a[68:71], v[120:123], v[192:195]
    v_mfma_f32_16x16x32_bf16 v[196:199], a[72:75], v[120:123], v[196:199]
    v_mfma_f32_16x16x32_bf16 v[200:203], a[76:79], v[120:123], v[200:203]
    s_waitcnt vmcnt(27)
    v_mfma_f32_16x16x32_bf16 v[204:207], a[60:63], v[124:127], v[204:207]
    buffer_load_dwordx4 v[108:111], v224, s[4:7], s93 offen offset:1024 sc1
    v_mfma_f32_16x16x32_bf16 v[208:211], a[64:67], v[124:127], v[208:211]
    v_mfma_f32_16x16x32_bf16 v[212:215], a[68:71], v[124:127], v[212:215]
    v_mfma_f32_16x16x32_bf16 v[216:219], a[72:75], v[124:127], v[216:219]
    v_mfma_f32_16x16x32_bf16 v[220:223], a[76:79], v[124:127], v[220:223]
    s_waitcnt vmcnt(27)
    buffer_load_dword v250, v249, s[4:7], s80 offen offset:64 sc1
    v_mfma_f32_16x16x32_bf16 v[144:147], a[80:83], v[128:131], v[144:147]
    v_mfma_f32_16x16x32_bf16 v[148:151], a[84:87], v[128:131], v[148:151]
    v_mfma_f32_16x16x32_bf16 v[152:155], a[88:91], v[128:131], v[152:155]
    v_mfma_f32_16x16x32_bf16 v[156:159], a[92:95], v[128:131], v[156:159]
    v_mfma_f32_16x16x32_bf16 v[160:163], a[96:99], v[128:131], v[160:163]
    s_waitcnt vmcnt(25)
    v_mfma_f32_16x16x32_bf16 v[164:167], a[80:83], v[132:135], v[164:167]
    v_mfma_f32_16x16x32_bf16 v[168:171], a[84:87], v[132:135], v[168:171]
    v_mfma_f32_16x16x32_bf16 v[172:175], a[88:91], v[132:135], v[172:175]
    v_mfma_f32_16x16x32_bf16 v[176:179], a[92:95], v[132:135], v[176:179]
    v_mfma_f32_16x16x32_bf16 v[180:183], a[96:99], v[132:135], v[180:183]
    s_waitcnt vmcnt(22)
    v_mfma_f32_16x16x32_bf16 v[184:187], a[80:83], v[136:139], v[184:187]
    v_mfma_f32_16x16x32_bf16 v[188:191], a[84:87], v[136:139], v[188:191]
    v_mfma_f32_16x16x32_bf16 v[192:195], a[88:91], v[136:139], v[192:195]
    v_mfma_f32_16x16x32_bf16 v[196:199], a[92:95], v[136:139], v[196:199]
    v_mfma_f32_16x16x32_bf16 v[200:203], a[96:99], v[136:139], v[200:203]
    s_waitcnt vmcnt(19)
    v_mfma_f32_16x16x32_bf16 v[204:207], a[80:83], v[140:143], v[204:207]
    v_mfma_f32_16x16x32_bf16 v[208:211], a[84:87], v[140:143], v[208:211]
    v_mfma_f32_16x16x32_bf16 v[212:215], a[88:91], v[140:143], v[212:215]
    v_mfma_f32_16x16x32_bf16 v[216:219], a[92:95], v[140:143], v[216:219]
    v_mfma_f32_16x16x32_bf16 v[220:223], a[96:99], v[140:143], v[220:223]
    s_waitcnt vmcnt(16)
    v_mfma_f32_16x16x32_bf16 v[144:147], v[0:3], v[64:67], v[144:147]
    v_mfma_f32_16x16x32_bf16 v[148:151], v[4:7], v[64:67], v[148:151]
    v_mfma_f32_16x16x32_bf16 v[152:155], v[8:11], v[64:67], v[152:155]
    v_mfma_f32_16x16x32_bf16 v[156:159], v[12:15], v[64:67], v[156:159]
    v_mfma_f32_16x16x32_bf16 v[160:163], v[16:19], v[64:67], v[160:163]
    s_waitcnt vmcnt(13)
    v_mfma_f32_16x16x32_bf16 v[164:167], v[0:3], v[68:71], v[164:167]
    v_mfma_f32_16x16x32_bf16 v[168:171], v[4:7], v[68:71], v[168:171]
    v_mfma_f32_16x16x32_bf16 v[172:175], v[8:11], v[68:71], v[172:175]
    v_mfma_f32_16x16x32_bf16 v[176:179], v[12:15], v[68:71], v[176:179]
    v_mfma_f32_16x16x32_bf16 v[180:183], v[16:19], v[68:71], v[180:183]
    s_waitcnt vmcnt(10)
    v_mfma_f32_16x16x32_bf16 v[184:187], v[0:3], v[72:75], v[184:187]
    v_mfma_f32_16x16x32_bf16 v[188:191], v[4:7], v[72:75], v[188:191]
    v_mfma_f32_16x16x32_bf16 v[192:195], v[8:11], v[72:75], v[192:195]
    v_mfma_f32_16x16x32_bf16 v[196:199], v[12:15], v[72:75], v[196:199]
    v_mfma_f32_16x16x32_bf16 v[200:203], v[16:19], v[72:75], v[200:203]
    s_waitcnt vmcnt(9)
    v_mfma_f32_16x16x32_bf16 v[204:207], v[0:3], v[76:79], v[204:207]
    v_mfma_f32_16x16x32_bf16 v[208:211], v[4:7], v[76:79], v[208:211]
    v_mfma_f32_16x16x32_bf16 v[212:215], v[8:11], v[76:79], v[212:215]
    v_mfma_f32_16x16x32_bf16 v[216:219], v[12:15], v[76:79], v[216:219]
    v_mfma_f32_16x16x32_bf16 v[220:223], v[16:19], v[76:79], v[220:223]
    s_waitcnt vmcnt(8)
    s_waitcnt vmcnt(0)
    v_cmp_ne_u32 vcc, s3, v250
    s_cbranch_vccnz L_spin_50
L_back_51:
    s_add_u32 s90, s90, 4096
    buffer_load_dwordx4 v[112:115], v224, s[4:7], s90 offen offset:0 sc1
    s_add_u32 s91, s91, 4096
    buffer_load_dwordx4 v[116:119], v224, s[4:7], s91 offen offset:0 sc1
    s_add_u32 s92, s92, 4096
    buffer_load_dwordx4 v[120:123], v224, s[4:7], s92 offen offset:0 sc1
    s_add_u32 s93, s93, 4096
    buffer_load_dwordx4 v[124:127], v224, s[4:7], s93 offen offset:0 sc1
    buffer_load_dwordx4 v[128:131], v224, s[4:7], s90 offen offset:1024 sc1
    buffer_load_dwordx4 v[132:135], v224, s[4:7], s91 offen offset:1024 sc1
    buffer_load_dwordx4 v[136:139], v224, s[4:7], s92 offen offset:1024 sc1
    buffer_load_dwordx4 v[140:143], v224, s[4:7], s93 offen offset:1024 sc1
    v_mfma_f32_16x16x32_bf16 v[144:147], v[20:23], v[80:83], v[144:147]
    buffer_load_dwordx4 v[64:67], v224, s[4:7], s90 offen offset:2048 sc1
    v_mfma_f32_16x16x32_bf16 v[148:151], v[24:27], v[80:83], v[148:151]
    v_mfma_f32_16x16x32_bf16 v[152:155], v[28:31], v[80:83], v[152:155]
    v_mfma_f32_16x16x32_bf16 v[156:159], v[32:35], v[80:83], v[156:159]
    v_mfma_f32_16x16x32_bf16 v[160:163], v[36:39], v[80:83], v[160:163]
    v_mfma_f32_16x16x32_bf16 v[164:167], v[20:23], v[84:87], v[164:167]
    buffer_load_dwordx4 v[68:71], v224, s[4:7], s91 offen offset:2048 sc1
    v_mfma_f32_16x16x32_bf16 v[168:171], v[24:27], v[84:87], v[168:171]
    v_mfma_f32_16x16x32_bf16 v[172:175], v[28:31], v[84:87], v[172:175]
    v_mfma_f32_16x16x32_bf16 v[176:179], v[32:35], v[84:87], v[176:179]
    v_mfma_f32_16x16x32_bf16 v[180:183], v[36:39], v[84:87], v[180:183]
    v_mfma_f32_16x16x32_bf16 v[184:187], v[20:23], v[88:91], v[184:187]
    buffer_load_dwordx4 v[72:75], v224, s[4:7], s92 offen offset:2048 sc1
    v_mfma_f32_16x16x32_bf16 v[188:191], v[24:27], v[88:91], v[188:191]
    v_mfma_f32_16x16x32_bf16 v[192:195], v[28:31], v[88:91], v[192:195]
    v_mfma_f32_16x16x32_bf16 v[196:199], v[32:35], v[88:91], v[196:199]
    v_mfma_f32_16x16x32_bf16 v[200:203], v[36:39], v[88:91], v[200:203]
    v_mfma_f32_16x16x32_bf16 v[204:207], v[20:23], v[92:95], v[204:207]
    buffer_load_dwordx4 v[76:79], v224, s[4:7], s93 offen offset:2048 sc1
    v_mfma_f32_16x16x32_bf16 v[208:211], v[24:27], v[92:95], v[208:211]
    v_mfma_f32_16x16x32_bf16 v[212:215], v[28:31], v[92:95], v[212:215]
    v_mfma_f32_16x16x32_bf16 v[216:219], v[32:35], v[92:95], v[216:219]
    v_mfma_f32_16x16x32_bf16 v[220:223], v[36:39], v[92:95], v[220:223]
    v_mfma_f32_16x16x32_bf16 v[144:147], a[100:103], v[96:99], v[144:147]
    buffer_load_dwordx4 v[80:83], v224, s[4:7], s90 offen offset:3072 sc1
    v_mfma_f32_16x16x32_bf16 v[148:151], a[104:107], v[96:99], v[148:151]
    v_mfma_f32_16x16x32_bf16 v[152:155], a[108:111], v[96:99], v[152:155]
    v_mfma_f32_16x16x32_bf16 v[156:159], v[40:43], v[96:99], v[156:159]
    v_mfma_f32_16x16x32_bf16 v[160:163], v[44:47], v[96:99], v[160:163]
    v_mfma_f32_16x16x32_bf16 v[164:167], a[100:103], v[100:103], v[164:167]
    buffer_load_dwordx4 v[84:87], v224, s[4:7], s91 offen offset:3072 sc1
    v_mfma_f32_16x16x32_bf16 v[168:171], a[104:107], v[100:103], v[168:171]
    v_mfma_f32_16x16x32_bf16 v[172:175], a[108:111], v[100:103], v[172:175]
    v_mfma_f32_16x16x32_bf16 v[176:179], v[40:43], v[100:103], v[176:179]
    v_mfma_f32_16x16x32_bf16 v[180:183], v[44:47], v[100:103], v[180:183]
    v_mfma_f32_16x16x32_bf16 v[184:187], a[100:103], v[104:107], v[184:187]
    buffer_load_dwordx4 v[88:91], v224, s[4:7], s92 offen offset:3072 sc1
    v_mfma_f32_16x16x32_bf16 v[188:191], a[104:107], v[104:107], v[188:191]
    v_mfma_f32_16x16x32_bf16 v[192:195], a[108:111], v[104:107], v[192:195]
    v_mfma_f32_16x16x32_bf16 v[196:199], v[40:43], v[104:107], v[196:199]
    v_mfma_f32_16x16x32_bf16 v[200:203], v[44:47], v[104:107], v[200:203]
    v_mfma_f32_16x16x32_bf16 v[204:207], a[100:103], v[108:111], v[204:207]
    buffer_load_dwordx4 v[92:95], v224, s[4:7], s93 offen offset:3072 sc1
    v_mfma_f32_16x16x32_bf16 v[208:211], a[104:107], v[108:111], v[208:211]
    v_mfma_f32_16x16x32_bf16 v[212:215], a[108:111], v[108:111], v[212:215]
    v_mfma_f32_16x16x32_bf16 v[216:219], v[40:43], v[108:111], v[216:219]
    v_mfma_f32_16x16x32_bf16 v[220:223], v[44:47], v[108:111], v[220:223]
    s_waitcnt vmcnt(15)
    v_mfma_f32_16x16x32_bf16 v[144:147], a[112:115], v[112:115], v[144:147]
    s_add_u32 s91, s91, 4096
    buffer_load_dwordx4 v[100:103], v242, s[4:7], s91 offen offset:0 sc1
    v_mfma_f32_16x16x32_bf16 v[148:151], a[116:119], v[112:115], v[148:151]
    v_mfma_f32_16x16x32_bf16 v[152:155], a[120:123], v[112:115], v[152:155]
    v_mfma_f32_16x16x32_bf16 v[156:159], a[124:127], v[112:115], v[156:159]
    v_mfma_f32_16x16x32_bf16 v[160:163], a[128:131], v[112:115], v[160:163]
    s_waitcnt vmcnt(15)
    v_mfma_f32_16x16x32_bf16 v[164:167], a[112:115], v[116:119], v[164:167]
    v_mfma_f32_16x16x32_bf16 v[168:171], a[116:119], v[116:119], v[168:171]
    v_mfma_f32_16x16x32_bf16 v[172:175], a[120:123], v[116:119], v[172:175]
    v_mfma_f32_16x16x32_bf16 v[176:179], a[124:127], v[116:119], v[176:179]
    v_mfma_f32_16x16x32_bf16 v[180:183], a[128:131], v[116:119], v[180:183]
    s_waitcnt vmcnt(14)
    v_mfma_f32_16x16x32_bf16 v[184:187], a[112:115], v[120:123], v[184:187]
    buffer_load_dwordx4 v[116:119], v242, s[4:7], s91 offen offset:1024 sc1
    v_mfma_f32_16x16x32_bf16 v[188:191], a[116:119], v[120:123], v[188:191]
    v_mfma_f32_16x16x32_bf16 v[192:195], a[120:123], v[120:123], v[192:195]
    s_add_u32 s92, s92, 4096
    buffer_load_dwordx4 v[104:107], v242, s[4:7], s92 offen offset:0 sc1
    v_mfma_f32_16x16x32_bf16 v[196:199], a[124:127], v[120:123], v[196:199]
    v_mfma_f32_16x16x32_bf16 v[200:203], a[128:131], v[120:123], v[200:203]
    s_waitcnt vmcnt(15)
    v_mfma_f32_16x16x32_bf16 v[204:207], a[112:115], v[124:127], v[204:207]
    buffer_load_dwordx4 v[120:123], v242, s[4:7], s92 offen offset:1024 sc1
    v_mfma_f32_16x16x32_bf16 v[208:211], a[116:119], v[124:127], v[208:211]
    v_mfma_f32_16x16x32_bf16 v[212:215], a[120:123], v[124:127], v[212:215]
    v_mfma_f32_16x16x32_bf16 v[216:219], a[124:127], v[124:127], v[216:219]
    v_mfma_f32_16x16x32_bf16 v[220:223], a[128:131], v[124:127], v[220:223]
    s_waitcnt vmcnt(15)
    v_mfma_f32_16x16x32_bf16 v[144:147], a[132:135], v[128:131], v[144:147]
    s_add_u32 s93, s93, 4096
    buffer_load_dwordx4 v[108:111], v242, s[4:7], s93 offen offset:0 sc1
    v_mfma_f32_16x16x32_bf16 v[148:151], a[136:139], v[128:131], v[148:151]
    v_mfma_f32_16x16x32_bf16 v[152:155], a[140:143], v[128:131], v[152:155]
    v_mfma_f32_16x16x32_bf16 v[156:159], a[144:147], v[128:131], v[156:159]
    v_mfma_f32_16x16x32_bf16 v[160:163], a[148:151], v[128:131], v[160:163]
    s_waitcnt vmcnt(15)
    v_mfma_f32_16x16x32_bf16 v[164:167], a[132:135], v[132:135], v[164:167]
    buffer_load_dwordx4 v[124:127], v242, s[4:7], s93 offen offset:1024 sc1
    v_mfma_f32_16x16x32_bf16 v[168:171], a[136:139], v[132:135], v[168:171]
    v_mfma_f32_16x16x32_bf16 v[172:175], a[140:143], v[132:135], v[172:175]
    v_mfma_f32_16x16x32_bf16 v[176:179], a[144:147], v[132:135], v[176:179]
    v_mfma_f32_16x16x32_bf16 v[180:183], a[148:151], v[132:135], v[180:183]
    s_waitcnt vmcnt(15)
    v_mfma_f32_16x16x32_bf16 v[184:187], a[132:135], v[136:139], v[184:187]
    s_add_u32 s90, s90, 4096
    buffer_load_dwordx4 v[96:99], v242, s[4:7], s90 offen offset:0 sc1
    v_mfma_f32_16x16x32_bf16 v[188:191], a[136:139], v[136:139], v[188:191]
    v_mfma_f32_16x16x32_bf16 v[192:195], a[140:143], v[136:139], v[192:195]
    v_mfma_f32_16x16x32_bf16 v[196:199], a[144:147], v[136:139], v[196:199]
    v_mfma_f32_16x16x32_bf16 v[200:203], a[148:151], v[136:139], v[200:203]
    s_waitcnt vmcnt(15)
    v_mfma_f32_16x16x32_bf16 v[204:207], a[132:135], v[140:143], v[204:207]
    buffer_load_dwordx4 v[112:115], v242, s[4:7], s90 offen offset:1024 sc1
    v_mfma_f32_16x16x32_bf16 v[208:211], a[136:139], v[140:143], v[208:211]
    v_mfma_f32_16x16x32_bf16 v[212:215], a[140:143], v[140:143], v[212:215]
    v_mfma_f32_16x16x32_bf16 v[216:219], a[144:147], v[140:143], v[216:219]
    v_mfma_f32_16x16x32_bf16 v[220:223], a[148:151], v[140:143], v[220:223]
    s_waitcnt vmcnt(15)
    v_mfma_f32_16x16x32_bf16 v[144:147], a[152:155], v[64:67], v[144:147]
    s_add_u32 s95, s94, 8912896
    buffer_load_dwordx2 v[232:233], v243, s[4:7], s95 offen offset:0 sc1
    v_mfma_f32_16x16x32_bf16 v[148:151], a[156:159], v[64:67], v[148:151]
    v_mfma_f32_16x16x32_bf16 v[152:155], a[160:163], v[64:67], v[152:155]
    v_mfma_f32_16x16x32_bf16 v[156:159], a[164:167], v[64:67], v[156:159]
    buffer_load_dwordx2 v[234:235], v243, s[4:7], s95 offen offset:1024 sc1
    v_mfma_f32_16x16x32_bf16 v[160:163], a[168:171], v[64:67], v[160:163]
    s_waitcnt vmcnt(16)
    v_mfma_f32_16x16x32_bf16 v[164:167], a[152:155], v[68:71], v[164:167]
    buffer_load_dwordx2 v[236:237], v243, s[4:7], s95 offen offset:2048 sc1
    v_mfma_f32_16x16x32_bf16 v[168:171], a[156:159], v[68:71], v[168:171]
    v_mfma_f32_16x16x32_bf16 v[172:175], a[160:163], v[68:71], v[172:175]
    v_mfma_f32_16x16x32_bf16 v[176:179], a[164:167], v[68:71], v[176:179]
    buffer_load_dwordx2 v[238:239], v243, s[4:7], s95 offen offset:3072 sc1
    v_mfma_f32_16x16x32_bf16 v[180:183], a[168:171], v[68:71], v[180:183]
    s_waitcnt vmcnt(17)
    v_mfma_f32_16x16x32_bf16 v[184:187], a[152:155], v[72:75], v[184:187]
    s_add_u32 s95, s95, 4096
    buffer_load_dwordx2 v[240:241], v243, s[4:7], s95 offen offset:0 sc1
    v_mfma_f32_16x16x32_bf16 v[188:191], a[156:159], v[72:75], v[188:191]
    v_mfma_f32_16x16x32_bf16 v[192:195], a[160:163], v[72:75], v[192:195]
    v_mfma_f32_16x16x32_bf16 v[196:199], a[164:167], v[72:75], v[196:199]
    s_add_u32 s95, s94, 11534336
    buffer_load_dwordx2 v[48:49], v243, s[4:7], s95 offen offset:0 sc1
    v_mfma_f32_16x16x32_bf16 v[200:203], a[168:171], v[72:75], v[200:203]
    s_waitcnt vmcnt(18)
    v_mfma_f32_16x16x32_bf16 v[204:207], a[152:155], v[76:79], v[204:207]
    buffer_load_dwordx2 v[50:51], v243, s[4:7], s95 offen offset:1024 sc1
    v_mfma_f32_16x16x32_bf16 v[208:211], a[156:159], v[76:79], v[208:211]
    v_mfma_f32_16x16x32_bf16 v[212:215], a[160:163], v[76:79], v[212:215]
    v_mfma_f32_16x16x32_bf16 v[216:219], a[164:167], v[76:79], v[216:219]
    buffer_load_dwordx2 v[52:53], v243, s[4:7], s95 offen offset:2048 sc1
    v_mfma_f32_16x16x32_bf16 v[220:223], a[168:171], v[76:79], v[220:223]
    s_waitcnt vmcnt(19)
    v_mfma_f32_16x16x32_bf16 v[144:147], a[172:175], v[80:83], v[144:147]
    buffer_load_dwordx2 v[54:55], v243, s[4:7], s95 offen offset:3072 sc1
    s_add_u32 s96, s59, 1
    s_and_b32 s96, s96, 3
    v_mfma_f32_16x16x32_bf16 v[148:151], a[176:179], v[80:83], v[148:151]
    s_mul_i32 s96, s96, 3
    s_add_u32 s96, s96, 0
    v_mfma_f32_16x16x32_bf16 v[152:155], a[180:183], v[80:83], v[152:155]
    s_lshl_b32 s97, s96, 10
    s_add_u32 s98, s97, 118784
    v_mfma_f32_16x16x32_bf16 v[156:159], a[184:187], v[80:83], v[156:159]
    s_add_u32 s95, s95, 4096
    buffer_load_dwordx2 v[56:57], v243, s[4:7], s95 offen offset:0 sc1
    v_add_u32 v128, s98, v224
    s_add_u32 s98, s97, 36864
    v_mfma_f32_16x16x32_bf16 v[160:163], a[188:191], v[80:83], v[160:163]
    s_add_u32 s99, s97, 147456
    s_cmp_lt_u32 s96, 8
    s_waitcnt vmcnt(20)
    v_mfma_f32_16x16x32_bf16 v[164:167], a[172:175], v[84:87], v[164:167]
    s_cselect_b32 s98, s98, s99
    v_add_u32 v129, s98, v224
    v_mfma_f32_16x16x32_bf16 v[168:171], a[176:179], v[84:87], v[168:171]
    s_add_u32 s98, s97, 77824
    s_add_u32 s99, s97, 4294959104
    v_mfma_f32_16x16x32_bf16 v[172:175], a[180:183], v[84:87], v[172:175]
    s_cmp_lt_u32 s96, 8
    s_cselect_b32 s98, s98, s99
    v_mfma_f32_16x16x32_bf16 v[176:179], a[184:187], v[84:87], v[176:179]
    v_add_u32 v130, s98, v224
    s_add_u32 s96, s59, 2
    v_mfma_f32_16x16x32_bf16 v[180:183], a[188:191], v[84:87], v[180:183]
    s_and_b32 s96, s96, 3
    s_mul_i32 s96, s96, 3
    s_waitcnt vmcnt(19)
    v_mfma_f32_16x16x32_bf16 v[184:187], a[172:175], v[88:91], v[184:187]
    s_add_u32 s96, s96, 1
    s_lshl_b32 s97, s96, 10
    v_mfma_f32_16x16x32_bf16 v[188:191], a[176:179], v[88:91], v[188:191]
    s_add_u32 s98, s97, 118784
    v_add_u32 v131, s98, v224
    v_mfma_f32_16x16x32_bf16 v[192:195], a[180:183], v[88:91], v[192:195]
    s_add_u32 s98, s97, 36864
    s_add_u32 s99, s97, 147456
    v_mfma_f32_16x16x32_bf16 v[196:199], a[184:187], v[88:91], v[196:199]
    s_cmp_lt_u32 s96, 8
    s_cselect_b32 s98, s98, s99
    v_mfma_f32_16x16x32_bf16 v[200:203], a[188:191], v[88:91], v[200:203]
    v_add_u32 v132, s98, v224
    s_add_u32 s98, s97, 77824
    s_waitcnt vmcnt(18)
    v_mfma_f32_16x16x32_bf16 v[204:207], a[172:175], v[92:95], v[204:207]
    s_add_u32 s99, s97, 4294959104
    s_cmp_lt_u32 s96, 8
    v_mfma_f32_16x16x32_bf16 v[208:211], a[176:179], v[92:95], v[208:211]
    s_cselect_b32 s98, s98, s99
    v_add_u32 v133, s98, v224
    v_mfma_f32_16x16x32_bf16 v[212:215], a[180:183], v[92:95], v[212:215]
    s_add_u32 s96, s59, 3
    s_and_b32 s96, s96, 3
    v_mfma_f32_16x16x32_bf16 v[216:219], a[184:187], v[92:95], v[216:219]
    s_mul_i32 s96, s96, 3
    s_add_u32 s96, s96, 2
    v_mfma_f32_16x16x32_bf16 v[220:223], a[188:191], v[92:95], v[220:223]
    s_lshl_b32 s97, s96, 10
    s_add_u32 s98, s97, 118784
    s_waitcnt vmcnt(17)
    v_mfma_f32_16x16x32_bf16 v[164:167], a[192:195], v[100:103], v[164:167]
    v_add_u32 v134, s98, v224
    s_add_u32 s98, s97, 36864
    v_mfma_f32_16x16x32_bf16 v[168:171], a[196:199], v[100:103], v[168:171]
    s_add_u32 s99, s97, 147456
    s_cmp_lt_u32 s96, 8
    v_mfma_f32_16x16x32_bf16 v[172:175], a[200:203], v[100:103], v[172:175]
    s_cselect_b32 s98, s98, s99
    v_add_u32 v135, s98, v224
    v_mfma_f32_16x16x32_bf16 v[176:179], a[204:207], v[100:103], v[176:179]
    s_add_u32 s98, s97, 77824
    s_add_u32 s99, s97, 4294959104
    v_mfma_f32_16x16x32_bf16 v[180:183], a[208:211], v[100:103], v[180:183]
    s_cmp_lt_u32 s96, 8
    s_cselect_b32 s98, s98, s99
    s_waitcnt vmcnt(16)
    v_mfma_f32_16x16x32_bf16 v[164:167], a[212:215], v[116:119], v[164:167]
    v_add_u32 v136, s98, v224
    s_mul_i32 s96, s59, 3
    v_mfma_f32_16x16x32_bf16 v[168:171], a[216:219], v[116:119], v[168:171]
    s_add_u32 s96, s96, 0
    s_lshl_b32 s97, s96, 10
    v_mfma_f32_16x16x32_bf16 v[172:175], a[220:223], v[116:119], v[172:175]
    s_add_u32 s98, s97, 118784
    v_add_u32 v137, s98, v224
    v_mfma_f32_16x16x32_bf16 v[176:179], a[224:227], v[116:119], v[176:179]
    s_add_u32 s98, s97, 36864
    s_add_u32 s99, s97, 147456
    v_mfma_f32_16x16x32_bf16 v[180:183], a[228:231], v[116:119], v[180:183]
    s_cmp_lt_u32 s96, 8
    s_cselect_b32 s98, s98, s99
    s_waitcnt vmcnt(15)
    v_mfma_f32_16x16x32_bf16 v[184:187], a[192:195], v[104:107], v[184:187]
    ds_write_b128 v128, v[164:167] offset:0
    v_add_u32 v138, s98, v224
    s_add_u32 s98, s97, 77824
    v_mfma_f32_16x16x32_bf16 v[188:191], a[196:199], v[104:107], v[188:191]
    s_add_u32 s99, s97, 4294959104
    s_cmp_lt_u32 s96, 8
    v_mfma_f32_16x16x32_bf16 v[192:195], a[200:203], v[104:107], v[192:195]
    ds_write_b128 v128, v[168:171] offset:12288
    s_cselect_b32 s98, s98, s99
    v_add_u32 v141, s98, v224
    v_mfma_f32_16x16x32_bf16 v[196:199], a[204:207], v[104:107], v[196:199]
    s_mul_i32 s96, s59, 3
    s_add_u32 s96, s96, 1
    v_mfma_f32_16x16x32_bf16 v[200:203], a[208:211], v[104:107], v[200:203]
    ds_write_b128 v128, v[172:175] offset:24576
    s_lshl_b32 s97, s96, 10
    s_add_u32 s98, s97, 36864
    s_waitcnt vmcnt(14)
    v_mfma_f32_16x16x32_bf16 v[184:187], a[212:215], v[120:123], v[184:187]
    s_add_u32 s99, s97, 147456
    s_cmp_lt_u32 s96, 8
    v_mfma_f32_16x16x32_bf16 v[188:191], a[216:219], v[120:123], v[188:191]
    ds_write_b128 v129, v[176:179]
    s_cselect_b32 s98, s98, s99
    v_add_u32 v139, s98, v224
    v_mfma_f32_16x16x32_bf16 v[192:195], a[220:223], v[120:123], v[192:195]
    s_add_u32 s98, s97, 77824
    s_add_u32 s99, s97, 4294959104
    v_mfma_f32_16x16x32_bf16 v[196:199], a[224:227], v[120:123], v[196:199]
    ds_write_b128 v130, v[180:183]
    s_cmp_lt_u32 s96, 8
    s_cselect_b32 s98, s98, s99
    v_mfma_f32_16x16x32_bf16 v[200:203], a[228:231], v[120:123], v[200:203]
    v_add_u32 v142, s98, v224
    s_mul_i32 s96, s59, 3
    s_waitcnt vmcnt(13)
    v_mfma_f32_16x16x32_bf16 v[204:207], a[192:195], v[108:111], v[204:207]
    ds_write_b128 v131, v[184:187] offset:0
    s_add_u32 s96, s96, 2
    s_lshl_b32 s97, s96, 10
    v_mfma_f32_16x16x32_bf16 v[208:211], a[196:199], v[108:111], v[208:211]
    s_add_u32 s98, s97, 36864
    s_add_u32 s99, s97, 147456
    v_mfma_f32_16x16x32_bf16 v[212:215], a[200:203], v[108:111], v[212:215]
    ds_write_b128 v131, v[188:191] offset:12288
    s_cmp_lt_u32 s96, 8
    s_cselect_b32 s98, s98, s99
    v_mfma_f32_16x16x32_bf16 v[216:219], a[204:207], v[108:111], v[216:219]
    v_add_u32 v140, s98, v224
    s_add_u32 s98, s97, 77824
    v_mfma_f32_16x16x32_bf16 v[220:223], a[208:211], v[108:111], v[220:223]
    ds_write_b128 v131, v[192:195] offset:24576
    s_add_u32 s99, s97, 4294959104
    s_cmp_lt_u32 s96, 8
    s_waitcnt vmcnt(12)
    v_mfma_f32_16x16x32_bf16 v[204:207], a[212:215], v[124:127], v[204:207]
    s_cselect_b32 s98, s98, s99
    v_add_u32 v143, s98, v224
    v_mfma_f32_16x16x32_bf16 v[208:211], a[216:219], v[124:127], v[208:211]
    ds_write_b128 v132, v[196:199]
    v_mfma_f32_16x16x32_bf16 v[212:215], a[220:223], v[124:127], v[212:215]
    v_mfma_f32_16x16x32_bf16 v[216:219], a[224:227], v[124:127], v[216:219]
    ds_write_b128 v133, v[200:203]
    v_mfma_f32_16x16x32_bf16 v[220:223], a[228:231], v[124:127], v[220:223]
    s_waitcnt vmcnt(11)
    v_mfma_f32_16x16x32_bf16 v[144:147], a[192:195], v[96:99], v[144:147]
    ds_write_b128 v134, v[204:207] offset:0
    v_mfma_f32_16x16x32_bf16 v[148:151], a[196:199], v[96:99], v[148:151]
    v_mfma_f32_16x16x32_bf16 v[152:155], a[200:203], v[96:99], v[152:155]
    ds_write_b128 v134, v[208:211] offset:12288
    v_mfma_f32_16x16x32_bf16 v[156:159], a[204:207], v[96:99], v[156:159]
    v_mfma_f32_16x16x32_bf16 v[160:163], a[208:211], v[96:99], v[160:163]
    ds_write_b128 v134, v[212:215] offset:24576
    s_waitcnt vmcnt(10)
    v_mfma_f32_16x16x32_bf16 v[144:147], a[212:215], v[112:115], v[144:147]
    v_mfma_f32_16x16x32_bf16 v[148:151], a[216:219], v[112:115], v[148:151]
    ds_write_b128 v135, v[216:219]
    v_mfma_f32_16x16x32_bf16 v[152:155], a[220:223], v[112:115], v[152:155]
    v_mfma_f32_16x16x32_bf16 v[156:159], a[224:227], v[112:115], v[156:159]
    ds_write_b128 v136, v[220:223]
    v_mfma_f32_16x16x32_bf16 v[160:163], a[228:231], v[112:115], v[160:163]
    s_waitcnt lgkmcnt(0)
    s_barrier
    ds_read_b128 v[64:67], v137 offset:0
    ds_read_b128 v[68:71], v137 offset:1024
    ds_read_b128 v[72:75], v137 offset:2048
    ds_read_b128 v[76:79], v137 offset:12288
    ds_read_b128 v[80:83], v137 offset:13312
    ds_read_b128 v[84:87], v137 offset:14336
    ds_read_b128 v[88:91], v137 offset:24576
    ds_read_b128 v[92:95], v137 offset:25600
    ds_read_b128 v[96:99], v137 offset:26624
    ds_read_b128 v[100:103], v138
    ds_read_b128 v[104:107], v139
    ds_read_b128 v[108:111], v140
    ds_read_b128 v[112:115], v141
    ds_read_b128 v[116:119], v142
    ds_read_b128 v[120:123], v143
    s_waitcnt vmcnt(5)
    s_mov_b32 s78, 0xffff0000
    s_waitcnt lgkmcnt(12)
    v_pk_add_f32 v[64:65], v[64:65], v[68:69]
    v_pk_add_f32 v[66:67], v[66:67], v[70:71]
    v_pk_add_f32 v[144:145], v[144:145], v[72:73]
    v_pk_add_f32 v[146:147], v[146:147], v[74:75]
    v_pk_add_f32 v[144:145], v[144:145], v[64:65]
    v_pk_add_f32 v[146:147], v[146:147], v[66:67]
    s_nop 1
    v_permlane32_swap_b32 v144, v146
    v_permlane32_swap_b32 v145, v147
    s_nop 1
    v_permlane16_swap_b32 v144, v145
    v_permlane16_swap_b32 v146, v147
    v_lshlrev_b32 v64, 16, v232
    v_and_b32 v65, s78, v232
    v_lshlrev_b32 v66, 16, v233
    v_and_b32 v67, s78, v233
    v_pk_add_f32 v[144:145], v[144:145], v[64:65]
    v_pk_add_f32 v[146:147], v[146:147], v[66:67]
    v_cvt_pk_bf16_f32 v204, v144, v145
    v_cvt_pk_bf16_f32 v205, v146, v147
    s_waitcnt lgkmcnt(9)
    v_pk_add_f32 v[76:77], v[76:77], v[80:81]
    v_pk_add_f32 v[78:79], v[78:79], v[82:83]
    v_pk_add_f32 v[148:149], v[148:149], v[84:85]
    v_pk_add_f32 v[150:151], v[150:151], v[86:87]
    v_pk_add_f32 v[148:149], v[148:149], v[76:77]
    v_pk_add_f32 v[150:151], v[150:151], v[78:79]
    s_nop 1
    v_permlane32_swap_b32 v148, v150
    v_permlane32_swap_b32 v149, v151
    s_nop 1
    v_permlane16_swap_b32 v148, v149
    v_permlane16_swap_b32 v150, v151
    v_lshlrev_b32 v76, 16, v234
    v_and_b32 v77, s78, v234
    v_lshlrev_b32 v78, 16, v235
    v_and_b32 v79, s78, v235
    v_pk_add_f32 v[148:149], v[148:149], v[76:77]
    v_pk_add_f32 v[150:151], v[150:151], v[78:79]
    v_cvt_pk_bf16_f32 v206, v148, v149
    v_cvt_pk_bf16_f32 v207, v150, v151
    s_waitcnt lgkmcnt(6)
    v_pk_add_f32 v[88:89], v[88:89], v[92:93]
    v_pk_add_f32 v[90:91], v[90:91], v[94:95]
    v_pk_add_f32 v[152:153], v[152:153], v[96:97]
    v_pk_add_f32 v[154:155], v[154:155], v[98:99]
    v_pk_add_f32 v[152:153], v[152:153], v[88:89]
    v_pk_add_f32 v[154:155], v[154:155], v[90:91]
    s_nop 1
    v_permlane32_swap_b32 v152, v154
    v_permlane32_swap_b32 v153, v155
    s_nop 1
    v_permlane16_swap_b32 v152, v153
    v_permlane16_swap_b32 v154, v155
    v_lshlrev_b32 v88, 16, v236
    v_and_b32 v89, s78, v236
    v_lshlrev_b32 v90, 16, v237
    v_and_b32 v91, s78, v237
    v_pk_add_f32 v[152:153], v[152:153], v[88:89]
    v_pk_add_f32 v[154:155], v[154:155], v[90:91]
    v_cvt_pk_bf16_f32 v208, v152, v153
    v_cvt_pk_bf16_f32 v209, v154, v155
    s_waitcnt lgkmcnt(3)
    v_pk_add_f32 v[100:101], v[100:101], v[104:105]
    v_pk_add_f32 v[102:103], v[102:103], v[106:107]
    v_pk_add_f32 v[156:157], v[156:157], v[108:109]
    v_pk_add_f32 v[158:159], v[158:159], v[110:111]
    v_pk_add_f32 v[156:157], v[156:157], v[100:101]
    v_pk_add_f32 v[158:159], v[158:159], v[102:103]
    s_nop 1
    v_permlane32_swap_b32 v156, v158
    v_permlane32_swap_b32 v157, v159
    s_nop 1
    v_permlane16_swap_b32 v156, v157
    v_permlane16_swap_b32 v158, v159
    v_lshlrev_b32 v100, 16, v238
    v_and_b32 v101, s78, v238
    v_lshlrev_b32 v102, 16, v239
    v_and_b32 v103, s78, v239
    v_pk_add_f32 v[156:157], v[156:157], v[100:101]
    v_pk_add_f32 v[158:159], v[158:159], v[102:103]
    v_cvt_pk_bf16_f32 v210, v156, v157
    v_cvt_pk_bf16_f32 v211, v158, v159
    s_waitcnt lgkmcnt(0)
    v_pk_add_f32 v[112:113], v[112:113], v[116:117]
    v_pk_add_f32 v[114:115], v[114:115], v[118:119]
    v_pk_add_f32 v[160:161], v[160:161], v[120:121]
    v_pk_add_f32 v[162:163], v[162:163], v[122:123]
    v_pk_add_f32 v[160:161], v[160:161], v[112:113]
    v_pk_add_f32 v[162:163], v[162:163], v[114:115]
    s_nop 1
    v_permlane32_swap_b32 v160, v162
    v_permlane32_swap_b32 v161, v163
    s_nop 1
    v_permlane16_swap_b32 v160, v161
    v_permlane16_swap_b32 v162, v163
    v_lshlrev_b32 v112, 16, v240
    v_and_b32 v113, s78, v240
    v_lshlrev_b32 v114, 16, v241
    v_and_b32 v115, s78, v241
    v_pk_add_f32 v[160:161], v[160:161], v[112:113]
    v_pk_add_f32 v[162:163], v[162:163], v[114:115]
    v_cvt_pk_bf16_f32 v212, v160, v161
    v_cvt_pk_bf16_f32 v213, v162, v163
    s_mov_b32 s75, 0x3f803f80
    v_dot2_f32_bf16 v244, v204, s75, 0
    v_dot2_f32_bf16 v246, v204, v204, 0
    v_dot2_f32_bf16 v244, v205, s75, v244
    v_dot2_f32_bf16 v246, v205, v205, v246
    v_dot2_f32_bf16 v244, v206, s75, v244
    v_dot2_f32_bf16 v246, v206, v206, v246
    v_dot2_f32_bf16 v244, v207, s75, v244
    v_dot2_f32_bf16 v246, v207, v207, v246
    v_dot2_f32_bf16 v244, v208, s75, v244
    v_dot2_f32_bf16 v246, v208, v208, v246
    v_dot2_f32_bf16 v244, v209, s75, v244
    v_dot2_f32_bf16 v246, v209, v209, v246
    v_dot2_f32_bf16 v244, v210, s75, v244
    v_dot2_f32_bf16 v246, v210, v210, v246
    v_dot2_f32_bf16 v244, v211, s75, v244
    v_dot2_f32_bf16 v246, v211, v211, v246
    v_dot2_f32_bf16 v244, v212, s75, v244
    v_dot2_f32_bf16 v246, v212, v212, v246
    v_dot2_f32_bf16 v244, v213, s75, v244
    v_dot2_f32_bf16 v246, v213, v213, v246
    s_nop 1
    v_mov_b32 v58, v244
    v_mov_b32 v59, v246
    s_nop 0
    v_permlane16_swap_b32 v58, v244
    v_permlane16_swap_b32 v59, v246
    v_add_f32 v244, v244, v58
    v_add_f32 v246, v246, v59
    v_mov_b32 v58, v244
    v_mov_b32 v59, v246
    s_nop 0
    v_permlane32_swap_b32 v58, v244
    v_permlane32_swap_b32 v59, v246
    v_add_f32 v244, v244, v58
    v_add_f32 v246, v246, v59
    v_mov_b32 v245, s3
    v_mov_b32 v247, s3
    v_and_b32 v58, 0xf0, v224
    s_lshl_b32 s74, s68, 13
    s_lshl_b32 s75, s59, 8
    s_add_u32 s74, s74, s75
    s_add_u32 s79, s74, 131072
    s_lshl_b32 s75, s69, 10
    s_add_u32 s74, s79, s75
    s_mov_b64 exec, 0xffff
    s_cmp_eq_u32 s89, 0
    s_cbranch_scc1 L_mg_52
    buffer_store_dwordx4 v[244:247], v58, s[4:7], s74 offen
L_mb_53:
    s_mov_b64 exec, -1
    v_lshrrev_b32 v59, 8, v224
    v_lshl_add_u32 v58, v59, 11, v58
    buffer_load_dwordx4 v[64:67], v58, s[4:7], s79 offen sc1
    buffer_load_dwordx4 v[68:71], v58, s[4:7], s79 offen offset:1024 sc1
    s_waitcnt vmcnt(3)
    v_lshlrev_b32 v84, 16, v204
    v_and_b32 v85, s78, v204
    v_lshlrev_b32 v104, 16, v48
    v_and_b32 v105, s78, v48
    v_lshlrev_b32 v86, 16, v205
    v_and_b32 v87, s78, v205
    v_lshlrev_b32 v106, 16, v49
    v_and_b32 v107, s78, v49
    v_lshlrev_b32 v88, 16, v206
    v_and_b32 v89, s78, v206
    v_lshlrev_b32 v108, 16, v50
    v_and_b32 v109, s78, v50
    v_lshlrev_b32 v90, 16, v207
    v_and_b32 v91, s78, v207
    v_lshlrev_b32 v110, 16, v51
    v_and_b32 v111, s78, v51
    v_lshlrev_b32 v92, 16, v208
    v_and_b32 v93, s78, v208
    v_lshlrev_b32 v112, 16, v52
    v_and_b32 v113, s78, v52
    v_lshlrev_b32 v94, 16, v209
    v_and_b32 v95, s78, v209
    v_lshlrev_b32 v114, 16, v53
    v_and_b32 v115, s78, v53
    v_lshlrev_b32 v96, 16, v210
    v_and_b32 v97, s78, v210
    v_lshlrev_b32 v116, 16, v54
    v_and_b32 v117, s78, v54
    v_lshlrev_b32 v98, 16, v211
    v_and_b32 v99, s78, v211
    v_lshlrev_b32 v118, 16, v55
    v_and_b32 v119, s78, v55
    v_lshlrev_b32 v100, 16, v212
    v_and_b32 v101, s78, v212
    v_lshlrev_b32 v120, 16, v56
    v_and_b32 v121, s78, v56
    v_lshlrev_b32 v102, 16, v213
    v_and_b32 v103, s78, v213
    v_lshlrev_b32 v122, 16, v57
    v_and_b32 v123, s78, v57
    v_bfe_u32 v60, v224, 4, 1
    v_lshlrev_b32 v61, 3, v60
    v_sub_u32 v61, v243, v61
    v_lshl_add_u32 v61, v60, 10, v61
    s_waitcnt vmcnt(0)
    v_xor_b32 v250, s3, v65
    v_xor_b32 v251, s3, v67
    v_xor_b32 v252, s3, v69
    v_xor_b32 v253, s3, v71
    v_or3_b32 v250, v250, v251, v252
    v_or_b32 v250, v250, v253
    v_cmp_ne_u32 vcc, 0, v250
    s_cbranch_vccnz L_spin_54
L_back_55:
    v_add_f32 v64, v64, v68
    v_add_f32 v66, v66, v70
    v_mov_b32 v250, v64
    v_mov_b32 v251, v66
    s_nop 0
    v_permlane16_swap_b32 v250, v64
    v_permlane16_swap_b32 v251, v66
    v_add_f32 v64, v64, v250
    v_add_f32 v66, v66, v251
    v_mov_b32 v250, v64
    v_mov_b32 v251, v66
    s_nop 0
    v_permlane32_swap_b32 v250, v64
    v_permlane32_swap_b32 v251, v66
    v_add_f32 v64, v64, v250
    v_add_f32 v66, v66, v251
    s_mov_b32 s74, 0x3acccccd
    s_mov_b32 s75, 0x3727c5ac
    v_mul_f32 v64, s74, v64
    v_mul_f32 v66, s74, v66
    v_fma_f32 v66, -v64, v64, v66
    v_max_f32 v66, 0, v66
    v_add_f32 v66, s75, v66
    v_rsq_f32 v66, v66
    s_nop 0
    v_mul_f32 v64, v64, v66
    v_sub_f32 v64, 0, v64
    v_pk_fma_f32 v[124:125], v[84:85], v[66:67], v[64:65] op_sel_hi:[1,0,0]
    v_pk_fma_f32 v[126:127], v[86:87], v[66:67], v[64:65] op_sel_hi:[1,0,0]
    v_pk_fma_f32 v[128:129], v[88:89], v[66:67], v[64:65] op_sel_hi:[1,0,0]
    v_pk_fma_f32 v[130:131], v[90:91], v[66:67], v[64:65] op_sel_hi:[1,0,0]
    v_pk_fma_f32 v[132:133], v[92:93], v[66:67], v[64:65] op_sel_hi:[1,0,0]
    v_pk_fma_f32 v[134:135], v[94:95], v[66:67], v[64:65] op_sel_hi:[1,0,0]
    v_pk_fma_f32 v[136:137], v[96:97], v[66:67], v[64:65] op_sel_hi:[1,0,0]
    v_pk_fma_f32 v[138:139], v[98:99], v[66:67], v[64:65] op_sel_hi:[1,0,0]
    v_pk_fma_f32 v[140:141], v[100:101], v[66:67], v[64:65] op_sel_hi:[1,0,0]
    v_pk_fma_f32 v[142:143], v[102:103], v[66:67], v[64:65] op_sel_hi:[1,0,0]
    v_pk_fma_f32 v[84:85], v[124:125], v[104:105], v[84:85]
    v_pk_fma_f32 v[86:87], v[126:127], v[106:107], v[86:87]
    v_pk_fma_f32 v[88:89], v[128:129], v[108:109], v[88:89]
    v_pk_fma_f32 v[90:91], v[130:131], v[110:111], v[90:91]
    v_pk_fma_f32 v[92:93], v[132:133], v[112:113], v[92:93]
    v_pk_fma_f32 v[94:95], v[134:135], v[114:115], v[94:95]
    v_pk_fma_f32 v[96:97], v[136:137], v[116:117], v[96:97]
    v_pk_fma_f32 v[98:99], v[138:139], v[118:119], v[98:99]
    v_pk_fma_f32 v[100:101], v[140:141], v[120:121], v[100:101]
    v_pk_fma_f32 v[102:103], v[142:143], v[122:123], v[102:103]
    v_cvt_pk_bf16_f32 v204, v84, v85
    v_cvt_pk_bf16_f32 v205, v86, v87
    v_cvt_pk_bf16_f32 v206, v88, v89
    v_cvt_pk_bf16_f32 v207, v90, v91
    v_cvt_pk_bf16_f32 v208, v92, v93
    v_cvt_pk_bf16_f32 v209, v94, v95
    v_cvt_pk_bf16_f32 v210, v96, v97
    v_cvt_pk_bf16_f32 v211, v98, v99
    v_cvt_pk_bf16_f32 v212, v100, v101
    v_cvt_pk_bf16_f32 v213, v102, v103
    v_cmp_eq_u32 vcc, 0, v60
    s_add_u32 s75, s94, 14155776
    s_add_u32 s76, s75, 4096
    v_cndmask_b32 v250, v204, v206, vcc
    v_cndmask_b32 v251, v205, v207, vcc
    s_nop 0
    v_cndmask_b32_dpp v216, v250, v204, vcc quad_perm:[1,0,3,2] row_mask:0xf bank_mask:0xf
    v_cndmask_b32_dpp v217, v251, v205, vcc quad_perm:[1,0,3,2] row_mask:0xf bank_mask:0xf
    s_not_b64 vcc, vcc
    s_nop 1
    v_cndmask_b32_dpp v218, v250, v206, vcc quad_perm:[1,0,3,2] row_mask:0xf bank_mask:0xf
    v_cndmask_b32_dpp v219, v251, v207, vcc quad_perm:[1,0,3,2] row_mask:0xf bank_mask:0xf
    s_not_b64 vcc, vcc
    s_nop 1
    buffer_store_dwordx4 v[216:219], v61, s[4:7], s75 offen offset:0 sc1
    v_cndmask_b32 v250, v208, v210, vcc
    v_cndmask_b32 v251, v209, v211, vcc
    s_nop 0
    v_cndmask_b32_dpp v220, v250, v208, vcc quad_perm:[1,0,3,2] row_mask:0xf bank_mask:0xf
    v_cndmask_b32_dpp v221, v251, v209, vcc quad_perm:[1,0,3,2] row_mask:0xf bank_mask:0xf
    s_not_b64 vcc, vcc
    s_nop 1
    v_cndmask_b32_dpp v222, v250, v210, vcc quad_perm:[1,0,3,2] row_mask:0xf bank_mask:0xf
    v_cndmask_b32_dpp v223, v251, v211, vcc quad_perm:[1,0,3,2] row_mask:0xf bank_mask:0xf
    s_not_b64 vcc, vcc
    s_nop 1
    buffer_store_dwordx4 v[220:223], v61, s[4:7], s75 offen offset:2048 sc1
    v_mov_b32_dpp v214, v212 quad_perm:[1,0,3,2] row_mask:0xf bank_mask:0xf
    v_mov_b32_dpp v215, v213 quad_perm:[1,0,3,2] row_mask:0xf bank_mask:0xf
    s_mov_b32 exec_lo, 0x55555555
    s_mov_b32 exec_hi, 0x55555555
    buffer_store_dwordx4 v[212:215], v61, s[4:7], s76 offen sc1
    s_mov_b64 exec, -1
    s_lshr_b32 s74, s68, 1
    s_lshl_b32 s74, s74, 9
    s_and_b32 s75, s68, 1
    s_lshl_b32 s75, s75, 3
    s_add_u32 s75, s75, s69
    s_lshl_b32 s75, s75, 2
    s_add_u32 s74, s74, s75
    s_add_u32 s79, s74, 49152
    s_lshl_b32 s80, s64, 2
    s_and_b32 s75, s65, 3
    s_add_u32 s80, s80, s75
    s_lshl_b32 s80, s80, 7
    s_add_u32 s80, s80, 49152
    v_lshrrev_b32 v249, 4, v224
    v_min_u32 v249, 15, v249
    v_lshlrev_b32 v249, 2, v249
    s_waitcnt vmcnt(0)
    s_barrier
    s_cmp_lg_u32 s59, 0
    s_cbranch_scc1 L_fs_56
    v_mbcnt_lo_u32_b32 v250, -1, 0
    v_mul_u32_u24 v250, 128, v250
    v_mov_b32 v251, s3
    s_mov_b64 exec, 15
    buffer_store_dword v251, v250, s[4:7], s79 offen sc1
    s_mov_b64 exec, -1
L_fs_56:
    s_cmp_eq_u32 s59, 1
    s_cbranch_scc1 L_nd_57
    s_mov_b32 s74, 36864
    s_mov_b32 s75, 196608
    s_cmp_eq_u32 s59, 2
    s_cselect_b32 s74, 77824, s74
    s_cselect_b32 s75, 237568, s75
    s_cmp_eq_u32 s59, 3
    s_cselect_b32 s74, 118784, s74
    s_cselect_b32 s75, 278528, s75
    s_add_u32 s75, s75, s67
    s_mov_b32 m0, s74
    s_nop 0
    buffer_load_dwordx4 v224, s[4:7], s75 offen offset:0 sc1 lds
    buffer_load_dwordx4 v224, s[4:7], s75 offen offset:1024 sc1 lds
    buffer_load_dwordx4 v224, s[4:7], s75 offen offset:2048 sc1 lds
    buffer_load_dwordx4 v224, s[4:7], s75 offen offset:3072 sc1 lds
    s_mov_b32 s74, 40960
    s_mov_b32 s75, 200704
    s_cmp_eq_u32 s59, 2
    s_cselect_b32 s74, 81920, s74
    s_cselect_b32 s75, 241664, s75
    s_cmp_eq_u32 s59, 3
    s_cselect_b32 s74, 122880, s74
    s_cselect_b32 s75, 282624, s75
    s_add_u32 s75, s75, s67
    s_mov_b32 m0, s74
    s_nop 0
    buffer_load_dwordx4 v224, s[4:7], s75 offen offset:0 sc1 lds
    buffer_load_dwordx4 v224, s[4:7], s75 offen offset:1024 sc1 lds
    buffer_load_dwordx4 v224, s[4:7], s75 offen offset:2048 sc1 lds
    buffer_load_dwordx4 v224, s[4:7], s75 offen offset:3072 sc1 lds
    s_waitcnt vmcnt(0)
L_nd_57:
    s_cmp_lg_u32 s59, 1
    s_cbranch_scc1 L_pw_58
    buffer_load_dword v250, v249, s[4:7], s80 offen sc1
    s_waitcnt vmcnt(0)
    v_cmp_ne_u32 vcc, s3, v250
    s_cbranch_vccnz L_spin_59
L_back_60:
L_pw_58:
    s_barrier
    s_lshl_b32 s72, s64, 2
    s_add_u32 s72, s72, s59
    s_mul_i32 s72, s72, 40960
    s_add_u32 s72, s72, 14155776
    buffer_load_dwordx4 v[64:67], v224, s[4:7], s72 offen offset:0 sc1
    buffer_load_dwordx4 v[68:71], v224, s[4:7], s72 offen offset:1024 sc1
    buffer_load_dwordx4 v[72:75], v224, s[4:7], s72 offen offset:2048 sc1
    buffer_load_dwordx4 v[76:79], v224, s[4:7], s72 offen offset:3072 sc1
    v_lshrrev_b32 v250, 6, v224
    v_lshlrev_b32 v250, 8, v250
    v_and_b32 v251, 0x30, v224
    v_or_b32 v250, v250, v251
    v_mov_b32 v252, 2147483648
    v_cmp_le_u32 vcc, 0x200, v224
    s_nop 1
    v_cndmask_b32 v251, 0, v252, vcc
    v_or_b32 v251, v251, v250
    s_lshr_b32 s74, s65, 2
    s_lshl_b32 s75, s64, 2
    s_add_u32 s74, s74, s75
    s_mul_i32 s74, s74, 40960
    s_and_b32 s75, s65, 3
    s_lshl_b32 s75, s75, 6
    s_add_u32 s74, s74, s75
    s_mul_i32 s75, s59, 10240
    s_add_u32 s74, s74, s75
    s_add_u32 s74, s74, 14155776
    buffer_load_dwordx4 v[232:235], v250, s[4:7], s74 offen sc1
    s_add_u32 s74, s74, 4096
    buffer_load_dwordx4 v[236:239], v250, s[4:7], s74 offen sc1
    s_add_u32 s74, s74, 4096
    buffer_load_dwordx4 v[240:243], v251, s[4:7], s74 offen sc1
    s_add_u32 s72, s72, 4096
    buffer_load_dwordx4 v[80:83], v224, s[4:7], s72 offen offset:0 sc1
    buffer_load_dwordx4 v[84:87], v224, s[4:7], s72 offen offset:1024 sc1
    buffer_load_dwordx4 v[88:91], v224, s[4:7], s72 offen offset:2048 sc1
    buffer_load_dwordx4 v[92:95], v224, s[4:7], s72 offen offset:3072 sc1
    s_add_u32 s72, s72, 4096
    buffer_load_dwordx4 v[96:99], v224, s[4:7], s72 offen offset:0 sc1
    buffer_load_dwordx4 v[100:103], v224, s[4:7], s72 offen offset:1024 sc1
    buffer_load_dwordx4 v[104:107], v224, s[4:7], s72 offen offset:2048 sc1
    buffer_load_dwordx4 v[108:111], v224, s[4:7], s72 offen offset:3072 sc1
    s_add_u32 s72, s72, 4096
    buffer_load_dwordx4 v[112:115], v224, s[4:7], s72 offen offset:0 sc1
    buffer_load_dwordx4 v[116:119], v224, s[4:7], s72 offen offset:1024 sc1
    buffer_load_dwordx4 v[120:123], v224, s[4:7], s72 offen offset:2048 sc1
    buffer_load_dwordx4 v[124:127], v224, s[4:7], s72 offen offset:3072 sc1
    ds_read_b128 a[232:235], v225 offset:4096
    ds_read_b128 a[236:239], v225 offset:45056
    ds_read_b128 a[240:243], v226 offset:20480
    ds_read_b128 a[244:247], v225 offset:5120
    s_lshl_b32 s75, s64, 2
    s_add_u32 s75, s75, s59
    s_mul_i32 s75, s75, 110592
    s_lshr_b32 s76, s65, 2
    s_mul_i32 s76, s76, 14336
    s_add_u32 s75, s75, s76
    s_add_u32 s77, s75, 30932992
    s_add_u32 s82, s71, 4096
    s_sub_u32 s83, s71, 4096
    s_cmp_eq_u32 s59, 0
    s_cselect_b32 s83, 159744, s83
    s_add_u32 s83, s83, s67
    s_mov_b32 s78, 0xffff0000
    s_waitcnt vmcnt(18)
    v_permlane16_swap_b32 v64, v66
    v_permlane16_swap_b32 v65, v67
    s_waitcnt lgkmcnt(2)
    s_nop 0
    v_mfma_f32_32x32x16_bf16 v[0:15], a[232:235], v[64:67], 0
    ds_read_b128 a[248:251], v225 offset:46080
    s_add_u32 s72, s72, 4096
    buffer_load_dwordx4 v[128:131], v224, s[4:7], s72 offen offset:0 sc1
    v_mfma_f32_32x32x16_bf16 v[16:31], a[236:239], v[64:67], 0
    ds_read_b128 a[252:255], v226 offset:21504
    s_waitcnt vmcnt(18)
    v_permlane16_swap_b32 v68, v70
    v_permlane16_swap_b32 v69, v71
    s_waitcnt lgkmcnt(2)
    v_mfma_f32_32x32x16_bf16 v[32:47], a[240:243], v[64:67], 0
    ds_read_b128 a[232:235], v225 offset:6144
    v_mfma_f32_32x32x16_bf16 v[0:15], a[244:247], v[68:71], v[0:15]
    ds_read_b128 a[236:239], v225 offset:47104
    buffer_load_dwordx4 v[132:135], v224, s[4:7], s72 offen offset:1024 sc1
    s_waitcnt lgkmcnt(2)
    v_mfma_f32_32x32x16_bf16 v[16:31], a[248:251], v[68:71], v[16:31]
    ds_read_b128 a[240:243], v226 offset:22528
    s_waitcnt vmcnt(18)
    v_permlane16_swap_b32 v72, v74
    v_permlane16_swap_b32 v73, v75
    v_mfma_f32_32x32x16_bf16 v[32:47], a[252:255], v[68:71], v[32:47]
    ds_read_b128 a[244:247], v225 offset:7168
    s_waitcnt lgkmcnt(2)
    v_mfma_f32_32x32x16_bf16 v[0:15], a[232:235], v[72:75], v[0:15]
    ds_read_b128 a[248:251], v225 offset:48128
    buffer_load_dwordx4 v[136:139], v224, s[4:7], s72 offen offset:2048 sc1
    v_mfma_f32_32x32x16_bf16 v[16:31], a[236:239], v[72:75], v[16:31]
    ds_read_b128 a[252:255], v226 offset:23552
    s_waitcnt vmcnt(18)
    v_permlane16_swap_b32 v76, v78
    v_permlane16_swap_b32 v77, v79
    s_waitcnt lgkmcnt(2)
    v_mfma_f32_32x32x16_bf16 v[32:47], a[240:243], v[72:75], v[32:47]
    ds_read_b128 a[232:235], v225 offset:8192
    v_mfma_f32_32x32x16_bf16 v[0:15], a[244:247], v[76:79], v[0:15]
    ds_read_b128 a[236:239], v225 offset:49152
    buffer_load_dwordx4 v[140:143], v224, s[4:7], s72 offen offset:3072 sc1
    s_waitcnt vmcnt(16)
    v_lshlrev_b32 v250, 16, v232
    v_and_b32 v251, s78, v232
    s_waitcnt lgkmcnt(2)
    v_mfma_f32_32x32x16_bf16 v[16:31], a[248:251], v[76:79], v[16:31]
    ds_read_b128 a[240:243], v226 offset:24576
    s_waitcnt vmcnt(15)
    v_permlane16_swap_b32 v80, v82
    v_permlane16_swap_b32 v81, v83
    v_add_f32 v244, v250, v251
    v_mul_f32 v245, v250, v250
    v_mfma_f32_32x32x16_bf16 v[32:47], a[252:255], v[76:79], v[32:47]
    ds_read_b128 a[244:247], v225 offset:9216
    v_fmac_f32 v245, v251, v251
    v_lshlrev_b32 v250, 16, v233
    v_and_b32 v251, s78, v233
    v_add_f32 v244, v244, v250
    s_waitcnt lgkmcnt(2)
    v_mfma_f32_32x32x16_bf16 v[0:15], a[232:235], v[80:83], v[0:15]
    ds_read_b128 a[248:251], v225 offset:50176
    s_add_u32 s72, s72, 4096
    buffer_load_dwordx4 v[144:147], v224, s[4:7], s72 offen offset:0 sc1
    v_fmac_f32 v245, v250, v250
    v_add_f32 v244, v244, v251
    v_fmac_f32 v245, v251, v251
    v_lshlrev_b32 v250, 16, v234
    v_mfma_f32_32x32x16_bf16 v[16:31], a[236:239], v[80:83], v[16:31]
    ds_read_b128 a[252:255], v226 offset:25600
    s_waitcnt vmcnt(15)
    v_permlane16_swap_b32 v84, v86
    v_permlane16_swap_b32 v85, v87
    v_and_b32 v251, s78, v234
    s_waitcnt lgkmcnt(2)
    v_mfma_f32_32x32x16_bf16 v[32:47], a[240:243], v[80:83], v[32:47]
    ds_read_b128 a[232:235], v225 offset:10240
    v_add_f32 v246, v250, v251
    v_mul_f32 v247, v250, v250
    v_fmac_f32 v247, v251, v251
    v_lshlrev_b32 v250, 16, v235
    v_and_b32 v251, s78, v235
    v_mfma_f32_32x32x16_bf16 v[0:15], a[244:247], v[84:87], v[0:15]
    ds_read_b128 a[236:239], v225 offset:51200
    buffer_load_dwordx4 v[148:151], v224, s[4:7], s72 offen offset:1024 sc1
    v_add_f32 v246, v246, v250
    v_fmac_f32 v247, v250, v250
    v_add_f32 v246, v246, v251
    s_waitcnt lgkmcnt(2)
    v_mfma_f32_32x32x16_bf16 v[16:31], a[248:251], v[84:87], v[16:31]
    ds_read_b128 a[240:243], v226 offset:26624
    s_waitcnt vmcnt(15)
    v_permlane16_swap_b32 v88, v90
    v_permlane16_swap_b32 v89, v91
    v_fmac_f32 v247, v251, v251
    v_lshlrev_b32 v250, 16, v236
    v_mfma_f32_32x32x16_bf16 v[32:47], a[252:255], v[84:87], v[32:47]
    ds_read_b128 a[244:247], v225 offset:11264
    v_and_b32 v251, s78, v236
    v_add_f32 v244, v244, v250
    v_fmac_f32 v245, v250, v250
    v_add_f32 v244, v244, v251
    s_waitcnt lgkmcnt(2)
    v_mfma_f32_32x32x16_bf16 v[0:15], a[232:235], v[88:91], v[0:15]
    ds_read_b128 a[248:251], v225 offset:52224
    buffer_load_dwordx4 v[152:155], v224, s[4:7], s72 offen offset:2048 sc1
    v_fmac_f32 v245, v251, v251
    v_lshlrev_b32 v250, 16, v237
    v_and_b32 v251, s78, v237
    v_add_f32 v244, v244, v250
    v_mfma_f32_32x32x16_bf16 v[16:31], a[236:239], v[88:91], v[16:31]
    ds_read_b128 a[252:255], v226 offset:27648
    s_waitcnt vmcnt(15)
    v_permlane16_swap_b32 v92, v94
    v_permlane16_swap_b32 v93, v95
    v_fmac_f32 v245, v250, v250
    s_waitcnt lgkmcnt(2)
    v_mfma_f32_32x32x16_bf16 v[32:47], a[240:243], v[88:91], v[32:47]
    ds_read_b128 a[232:235], v225 offset:12288
    v_add_f32 v244, v244, v251
    v_fmac_f32 v245, v251, v251
    v_lshlrev_b32 v250, 16, v238
    v_and_b32 v251, s78, v238
    v_add_f32 v246, v246, v250
    v_mfma_f32_32x32x16_bf16 v[0:15], a[244:247], v[92:95], v[0:15]
    ds_read_b128 a[236:239], v225 offset:53248
    buffer_load_dwordx4 v[156:159], v224, s[4:7], s72 offen offset:3072 sc1
    v_fmac_f32 v247, v250, v250
    v_add_f32 v246, v246, v251
    v_fmac_f32 v247, v251, v251
    s_waitcnt lgkmcnt(2)
    v_mfma_f32_32x32x16_bf16 v[16:31], a[248:251], v[92:95], v[16:31]
    ds_read_b128 a[240:243], v226 offset:28672
    s_waitcnt vmcnt(15)
    v_permlane16_swap_b32 v96, v98
    v_permlane16_swap_b32 v97, v99
    v_lshlrev_b32 v250, 16, v239
    v_and_b32 v251, s78, v239
    v_mfma_f32_32x32x16_bf16 v[32:47], a[252:255], v[92:95], v[32:47]
    ds_read_b128 a[244:247], v225 offset:13312
    v_add_f32 v246, v246, v250
    v_fmac_f32 v247, v250, v250
    v_add_f32 v246, v246, v251
    v_fmac_f32 v247, v251, v251
    s_waitcnt lgkmcnt(2)
    v_mfma_f32_32x32x16_bf16 v[0:15], a[232:235], v[96:99], v[0:15]
    ds_read_b128 a[248:251], v225 offset:54272
    s_add_u32 s72, s72, 4096
    buffer_load_dwordx4 v[160:163], v224, s[4:7], s72 offen offset:0 sc1
    v_lshlrev_b32 v250, 16, v240
    v_and_b32 v251, s78, v240
    v_add_f32 v244, v244, v250
    v_fmac_f32 v245, v250, v250
    v_mfma_f32_32x32x16_bf16 v[16:31], a[236:239], v[96:99], v[16:31]
    ds_read_b128 a[252:255], v226 offset:29696
    s_waitcnt vmcnt(15)
    v_permlane16_swap_b32 v100, v102
    v_permlane16_swap_b32 v101, v103
    v_add_f32 v244, v244, v251
    s_waitcnt lgkmcnt(2)
    v_mfma_f32_32x32x16_bf16 v[32:47], a[240:243], v[96:99], v[32:47]
    ds_read_b128 a[232:235], v225 offset:14336
    v_fmac_f32 v245, v251, v251
    v_lshlrev_b32 v250, 16, v241
    v_and_b32 v251, s78, v241
    v_add_f32 v244, v244, v250
    v_fmac_f32 v245, v250, v250
    v_mfma_f32_32x32x16_bf16 v[0:15], a[244:247], v[100:103], v[0:15]
    ds_read_b128 a[236:239], v225 offset:55296
    buffer_load_dwordx4 v[164:167], v224, s[4:7], s72 offen offset:1024 sc1
    v_add_f32 v244, v244, v251
    v_fmac_f32 v245, v251, v251
    v_lshlrev_b32 v250, 16, v242
    s_waitcnt lgkmcnt(2)
    v_mfma_f32_32x32x16_bf16 v[16:31], a[248:251], v[100:103], v[16:31]
    ds_read_b128 a[240:243], v226 offset:30720
    s_waitcnt vmcnt(15)
    v_permlane16_swap_b32 v104, v106
    v_permlane16_swap_b32 v105, v107
    v_and_b32 v251, s78, v242
    v_add_f32 v246, v246, v250
    v_mfma_f32_32x32x16_bf16 v[32:47], a[252:255], v[100:103], v[32:47]
    ds_read_b128 a[244:247], v225 offset:15360
    v_fmac_f32 v247, v250, v250
    v_add_f32 v246, v246, v251
    v_fmac_f32 v247, v251, v251
    v_lshlrev_b32 v250, 16, v243
    s_waitcnt lgkmcnt(2)
    v_mfma_f32_32x32x16_bf16 v[0:15], a[232:235], v[104:107], v[0:15]
    ds_read_b128 a[248:251], v225 offset:56320
    buffer_load_dwordx4 v[168:171], v224, s[4:7], s72 offen offset:2048 sc1
    v_and_b32 v251, s78, v243
    v_add_f32 v246, v246, v250
    v_fmac_f32 v247, v250, v250
    v_add_f32 v246, v246, v251
    v_mfma_f32_32x32x16_bf16 v[16:31], a[236:239], v[104:107], v[16:31]
    ds_read_b128 a[252:255], v226 offset:31744
    s_waitcnt vmcnt(15)
    v_permlane16_swap_b32 v108, v110
    v_permlane16_swap_b32 v109, v111
    v_fmac_f32 v247, v251, v251
    s_waitcnt lgkmcnt(2)
    v_mfma_f32_32x32x16_bf16 v[32:47], a[240:243], v[104:107], v[32:47]
    ds_read_b128 a[232:235], v225 offset:16384
    v_add_f32_dpp v244, v244, v244 row_ror:4 row_mask:0xf bank_mask:0xf
    v_add_f32_dpp v245, v245, v245 row_ror:4 row_mask:0xf bank_mask:0xf
    v_add_f32_dpp v246, v246, v246 row_ror:4 row_mask:0xf bank_mask:0xf
    v_add_f32_dpp v247, v247, v247 row_ror:4 row_mask:0xf bank_mask:0xf
    v_add_f32_dpp v244, v244, v244 row_ror:8 row_mask:0xf bank_mask:0xf
    v_mfma_f32_32x32x16_bf16 v[0:15], a[244:247], v[108:111], v[0:15]
    ds_read_b128 a[236:239], v225 offset:57344
    buffer_load_dwordx4 v[172:175], v224, s[4:7], s72 offen offset:3072 sc1
    v_add_f32_dpp v245, v245, v245 row_ror:8 row_mask:0xf bank_mask:0xf
    v_add_f32_dpp v246, v246, v246 row_ror:8 row_mask:0xf bank_mask:0xf
    v_add_f32_dpp v247, v247, v247 row_ror:8 row_mask:0xf bank_mask:0xf
    s_waitcnt lgkmcnt(2)
    v_mfma_f32_32x32x16_bf16 v[16:31], a[248:251], v[108:111], v[16:31]
    ds_read_b128 a[240:243], v226 offset:32768
    s_waitcnt vmcnt(15)
    v_permlane16_swap_b32 v112, v114
    v_permlane16_swap_b32 v113, v115
    v_mov_b32 v250, v244
    v_mov_b32 v251, v245
    v_mfma_f32_32x32x16_bf16 v[32:47], a[252:255], v[108:111], v[32:47]
    ds_read_b128 a[244:247], v225 offset:17408
    v_mov_b32 v252, v246
    v_mov_b32 v253, v247
    v_permlane16_swap_b32 v250, v244
    v_permlane16_swap_b32 v251, v245
    s_waitcnt lgkmcnt(2)
    v_mfma_f32_32x32x16_bf16 v[0:15], a[232:235], v[112:115], v[0:15]
    ds_read_b128 a[248:251], v225 offset:58368
    s_add_u32 s72, s72, 4096
    buffer_load_dwordx4 v[176:179], v224, s[4:7], s72 offen offset:0 sc1
    v_permlane16_swap_b32 v252, v246
    v_permlane16_swap_b32 v253, v247
    v_add_f32 v244, v244, v250
    v_add_f32 v245, v245, v251
    v_mfma_f32_32x32x16_bf16 v[16:31], a[236:239], v[112:115], v[16:31]
    ds_read_b128 a[252:255], v226 offset:33792
    s_waitcnt vmcnt(15)
    v_permlane16_swap_b32 v116, v118
    v_permlane16_swap_b32 v117, v119
    v_add_f32 v246, v246, v252
    s_waitcnt lgkmcnt(2)
    v_mfma_f32_32x32x16_bf16 v[32:47], a[240:243], v[112:115], v[32:47]
    ds_read_b128 a[232:235], v225 offset:18432
    v_add_f32 v247, v247, v253
    v_mov_b32 v250, v244
    v_mov_b32 v251, v245
    v_mov_b32 v252, v246
    v_mov_b32 v253, v247
    v_mfma_f32_32x32x16_bf16 v[0:15], a[244:247], v[116:119], v[0:15]
    ds_read_b128 a[236:239], v225 offset:59392
    buffer_load_dwordx4 v[180:183], v224, s[4:7], s72 offen offset:1024 sc1
    v_permlane32_swap_b32 v250, v244
    v_permlane32_swap_b32 v251, v245
    v_permlane32_swap_b32 v252, v246
    s_waitcnt lgkmcnt(2)
    v_mfma_f32_32x32x16_bf16 v[16:31], a[248:251], v[116:119], v[16:31]
    ds_read_b128 a[240:243], v226 offset:34816
    s_waitcnt vmcnt(15)
    v_permlane16_swap_b32 v120, v122
    v_permlane16_swap_b32 v121, v123
    v_permlane32_swap_b32 v253, v247
    v_add_f32 v244, v244, v250
    v_mfma_f32_32x32x16_bf16 v[32:47], a[252:255], v[116:119], v[32:47]
    ds_read_b128 a[244:247], v225 offset:19456
    v_add_f32 v245, v245, v251
    v_add_f32 v246, v246, v252
    v_add_f32 v247, v247, v253
    v_and_b32 v254, 0x40, v224
    s_waitcnt lgkmcnt(2)
    v_mfma_f32_32x32x16_bf16 v[0:15], a[232:235], v[120:123], v[0:15]
    ds_read_b128 a[248:251], v225 offset:60416
    buffer_load_dwordx4 v[184:187], v224, s[4:7], s72 offen offset:2048 sc1
    v_cmp_ne_u32 vcc, 0, v254
    s_lshr_b32 s74, s65, 2
    s_lshl_b32 s74, s74, 9
    v_cndmask_b32 v250, v244, v246, vcc
    v_mfma_f32_32x32x16_bf16 v[16:31], a[236:239], v[120:123], v[16:31]
    ds_read_b128 a[252:255], v226 offset:35840
    s_waitcnt vmcnt(15)
    v_permlane16_swap_b32 v124, v126
    v_permlane16_swap_b32 v125, v127
    v_cndmask_b32 v252, v245, v247, vcc
    s_waitcnt lgkmcnt(2)
    v_mfma_f32_32x32x16_bf16 v[32:47], a[240:243], v[120:123], v[32:47]
    ds_read_b128 a[232:235], v225 offset:20480
    v_mov_b32 v251, s3
    v_mov_b32 v253, s3
    v_lshlrev_b32 v254, 2, v254
    v_and_b32 v244, 0x30, v224
    v_add_u32 v254, v254, v244
    v_mfma_f32_32x32x16_bf16 v[0:15], a[244:247], v[124:127], v[0:15]
    ds_read_b128 a[236:239], v225 offset:61440
    buffer_load_dwordx4 v[188:191], v224, s[4:7], s72 offen offset:3072 sc1
    s_and_b32 s75, s65, 3
    s_lshl_b32 s75, s75, 6
    s_add_u32 s74, s74, s75
    s_waitcnt lgkmcnt(2)
    v_mfma_f32_32x32x16_bf16 v[16:31], a[248:251], v[124:127], v[16:31]
    ds_read_b128 a[240:243], v226 offset:36864
    s_waitcnt vmcnt(15)
    v_permlane16_swap_b32 v128, v130
    v_permlane16_swap_b32 v129, v131
    s_lshl_b32 s75, s59, 11
    s_add_u32 s74, s74, s75
    v_mfma_f32_32x32x16_bf16 v[32:47], a[252:255], v[124:127], v[32:47]
    ds_read_b128 a[244:247], v225 offset:21504
    s_lshl_b32 s75, s64, 13
    s_add_u32 s74, s74, s75
    s_add_u32 s74, s74, 38141952
    s_mov_b64 exec, 0xff
    buffer_store_dwordx4 v[250:253], v254, s[4:7], s74 offen sc1
    s_mov_b64 exec, -1
    s_waitcnt lgkmcnt(2)
    v_mfma_f32_32x32x16_bf16 v[0:15], a[232:235], v[128:131], v[0:15]
    ds_read_b128 a[248:251], v225 offset:62464
    s_add_u32 s72, s72, 4096
    buffer_load_dwordx4 v[192:195], v224, s[4:7], s72 offen offset:0 sc1
    s_mul_i32 s79, s59, 14336
    s_add_u32 s79, s79, 30941184
    s_add_u32 s90, s59, 0
    s_and_b32 s90, s90, 3
    v_mfma_f32_32x32x16_bf16 v[16:31], a[236:239], v[128:131], v[16:31]
    ds_read_b128 a[252:255], v226 offset:37888
    s_waitcnt vmcnt(16)
    v_permlane16_swap_b32 v132, v134
    v_permlane16_swap_b32 v133, v135
    s_lshl_b32 s63, s68, 2
    s_waitcnt lgkmcnt(2)
    v_mfma_f32_32x32x16_bf16 v[32:47], a[240:243], v[128:131], v[32:47]
    ds_read_b128 a[232:235], v225 offset:22528
    s_add_u32 s90, s90, s63
    s_mul_i32 s90, s90, 55296
    s_add_u32 s90, s90, s79
    s_add_u32 s91, s59, 1
    s_and_b32 s91, s91, 3
    v_mfma_f32_32x32x16_bf16 v[0:15], a[244:247], v[132:135], v[0:15]
    ds_read_b128 a[236:239], v225 offset:63488
    buffer_load_dwordx4 v[196:199], v224, s[4:7], s72 offen offset:1024 sc1
    s_lshl_b32 s63, s68, 2
    s_add_u32 s91, s91, s63
    s_mul_i32 s91, s91, 55296
    s_waitcnt lgkmcnt(2)
    v_mfma_f32_32x32x16_bf16 v[16:31], a[248:251], v[132:135], v[16:31]
    ds_read_b128 a[240:243], v226 offset:38912
    s_waitcnt vmcnt(16)
    v_permlane16_swap_b32 v136, v138
    v_permlane16_swap_b32 v137, v139
    s_add_u32 s91, s91, s79
    s_add_u32 s92, s59, 2
    v_mfma_f32_32x32x16_bf16 v[32:47], a[252:255], v[132:135], v[32:47]
    ds_read_b128 a[244:247], v225 offset:23552
    s_and_b32 s92, s92, 3
    s_lshl_b32 s63, s68, 2
    s_add_u32 s92, s92, s63
    s_mul_i32 s92, s92, 55296
    s_waitcnt lgkmcnt(2)
    v_mfma_f32_32x32x16_bf16 v[0:15], a[232:235], v[136:139], v[0:15]
    ds_read_b128 a[248:251], v225 offset:64512
    buffer_load_dwordx4 v[200:203], v224, s[4:7], s72 offen offset:2048 sc1
    s_add_u32 s92, s92, s79
    s_add_u32 s93, s59, 3
    s_and_b32 s93, s93, 3
    s_lshl_b32 s63, s68, 2
    v_mfma_f32_32x32x16_bf16 v[16:31], a[236:239], v[136:139], v[16:31]
    ds_read_b128 a[252:255], v226 offset:39936
    s_waitcnt vmcnt(16)
    v_permlane16_swap_b32 v140, v142
    v_permlane16_swap_b32 v141, v143
    s_add_u32 s93, s93, s63
    s_waitcnt lgkmcnt(2)
    v_mfma_f32_32x32x16_bf16 v[32:47], a[240:243], v[136:139], v[32:47]
    ds_read_b128 a[232:235], v225 offset:24576
    s_mul_i32 s93, s93, 55296
    s_add_u32 s93, s93, s79
    s_lshr_b32 s81, s68, 1
    s_lshl_b32 s81, s81, 2
    s_add_u32 s81, s81, s59
    v_mfma_f32_32x32x16_bf16 v[0:15], a[244:247], v[140:143], v[0:15]
    ds_read_b128 a[236:239], v226 offset:0
    buffer_load_dwordx4 v[204:207], v224, s[4:7], s72 offen offset:3072 sc1
    s_lshl_b32 s81, s81, 7
    s_add_u32 s81, s81, 98304
    s_waitcnt lgkmcnt(2)
    v_mfma_f32_32x32x16_bf16 v[16:31], a[248:251], v[140:143], v[16:31]
    ds_read_b128 a[240:243], v226 offset:40960
    s_waitcnt vmcnt(16)
    v_permlane16_swap_b32 v144, v146
    v_permlane16_swap_b32 v145, v147
    v_mfma_f32_32x32x16_bf16 v[32:47], a[252:255], v[140:143], v[32:47]
    ds_read_b128 a[244:247], v225 offset:25600
    s_waitcnt lgkmcnt(2)
    v_mfma_f32_32x32x16_bf16 v[0:15], a[232:235], v[144:147], v[0:15]
    ds_read_b128 a[248:251], v226 offset:1024
    s_add_u32 s72, s72, 4096
    buffer_load_dwordx4 v[208:211], v224, s[4:7], s72 offen offset:0 sc1
    v_mfma_f32_32x32x16_bf16 v[16:31], a[236:239], v[144:147], v[16:31]
    ds_read_b128 a[252:255], v226 offset:41984
    s_waitcnt vmcnt(16)
    v_permlane16_swap_b32 v148, v150
    v_permlane16_swap_b32 v149, v151
    s_waitcnt lgkmcnt(2)
    v_mfma_f32_32x32x16_bf16 v[32:47], a[240:243], v[144:147], v[32:47]
    ds_read_b128 a[232:235], v225 offset:26624
    v_mfma_f32_32x32x16_bf16 v[0:15], a[244:247], v[148:151], v[0:15]
    ds_read_b128 a[236:239], v226 offset:2048
    buffer_load_dwordx4 v[212:215], v224, s[4:7], s72 offen offset:1024 sc1
    s_waitcnt lgkmcnt(2)
    v_mfma_f32_32x32x16_bf16 v[16:31], a[248:251], v[148:151], v[16:31]
    ds_read_b128 a[240:243], v226 offset:43008
    s_waitcnt vmcnt(16)
    v_permlane16_swap_b32 v152, v154
    v_permlane16_swap_b32 v153, v155
    v_mfma_f32_32x32x16_bf16 v[32:47], a[252:255], v[148:151], v[32:47]
    ds_read_b128 a[244:247], v225 offset:27648
    s_waitcnt lgkmcnt(2)
    v_mfma_f32_32x32x16_bf16 v[0:15], a[232:235], v[152:155], v[0:15]
    ds_read_b128 a[248:251], v226 offset:3072
    buffer_load_dwordx4 v[216:219], v224, s[4:7], s72 offen offset:2048 sc1
    v_mfma_f32_32x32x16_bf16 v[16:31], a[236:239], v[152:155], v[16:31]
    ds_read_b128 a[252:255], v226 offset:44032
    s_waitcnt vmcnt(16)
    v_permlane16_swap_b32 v156, v158
    v_permlane16_swap_b32 v157, v159
    s_waitcnt lgkmcnt(2)
    v_mfma_f32_32x32x16_bf16 v[32:47], a[240:243], v[152:155], v[32:47]
    ds_read_b128 a[232:235], v225 offset:28672
    v_mfma_f32_32x32x16_bf16 v[0:15], a[244:247], v[156:159], v[0:15]
    ds_read_b128 a[236:239], v226 offset:4096
    buffer_load_dwordx4 v[220:223], v224, s[4:7], s72 offen offset:3072 sc1
    s_waitcnt lgkmcnt(2)
    v_mfma_f32_32x32x16_bf16 v[16:31], a[248:251], v[156:159], v[16:31]
    ds_read_b128 a[240:243], v226 offset:45056
    s_waitcnt vmcnt(16)
    v_permlane16_swap_b32 v160, v162
    v_permlane16_swap_b32 v161, v163
    v_mfma_f32_32x32x16_bf16 v[32:47], a[252:255], v[156:159], v[32:47]
    ds_read_b128 a[244:247], v225 offset:29696
    s_waitcnt lgkmcnt(2)
    v_mfma_f32_32x32x16_bf16 v[0:15], a[232:235], v[160:163], v[0:15]
    ds_read_b128 a[248:251], v226 offset:5120
    s_add_u32 s96, s59, 0
    s_min_u32 s96, s96, 8
    s_add_u32 s97, s96, 31
    s_cmp_eq_u32 s96, 8
    s_cselect_b32 s97, 0, s97
    s_lshl_b32 s97, s97, 12
    s_mov_b32 m0, s97
    s_lshl_b32 s96, s96, 12
    s_add_u32 s96, s96, s67
    s_add_u32 s96, s96, 122880
    buffer_load_dwordx4 v224, s[4:7], s96 offen offset:0 sc1 lds
    v_mfma_f32_32x32x16_bf16 v[16:31], a[236:239], v[160:163], v[16:31]
    ds_read_b128 a[252:255], v226 offset:46080
    s_waitcnt vmcnt(16)
    v_permlane16_swap_b32 v164, v166
    v_permlane16_swap_b32 v165, v167
    s_waitcnt lgkmcnt(2)
    v_mfma_f32_32x32x16_bf16 v[32:47], a[240:243], v[160:163], v[32:47]
    ds_read_b128 a[232:235], v225 offset:30720
    buffer_load_dwordx4 v224, s[4:7], s96 offen offset:1024 sc1 lds
    v_mfma_f32_32x32x16_bf16 v[0:15], a[244:247], v[164:167], v[0:15]
    ds_read_b128 a[236:239], v226 offset:6144
    s_waitcnt lgkmcnt(2)
    v_mfma_f32_32x32x16_bf16 v[16:31], a[248:251], v[164:167], v[16:31]
    ds_read_b128 a[240:243], v226 offset:47104
    s_waitcnt vmcnt(16)
    v_permlane16_swap_b32 v168, v170
    v_permlane16_swap_b32 v169, v171
    buffer_load_dwordx4 v224, s[4:7], s96 offen offset:2048 sc1 lds
    v_mfma_f32_32x32x16_bf16 v[32:47], a[252:255], v[164:167], v[32:47]
    ds_read_b128 a[244:247], v225 offset:31744
    s_waitcnt lgkmcnt(2)
    v_mfma_f32_32x32x16_bf16 v[0:15], a[232:235], v[168:171], v[0:15]
    ds_read_b128 a[248:251], v226 offset:7168
    buffer_load_dwordx4 v224, s[4:7], s96 offen offset:3072 sc1 lds
    v_mfma_f32_32x32x16_bf16 v[16:31], a[236:239], v[168:171], v[16:31]
    ds_read_b128 a[252:255], v226 offset:48128
    s_waitcnt vmcnt(17)
    v_permlane16_swap_b32 v172, v174
    v_permlane16_swap_b32 v173, v175
    s_waitcnt lgkmcnt(2)
    v_mfma_f32_32x32x16_bf16 v[32:47], a[240:243], v[168:171], v[32:47]
    ds_read_b128 a[232:235], v225 offset:32768
    s_add_u32 s96, s59, 4
    s_min_u32 s96, s96, 8
    s_add_u32 s97, s96, 31
    s_cmp_eq_u32 s96, 8
    s_cselect_b32 s97, 0, s97
    s_lshl_b32 s97, s97, 12
    s_mov_b32 m0, s97
    s_lshl_b32 s96, s96, 12
    s_add_u32 s96, s96, s67
    s_add_u32 s96, s96, 122880
    buffer_load_dwordx4 v224, s[4:7], s96 offen offset:0 sc1 lds
    v_mfma_f32_32x32x16_bf16 v[0:15], a[244:247], v[172:175], v[0:15]
    ds_read_b128 a[236:239], v226 offset:8192
    s_waitcnt lgkmcnt(2)
    v_mfma_f32_32x32x16_bf16 v[16:31], a[248:251], v[172:175], v[16:31]
    ds_read_b128 a[240:243], v226 offset:49152
    s_waitcnt vmcnt(17)
    v_permlane16_swap_b32 v176, v178
    v_permlane16_swap_b32 v177, v179
    buffer_load_dwordx4 v224, s[4:7], s96 offen offset:1024 sc1 lds
    v_mfma_f32_32x32x16_bf16 v[32:47], a[252:255], v[172:175], v[32:47]
    ds_read_b128 a[244:247], v225 offset:33792
    s_waitcnt lgkmcnt(2)
    v_mfma_f32_32x32x16_bf16 v[0:15], a[232:235], v[176:179], v[0:15]
    ds_read_b128 a[248:251], v226 offset:9216
    buffer_load_dwordx4 v224, s[4:7], s96 offen offset:2048 sc1 lds
    v_and_b32 v254, 0x1f0, v224
    v_lshrrev_b32 v250, 9, v224
    v_lshl_add_u32 v254, v250, 12, v254
    s_lshl_b32 s74, s64, 13
    v_mfma_f32_32x32x16_bf16 v[16:31], a[236:239], v[176:179], v[16:31]
    ds_read_b128 a[252:255], v226 offset:50176
    s_waitcnt vmcnt(18)
    v_permlane16_swap_b32 v180, v182
    v_permlane16_swap_b32 v181, v183
    s_lshl_b32 s75, s59, 9
    s_waitcnt lgkmcnt(2)
    v_mfma_f32_32x32x16_bf16 v[32:47], a[240:243], v[176:179], v[32:47]
    ds_read_b128 a[232:235], v225 offset:34816
    buffer_load_dwordx4 v224, s[4:7], s96 offen offset:3072 sc1 lds
    s_add_u32 s74, s74, s75
    s_add_u32 s74, s74, 38141952
    buffer_load_dwordx4 v[232:235], v254, s[4:7], s74 offen sc1
    buffer_load_dwordx4 v[236:239], v254, s[4:7], s74 offen offset:2048 sc1
    v_mfma_f32_32x32x16_bf16 v[0:15], a[244:247], v[180:183], v[0:15]
    ds_read_b128 a[236:239], v226 offset:10240
    s_waitcnt lgkmcnt(2)
    v_mfma_f32_32x32x16_bf16 v[16:31], a[248:251], v[180:183], v[16:31]
    ds_read_b128 a[240:243], v226 offset:51200
    s_waitcnt vmcnt(20)
    v_permlane16_swap_b32 v184, v186
    v_permlane16_swap_b32 v185, v187
    s_add_u32 s96, s59, 8
    s_min_u32 s96, s96, 8
    s_add_u32 s97, s96, 31
    s_cmp_eq_u32 s96, 8
    s_cselect_b32 s97, 0, s97
    s_lshl_b32 s97, s97, 12
    s_mov_b32 m0, s97
    s_lshl_b32 s96, s96, 12
    s_add_u32 s96, s96, s67
    s_add_u32 s96, s96, 122880
    buffer_load_dwordx4 v224, s[4:7], s96 offen offset:0 sc1 lds
    v_mfma_f32_32x32x16_bf16 v[32:47], a[252:255], v[180:183], v[32:47]
    ds_read_b128 a[244:247], v225 offset:35840
    s_waitcnt lgkmcnt(2)
    v_mfma_f32_32x32x16_bf16 v[0:15], a[232:235], v[184:187], v[0:15]
    ds_read_b128 a[248:251], v226 offset:11264
    buffer_load_dwordx4 v224, s[4:7], s96 offen offset:1024 sc1 lds
    v_mfma_f32_32x32x16_bf16 v[16:31], a[236:239], v[184:187], v[16:31]
    ds_read_b128 a[252:255], v226 offset:52224
    s_waitcnt vmcnt(21)
    v_permlane16_swap_b32 v188, v190
    v_permlane16_swap_b32 v189, v191
    s_waitcnt lgkmcnt(2)
    v_mfma_f32_32x32x16_bf16 v[32:47], a[240:243], v[184:187], v[32:47]
    ds_read_b128 a[232:235], v225 offset:36864
    buffer_load_dwordx4 v224, s[4:7], s96 offen offset:2048 sc1 lds
    v_mfma_f32_32x32x16_bf16 v[0:15], a[244:247], v[188:191], v[0:15]
    ds_read_b128 a[236:239], v226 offset:12288
    s_waitcnt lgkmcnt(2)
    v_mfma_f32_32x32x16_bf16 v[16:31], a[248:251], v[188:191], v[16:31]
    ds_read_b128 a[240:243], v226 offset:53248
    s_waitcnt vmcnt(20)
    v_permlane16_swap_b32 v192, v194
    v_permlane16_swap_b32 v193, v195
    buffer_load_dwordx4 v224, s[4:7], s96 offen offset:3072 sc1 lds
    v_mfma_f32_32x32x16_bf16 v[32:47], a[252:255], v[188:191], v[32:47]
    ds_read_b128 a[244:247], v225 offset:37888
    s_barrier
    s_waitcnt lgkmcnt(2)
    v_mfma_f32_32x32x16_bf16 v[0:15], a[232:235], v[192:195], v[0:15]
    ds_read_b128 a[248:251], v226 offset:13312
    s_mov_b32 m0, s82
    s_nop 0
    buffer_load_dwordx4 v224, s[4:7], s83 offen offset:0 sc1 lds
    v_mfma_f32_32x32x16_bf16 v[16:31], a[236:239], v[192:195], v[16:31]
    ds_read_b128 a[252:255], v226 offset:54272
    s_waitcnt vmcnt(21)
    v_permlane16_swap_b32 v196, v198
    v_permlane16_swap_b32 v197, v199
    s_waitcnt lgkmcnt(2)
    v_mfma_f32_32x32x16_bf16 v[32:47], a[240:243], v[192:195], v[32:47]
    ds_read_b128 a[232:235], v225 offset:38912
    buffer_load_dwordx4 v224, s[4:7], s83 offen offset:1024 sc1 lds
    v_mfma_f32_32x32x16_bf16 v[0:15], a[244:247], v[196:199], v[0:15]
    ds_read_b128 a[236:239], v226 offset:14336
    s_waitcnt lgkmcnt(2)
    v_mfma_f32_32x32x16_bf16 v[16:31], a[248:251], v[196:199], v[16:31]
    ds_read_b128 a[240:243], v226 offset:55296
    s_waitcnt vmcnt(21)
    v_permlane16_swap_b32 v200, v202
    v_permlane16_swap_b32 v201, v203
    buffer_load_dwordx4 v224, s[4:7], s83 offen offset:2048 sc1 lds
    v_mfma_f32_32x32x16_bf16 v[32:47], a[252:255], v[196:199], v[32:47]
    ds_read_b128 a[244:247], v225 offset:39936
    s_waitcnt lgkmcnt(2)
    v_mfma_f32_32x32x16_bf16 v[0:15], a[232:235], v[200:203], v[0:15]
    ds_read_b128 a[248:251], v226 offset:15360
    buffer_load_dwordx4 v224, s[4:7], s83 offen offset:3072 sc1 lds
    s_add_u32 s82, s82, 16384
    s_add_u32 s83, s83, 16384
    v_mfma_f32_32x32x16_bf16 v[16:31], a[236:239], v[200:203], v[16:31]
    ds_read_b128 a[252:255], v226 offset:56320
    s_waitcnt vmcnt(22)
    v_permlane16_swap_b32 v204, v206
    v_permlane16_swap_b32 v205, v207
    s_waitcnt lgkmcnt(2)
    v_mfma_f32_32x32x16_bf16 v[32:47], a[240:243], v[200:203], v[32:47]
    ds_read_b128 a[232:235], v225 offset:40960
    s_add_u32 s83, s71, 12288
    s_add_u32 s83, s83, s67
    s_mov_b32 m0, s82
    s_nop 0
    buffer_load_dwordx4 v224, s[4:7], s83 offen offset:0 sc1 lds
    v_mfma_f32_32x32x16_bf16 v[0:15], a[244:247], v[204:207], v[0:15]
    ds_read_b128 a[236:239], v226 offset:16384
    s_waitcnt lgkmcnt(2)
    v_mfma_f32_32x32x16_bf16 v[16:31], a[248:251], v[204:207], v[16:31]
    ds_read_b128 a[240:243], v226 offset:57344
    s_waitcnt vmcnt(22)
    v_permlane16_swap_b32 v208, v210
    v_permlane16_swap_b32 v209, v211
    buffer_load_dwordx4 v224, s[4:7], s83 offen offset:1024 sc1 lds
    v_mfma_f32_32x32x16_bf16 v[32:47], a[252:255], v[204:207], v[32:47]
    ds_read_b128 a[244:247], v225 offset:41984
    s_waitcnt lgkmcnt(2)
    v_mfma_f32_32x32x16_bf16 v[0:15], a[232:235], v[208:211], v[0:15]
    ds_read_b128 a[248:251], v226 offset:17408
    buffer_load_dwordx4 v224, s[4:7], s83 offen offset:2048 sc1 lds
    v_mfma_f32_32x32x16_bf16 v[16:31], a[236:239], v[208:211], v[16:31]
    ds_read_b128 a[252:255], v226 offset:58368
    s_waitcnt vmcnt(23)
    v_permlane16_swap_b32 v212, v214
    v_permlane16_swap_b32 v213, v215
    s_waitcnt lgkmcnt(2)
    v_mfma_f32_32x32x16_bf16 v[32:47], a[240:243], v[208:211], v[32:47]
    ds_read_b128 a[232:235], v225 offset:43008
    buffer_load_dwordx4 v224, s[4:7], s83 offen offset:3072 sc1 lds
    s_add_u32 s82, s82, 24576
    s_add_u32 s83, s83, 16384
    v_mfma_f32_32x32x16_bf16 v[0:15], a[244:247], v[212:215], v[0:15]
    ds_read_b128 a[236:239], v226 offset:18432
    s_waitcnt lgkmcnt(2)
    v_mfma_f32_32x32x16_bf16 v[16:31], a[248:251], v[212:215], v[16:31]
    ds_read_b128 a[240:243], v226 offset:59392
    s_waitcnt vmcnt(23)
    v_permlane16_swap_b32 v216, v218
    v_permlane16_swap_b32 v217, v219
    s_mov_b32 m0, s82
    s_nop 0
    buffer_load_dwordx4 v224, s[4:7], s83 offen offset:0 sc1 lds
    v_mfma_f32_32x32x16_bf16 v[32:47], a[252:255], v[212:215], v[32:47]
    ds_read_b128 a[244:247], v225 offset:44032
    s_waitcnt vmcnt(13)
    v_xor_b32 v250, s3, v233
    v_xor_b32 v251, s3, v235
    v_xor_b32 v252, s3, v237
    v_xor_b32 v253, s3, v239
    v_or3_b32 v250, v250, v251, v252
    v_or_b32 v250, v250, v253
    v_cmp_ne_u32 vcc, 0, v250
    s_cbranch_vccnz L_spin_61
L_back_62:
    v_add_f32 v232, v232, v236
    v_add_f32 v234, v234, v238
    s_mov_b32 s74, 0x3acccccd
    s_waitcnt lgkmcnt(2)
    v_mfma_f32_32x32x16_bf16 v[0:15], a[232:235], v[216:219], v[0:15]
    ds_read_b128 a[248:251], v226 offset:19456
    buffer_load_dwordx4 v224, s[4:7], s83 offen offset:1024 sc1 lds
    s_mov_b32 s75, 0x3727c5ac
    v_mov_b32 v250, v232
    v_mov_b32 v251, v234
    s_mov_b32 s76, 0xbfb8aa3b
    v_mfma_f32_32x32x16_bf16 v[16:31], a[236:239], v[216:219], v[16:31]
    ds_read_b128 a[252:255], v226 offset:60416
    v_permlane16_swap_b32 v220, v222
    v_permlane16_swap_b32 v221, v223
    s_nop 0
    s_waitcnt vmcnt(10)
    s_barrier
    s_waitcnt lgkmcnt(2)
    v_mfma_f32_32x32x16_bf16 v[32:47], a[240:243], v[216:219], v[32:47]
    ds_read_b128 a[232:235], v226 offset:61440
    buffer_load_dwordx4 v224, s[4:7], s83 offen offset:2048 sc1 lds
    v_permlane32_swap_b32 v250, v232
    v_permlane32_swap_b32 v251, v234
    v_add_f32 v232, v232, v250
    v_add_f32 v234, v234, v251
    v_mfma_f32_32x32x16_bf16 v[0:15], a[244:247], v[220:223], v[0:15]
    ds_read_b128 a[236:239], v226 offset:62464
    v_mul_f32 v229, s74, v232
    v_mul_f32 v231, s74, v234
    v_fma_f32 v231, -v229, v229, v231
    v_max_f32 v231, 0, v231
    s_waitcnt lgkmcnt(2)
    v_mfma_f32_32x32x16_bf16 v[16:31], a[248:251], v[220:223], v[16:31]
    ds_read_b128 a[240:243], v226 offset:63488
    buffer_load_dwordx4 v224, s[4:7], s83 offen offset:3072 sc1 lds
    s_add_u32 s82, s82, 16384
    s_add_u32 s83, s83, 16384
    v_add_f32 v231, s75, v231
    v_rsq_f32 v230, v231
    v_mfma_f32_32x32x16_bf16 v[32:47], a[252:255], v[220:223], v[32:47]
    ds_read_b128 a[244:247], v226 offset:64512
    v_sub_f32 v229, 0, v229
    v_mul_f32 v230, s76, v230
    s_waitcnt lgkmcnt(2)
    v_mfma_f32_32x32x16_bf16 v[48:63], a[232:235], v[64:67], 0
    ds_read_b128 a[248:251], v227 offset:0
    s_mov_b32 m0, s82
    s_nop 0
    buffer_load_dwordx4 v224, s[4:7], s83 offen offset:0 sc1 lds
    ds_read_b128 v[232:235], v248 offset:512
    ds_read_b128 v[236:239], v248 offset:528
    v_mfma_f32_32x32x16_bf16 v[48:63], a[236:239], v[68:71], v[48:63]
    ds_read_b128 a[252:255], v227 offset:1024
    ds_read_b128 v[240:243], v248 offset:544
    ds_read_b128 v[244:247], v248 offset:560
    s_waitcnt lgkmcnt(3)
    v_fmac_f32 v0, v229, v232
    v_fmac_f32 v1, v229, v233
    v_mfma_f32_32x32x16_bf16 v[48:63], a[240:243], v[72:75], v[48:63]
    ds_read_b128 a[232:235], v227 offset:2048
    buffer_load_dwordx4 v224, s[4:7], s83 offen offset:1024 sc1 lds
    v_fmac_f32 v2, v229, v234
    v_fmac_f32 v3, v229, v235
    v_fmac_f32 v4, v229, v236
    v_mfma_f32_32x32x16_bf16 v[48:63], a[244:247], v[76:79], v[48:63]
    ds_read_b128 a[236:239], v227 offset:3072
    v_fmac_f32 v5, v229, v237
    v_fmac_f32 v6, v229, v238
    v_fmac_f32 v7, v229, v239
    s_waitcnt lgkmcnt(4)
    v_mfma_f32_32x32x16_bf16 v[48:63], a[248:251], v[80:83], v[48:63]
    ds_read_b128 a[240:243], v227 offset:4096
    buffer_load_dwordx4 v224, s[4:7], s83 offen offset:2048 sc1 lds
    v_mul_f32 v232, v230, v0
    v_mul_f32 v233, v230, v1
    v_mul_f32 v234, v230, v2
    v_mfma_f32_32x32x16_bf16 v[48:63], a[252:255], v[84:87], v[48:63]
    ds_read_b128 a[244:247], v227 offset:5120
    v_mul_f32 v235, v230, v3
    v_exp_f32 v232, v232
    v_mul_f32 v0, v0, v4
    s_waitcnt lgkmcnt(2)
    v_mfma_f32_32x32x16_bf16 v[48:63], a[232:235], v[88:91], v[48:63]
    ds_read_b128 a[248:251], v227 offset:6144
    buffer_load_dwordx4 v224, s[4:7], s83 offen offset:3072 sc1 lds
    s_add_u32 s82, s82, 24576
    s_add_u32 s83, s83, 16384
    v_exp_f32 v233, v233
    v_mfma_f32_32x32x16_bf16 v[48:63], a[236:239], v[92:95], v[48:63]
    ds_read_b128 a[252:255], v227 offset:7168
    v_mul_f32 v1, v1, v5
    v_exp_f32 v234, v234
    v_mul_f32 v2, v2, v6
    s_waitcnt lgkmcnt(2)
    v_mfma_f32_32x32x16_bf16 v[48:63], a[240:243], v[96:99], v[48:63]
    ds_read_b128 a[232:235], v227 offset:8192
    s_mov_b32 m0, s82
    s_nop 0
    buffer_load_dwordx4 v224, s[4:7], s83 offen offset:0 sc1 lds
    v_exp_f32 v235, v235
    v_mul_f32 v3, v3, v7
    v_mfma_f32_32x32x16_bf16 v[48:63], a[244:247], v[100:103], v[48:63]
    ds_read_b128 a[236:239], v227 offset:9216
    v_fma_f32 v232, v232, v231, v231
    v_fma_f32 v233, v233, v231, v231
    v_fma_f32 v234, v234, v231, v231
    s_waitcnt lgkmcnt(2)
    v_mfma_f32_32x32x16_bf16 v[48:63], a[248:251], v[104:107], v[48:63]
    ds_read_b128 a[240:243], v227 offset:10240
    buffer_load_dwordx4 v224, s[4:7], s83 offen offset:1024 sc1 lds
    v_fma_f32 v235, v235, v231, v231
    v_rcp_f32 v232, v232
    v_mfma_f32_32x32x16_bf16 v[48:63], a[252:255], v[108:111], v[48:63]
    ds_read_b128 a[244:247], v227 offset:11264
    v_rcp_f32 v233, v233
    v_rcp_f32 v234, v234
    s_waitcnt lgkmcnt(2)
    v_mfma_f32_32x32x16_bf16 v[48:63], a[232:235], v[112:115], v[48:63]
    ds_read_b128 a[248:251], v227 offset:12288
    buffer_load_dwordx4 v224, s[4:7], s83 offen offset:2048 sc1 lds
    v_rcp_f32 v235, v235
    v_mul_f32 v0, v0, v232
    v_mul_f32 v1, v1, v233
    v_mfma_f32_32x32x16_bf16 v[48:63], a[236:239], v[116:119], v[48:63]
    ds_read_b128 a[252:255], v227 offset:13312
    v_mul_f32 v2, v2, v234
    v_mul_f32 v3, v3, v235
    v_cvt_pk_bf16_f32 v4, v0, v1
    s_waitcnt lgkmcnt(2)
    v_mfma_f32_32x32x16_bf16 v[48:63], a[240:243], v[120:123], v[48:63]
    ds_read_b128 a[232:235], v227 offset:14336
    buffer_load_dwordx4 v224, s[4:7], s83 offen offset:3072 sc1 lds
    s_add_u32 s82, s82, 16384
    s_add_u32 s83, s83, 16384
    v_cvt_pk_bf16_f32 v5, v2, v3
    v_fmac_f32 v8, v229, v240
    v_mfma_f32_32x32x16_bf16 v[48:63], a[244:247], v[124:127], v[48:63]
    ds_read_b128 a[236:239], v227 offset:15360
    v_fmac_f32 v9, v229, v241
    v_fmac_f32 v10, v229, v242
    v_fmac_f32 v11, v229, v243
    s_waitcnt lgkmcnt(2)
    v_mfma_f32_32x32x16_bf16 v[48:63], a[248:251], v[128:131], v[48:63]
    ds_read_b128 a[240:243], v227 offset:16384
    s_mov_b32 m0, s82
    s_nop 0
    buffer_load_dwordx4 v224, s[4:7], s83 offen offset:0 sc1 lds
    v_fmac_f32 v12, v229, v244
    v_fmac_f32 v13, v229, v245
    v_fmac_f32 v14, v229, v246
    v_mfma_f32_32x32x16_bf16 v[48:63], a[252:255], v[132:135], v[48:63]
    ds_read_b128 a[244:247], v227 offset:17408
    v_fmac_f32 v15, v229, v247
    v_mul_f32 v240, v230, v8
    v_mul_f32 v241, v230, v9
    s_waitcnt lgkmcnt(2)
    v_mfma_f32_32x32x16_bf16 v[48:63], a[232:235], v[136:139], v[48:63]
    ds_read_b128 a[248:251], v227 offset:18432
    buffer_load_dwordx4 v224, s[4:7], s83 offen offset:1024 sc1 lds
    v_mul_f32 v242, v230, v10
    v_mul_f32 v243, v230, v11
    v_exp_f32 v240, v240
    v_mfma_f32_32x32x16_bf16 v[48:63], a[236:239], v[140:143], v[48:63]
    ds_read_b128 a[252:255], v227 offset:19456
    v_mul_f32 v8, v8, v12
    v_exp_f32 v241, v241
    v_mul_f32 v9, v9, v13
    s_waitcnt lgkmcnt(2)
    v_mfma_f32_32x32x16_bf16 v[48:63], a[240:243], v[144:147], v[48:63]
    ds_read_b128 a[232:235], v227 offset:20480
    buffer_load_dwordx4 v224, s[4:7], s83 offen offset:2048 sc1 lds
    v_exp_f32 v242, v242
    v_mul_f32 v10, v10, v14
    v_mfma_f32_32x32x16_bf16 v[48:63], a[244:247], v[148:151], v[48:63]
    ds_read_b128 a[236:239], v227 offset:21504
    v_exp_f32 v243, v243
    v_mul_f32 v11, v11, v15
    v_fma_f32 v240, v240, v231, v231
    s_waitcnt lgkmcnt(2)
    v_mfma_f32_32x32x16_bf16 v[48:63], a[248:251], v[152:155], v[48:63]
    ds_read_b128 a[240:243], v227 offset:22528
    buffer_load_dwordx4 v224, s[4:7], s83 offen offset:3072 sc1 lds
    s_add_u32 s82, s82, 24576
    s_add_u32 s83, s83, 16384
    v_fma_f32 v241, v241, v231, v231
    v_fma_f32 v242, v242, v231, v231
    v_mfma_f32_32x32x16_bf16 v[48:63], a[252:255], v[156:159], v[48:63]
    ds_read_b128 a[244:247], v227 offset:23552
    v_fma_f32 v243, v243, v231, v231
    v_rcp_f32 v240, v240
    s_waitcnt lgkmcnt(2)
    v_mfma_f32_32x32x16_bf16 v[48:63], a[232:235], v[160:163], v[48:63]
    ds_read_b128 a[248:251], v227 offset:24576
    v_rcp_f32 v241, v241
    v_rcp_f32 v242, v242
    v_mfma_f32_32x32x16_bf16 v[48:63], a[236:239], v[164:167], v[48:63]
    ds_read_b128 a[252:255], v227 offset:25600
    v_rcp_f32 v243, v243
    v_mul_f32 v8, v8, v240
    v_mul_f32 v9, v9, v241
    s_waitcnt lgkmcnt(2)
    v_mfma_f32_32x32x16_bf16 v[48:63], a[240:243], v[168:171], v[48:63]
    ds_read_b128 a[232:235], v227 offset:26624
    v_mul_f32 v10, v10, v242
    v_mul_f32 v11, v11, v243
    v_cvt_pk_bf16_f32 v6, v8, v9
    v_mfma_f32_32x32x16_bf16 v[48:63], a[244:247], v[172:175], v[48:63]
    ds_read_b128 a[236:239], v227 offset:27648
    v_cvt_pk_bf16_f32 v7, v10, v11
    s_and_b32 s74, s65, 3
    s_lshl_b32 s74, s74, 10
    s_add_u32 s74, s74, s77
    s_add_u32 s74, s74, 8192
    buffer_store_dwordx4 v[4:7], v228, s[4:7], s74 offen offset:0 sc1
    s_waitcnt vmcnt(13)
    s_barrier
    s_waitcnt lgkmcnt(2)
    v_mfma_f32_32x32x16_bf16 v[48:63], a[248:251], v[176:179], v[48:63]
    ds_read_b128 a[240:243], v225 offset:0
    s_and_b32 s74, s59, 1
    s_lshr_b32 s82, s59, 1
    s_mul_i32 s82, s82, 10
    s_add_u32 s82, s82, s74
    s_add_u32 s82, s82, 9
    s_lshl_b32 s82, s82, 12
    s_mov_b32 m0, s82
    s_nop 0
    buffer_load_dwordx4 v224, s[4:7], s83 offen offset:0 sc1 lds
    v_mfma_f32_32x32x16_bf16 v[48:63], a[252:255], v[180:183], v[48:63]
    ds_read_b128 a[244:247], v225 offset:1024
    ds_read_b128 v[232:235], v248 offset:640
    ds_read_b128 v[236:239], v248 offset:656
    ds_read_b128 v[240:243], v248 offset:672
    ds_read_b128 v[244:247], v248 offset:688
    s_waitcnt lgkmcnt(2)
    v_mfma_f32_32x32x16_bf16 v[48:63], a[232:235], v[184:187], v[48:63]
    ds_read_b128 a[248:251], v225 offset:2048
    buffer_load_dwordx4 v224, s[4:7], s83 offen offset:1024 sc1 lds
    v_fmac_f32 v16, v229, v232
    v_fmac_f32 v17, v229, v233
    v_fmac_f32 v18, v229, v234
    v_mfma_f32_32x32x16_bf16 v[48:63], a[236:239], v[188:191], v[48:63]
    ds_read_b128 a[252:255], v225 offset:3072
    v_fmac_f32 v19, v229, v235
    v_fmac_f32 v20, v229, v236
    v_fmac_f32 v21, v229, v237
    v_mfma_f32_32x32x16_bf16 v[48:63], a[240:243], v[192:195], v[48:63]
    ds_read_b128 a[232:235], v225 offset:4096
    buffer_load_dwordx4 v224, s[4:7], s83 offen offset:2048 sc1 lds
    v_fmac_f32 v22, v229, v238
    v_fmac_f32 v23, v229, v239
    v_mul_f32 v232, v230, v16
    v_mfma_f32_32x32x16_bf16 v[48:63], a[244:247], v[196:199], v[48:63]
    ds_read_b128 a[236:239], v225 offset:5120
    v_mul_f32 v233, v230, v17
    v_mul_f32 v234, v230, v18
    v_mul_f32 v235, v230, v19
    s_waitcnt lgkmcnt(2)
    v_mfma_f32_32x32x16_bf16 v[48:63], a[248:251], v[200:203], v[48:63]
    ds_read_b128 a[240:243], v225 offset:6144
    buffer_load_dwordx4 v224, s[4:7], s83 offen offset:3072 sc1 lds
    v_exp_f32 v232, v232
    v_mul_f32 v16, v16, v20
    v_mfma_f32_32x32x16_bf16 v[48:63], a[252:255], v[204:207], v[48:63]
    ds_read_b128 a[244:247], v225 offset:7168
    v_exp_f32 v233, v233
    v_mul_f32 v17, v17, v21
    s_waitcnt lgkmcnt(2)
    v_mfma_f32_32x32x16_bf16 v[48:63], a[232:235], v[208:211], v[48:63]
    ds_read_b128 a[248:251], v225 offset:8192
    s_min_u32 s74, s71, 8192
    s_add_u32 s82, s74, 118784
    s_add_u32 s83, s74, 110592
    s_add_u32 s83, s83, s67
    s_mov_b32 m0, s82
    s_nop 0
    buffer_load_dwordx4 v224, s[4:7], s83 offen offset:0 sc1 lds
    v_mfma_f32_32x32x16_bf16 v[48:63], a[236:239], v[212:215], v[48:63]
    ds_read_b128 a[252:255], v225 offset:9216
    v_exp_f32 v234, v234
    v_mul_f32 v18, v18, v22
    s_waitcnt lgkmcnt(2)
    v_mfma_f32_32x32x16_bf16 v[48:63], a[240:243], v[216:219], v[48:63]
    ds_read_b128 a[232:235], v225 offset:10240
    buffer_load_dwordx4 v224, s[4:7], s83 offen offset:1024 sc1 lds
    v_exp_f32 v235, v235
    v_mul_f32 v19, v19, v23
    v_fma_f32 v232, v232, v231, v231
    v_mfma_f32_32x32x16_bf16 v[48:63], a[244:247], v[220:223], v[48:63]
    ds_read_b128 a[236:239], v225 offset:11264
    v_fma_f32 v233, v233, v231, v231
    v_fma_f32 v234, v234, v231, v231
    v_fma_f32 v235, v235, v231, v231
    s_waitcnt lgkmcnt(2)
    v_mfma_f32_32x32x16_bf16 v[0:15], a[248:251], v[64:67], 0
    ds_read_b128 a[240:243], v225 offset:12288
    buffer_load_dwordx4 v224, s[4:7], s83 offen offset:2048 sc1 lds
    v_rcp_f32 v232, v232
    v_rcp_f32 v233, v233
    v_mfma_f32_32x32x16_bf16 v[0:15], a[252:255], v[68:71], v[0:15]
    ds_read_b128 a[244:247], v225 offset:13312
    v_rcp_f32 v234, v234
    v_rcp_f32 v235, v235
    s_waitcnt lgkmcnt(2)
    v_mfma_f32_32x32x16_bf16 v[0:15], a[232:235], v[72:75], v[0:15]
    ds_read_b128 a[248:251], v225 offset:14336
    buffer_load_dwordx4 v224, s[4:7], s83 offen offset:3072 sc1 lds
    v_mul_f32 v16, v16, v232
    v_mul_f32 v17, v17, v233
    v_mul_f32 v18, v18, v234
    v_mfma_f32_32x32x16_bf16 v[0:15], a[236:239], v[76:79], v[0:15]
    ds_read_b128 a[252:255], v225 offset:15360
    v_mul_f32 v19, v19, v235
    v_cvt_pk_bf16_f32 v20, v16, v17
    v_cvt_pk_bf16_f32 v21, v18, v19
    s_waitcnt lgkmcnt(2)
    v_mfma_f32_32x32x16_bf16 v[0:15], a[240:243], v[80:83], v[0:15]
    ds_read_b128 a[232:235], v225 offset:16384
    v_fmac_f32 v24, v229, v240
    v_fmac_f32 v25, v229, v241
    v_fmac_f32 v26, v229, v242
    v_mfma_f32_32x32x16_bf16 v[0:15], a[244:247], v[84:87], v[0:15]
    ds_read_b128 a[236:239], v225 offset:17408
    v_fmac_f32 v27, v229, v243
    v_fmac_f32 v28, v229, v244
    v_fmac_f32 v29, v229, v245
    s_waitcnt lgkmcnt(2)
    v_mfma_f32_32x32x16_bf16 v[0:15], a[248:251], v[88:91], v[0:15]
    ds_read_b128 a[240:243], v225 offset:18432
    v_fmac_f32 v30, v229, v246
    v_fmac_f32 v31, v229, v247
    v_mul_f32 v240, v230, v24
    v_mfma_f32_32x32x16_bf16 v[0:15], a[252:255], v[92:95], v[0:15]
    ds_read_b128 a[244:247], v225 offset:19456
    v_mul_f32 v241, v230, v25
    v_mul_f32 v242, v230, v26
    v_mul_f32 v243, v230, v27
    s_waitcnt lgkmcnt(2)
    v_mfma_f32_32x32x16_bf16 v[0:15], a[232:235], v[96:99], v[0:15]
    ds_read_b128 a[248:251], v225 offset:20480
    v_exp_f32 v240, v240
    v_mul_f32 v24, v24, v28
    v_exp_f32 v241, v241
    v_mfma_f32_32x32x16_bf16 v[0:15], a[236:239], v[100:103], v[0:15]
    ds_read_b128 a[252:255], v225 offset:21504
    v_mul_f32 v25, v25, v29
    v_exp_f32 v242, v242
    v_mul_f32 v26, v26, v30
    s_waitcnt lgkmcnt(2)
    v_mfma_f32_32x32x16_bf16 v[0:15], a[240:243], v[104:107], v[0:15]
    ds_read_b128 a[232:235], v225 offset:22528
    v_exp_f32 v243, v243
    v_mul_f32 v27, v27, v31
    v_fma_f32 v240, v240, v231, v231
    v_mfma_f32_32x32x16_bf16 v[0:15], a[244:247], v[108:111], v[0:15]
    ds_read_b128 a[236:239], v225 offset:23552
    v_fma_f32 v241, v241, v231, v231
    v_fma_f32 v242, v242, v231, v231
    v_fma_f32 v243, v243, v231, v231
    s_waitcnt lgkmcnt(2)
    v_mfma_f32_32x32x16_bf16 v[0:15], a[248:251], v[112:115], v[0:15]
    ds_read_b128 a[240:243], v225 offset:24576
    v_rcp_f32 v240, v240
    v_rcp_f32 v241, v241
    v_mfma_f32_32x32x16_bf16 v[0:15], a[252:255], v[116:119], v[0:15]
    ds_read_b128 a[244:247], v225 offset:25600
    v_rcp_f32 v242, v242
    v_rcp_f32 v243, v243
    s_waitcnt lgkmcnt(2)
    v_mfma_f32_32x32x16_bf16 v[0:15], a[232:235], v[120:123], v[0:15]
    ds_read_b128 a[248:251], v225 offset:26624
    v_mul_f32 v24, v24, v240
    v_mul_f32 v25, v25, v241
    v_mul_f32 v26, v26, v242
    v_mfma_f32_32x32x16_bf16 v[0:15], a[236:239], v[124:127], v[0:15]
    ds_read_b128 a[252:255], v225 offset:27648
    v_mul_f32 v27, v27, v243
    v_cvt_pk_bf16_f32 v22, v24, v25
    v_cvt_pk_bf16_f32 v23, v26, v27
    s_waitcnt lgkmcnt(2)
    v_mfma_f32_32x32x16_bf16 v[0:15], a[240:243], v[128:131], v[0:15]
    ds_read_b128 a[232:235], v225 offset:28672
    s_and_b32 s74, s65, 3
    s_lshl_b32 s74, s74, 10
    s_add_u32 s74, s74, s77
    s_add_u32 s74, s74, 8704
    buffer_store_dwordx4 v[20:23], v228, s[4:7], s74 offen offset:0 sc1
    v_mfma_f32_32x32x16_bf16 v[0:15], a[244:247], v[132:135], v[0:15]
    ds_read_b128 a[236:239], v225 offset:29696
    ds_read_b128 v[232:235], v248 offset:768
    ds_read_b128 v[236:239], v248 offset:784
    ds_read_b128 v[240:243], v248 offset:800
    ds_read_b128 v[244:247], v248 offset:816
    s_waitcnt lgkmcnt(2)
    v_mfma_f32_32x32x16_bf16 v[0:15], a[248:251], v[136:139], v[0:15]
    ds_read_b128 a[240:243], v225 offset:30720
    v_fmac_f32 v32, v229, v232
    v_fmac_f32 v33, v229, v233
    v_fmac_f32 v34, v229, v234
    v_mfma_f32_32x32x16_bf16 v[0:15], a[252:255], v[140:143], v[0:15]
    ds_read_b128 a[244:247], v225 offset:31744
    v_fmac_f32 v35, v229, v235
    v_fmac_f32 v36, v229, v236
    v_fmac_f32 v37, v229, v237
    v_mfma_f32_32x32x16_bf16 v[0:15], a[232:235], v[144:147], v[0:15]
    ds_read_b128 a[248:251], v225 offset:32768
    v_fmac_f32 v38, v229, v238
    v_fmac_f32 v39, v229, v239
    v_mul_f32 v232, v230, v32
    v_mfma_f32_32x32x16_bf16 v[0:15], a[236:239], v[148:151], v[0:15]
    ds_read_b128 a[252:255], v225 offset:33792
    v_mul_f32 v233, v230, v33
    v_mul_f32 v234, v230, v34
    v_mul_f32 v235, v230, v35
    s_waitcnt lgkmcnt(2)
    v_mfma_f32_32x32x16_bf16 v[0:15], a[240:243], v[152:155], v[0:15]
    ds_read_b128 a[232:235], v225 offset:34816
    v_exp_f32 v232, v232
    v_mul_f32 v32, v32, v36
    v_exp_f32 v233, v233
    v_mfma_f32_32x32x16_bf16 v[0:15], a[244:247], v[156:159], v[0:15]
    ds_read_b128 a[236:239], v225 offset:35840
    v_mul_f32 v33, v33, v37
    v_exp_f32 v234, v234
    v_mul_f32 v34, v34, v38
    s_waitcnt lgkmcnt(2)
    v_mfma_f32_32x32x16_bf16 v[0:15], a[248:251], v[160:163], v[0:15]
    ds_read_b128 a[240:243], v225 offset:45056
    v_exp_f32 v235, v235
    v_mul_f32 v35, v35, v39
    v_fma_f32 v232, v232, v231, v231
    v_mfma_f32_32x32x16_bf16 v[0:15], a[252:255], v[164:167], v[0:15]
    ds_read_b128 a[244:247], v225 offset:46080
    v_fma_f32 v233, v233, v231, v231
    v_fma_f32 v234, v234, v231, v231
    v_fma_f32 v235, v235, v231, v231
    s_waitcnt lgkmcnt(2)
    v_mfma_f32_32x32x16_bf16 v[0:15], a[232:235], v[168:171], v[0:15]
    ds_read_b128 a[248:251], v225 offset:47104
    v_rcp_f32 v232, v232
    v_rcp_f32 v233, v233
    v_mfma_f32_32x32x16_bf16 v[0:15], a[236:239], v[172:175], v[0:15]
    ds_read_b128 a[252:255], v225 offset:48128
    v_rcp_f32 v234, v234
    v_rcp_f32 v235, v235
    s_waitcnt lgkmcnt(2)
    v_mfma_f32_32x32x16_bf16 v[0:15], a[240:243], v[176:179], v[0:15]
    ds_read_b128 a[232:235], v225 offset:49152
    v_mul_f32 v32, v32, v232
    v_mul_f32 v33, v33, v233
    v_mul_f32 v34, v34, v234
    v_mfma_f32_32x32x16_bf16 v[0:15], a[244:247], v[180:183], v[0:15]
    ds_read_b128 a[236:239], v225 offset:50176
    v_mul_f32 v35, v35, v235
    v_cvt_pk_bf16_f32 v36, v32, v33
    v_cvt_pk_bf16_f32 v37, v34, v35
    s_waitcnt lgkmcnt(2)
    v_mfma_f32_32x32x16_bf16 v[0:15], a[248:251], v[184:187], v[0:15]
    ds_read_b128 a[240:243], v225 offset:51200
    v_fmac_f32 v40, v229, v240
    v_fmac_f32 v41, v229, v241
    v_fmac_f32 v42, v229, v242
    v_mfma_f32_32x32x16_bf16 v[0:15], a[252:255], v[188:191], v[0:15]
    ds_read_b128 a[244:247], v225 offset:52224
    v_fmac_f32 v43, v229, v243
    v_fmac_f32 v44, v229, v244
    v_fmac_f32 v45, v229, v245
    s_waitcnt lgkmcnt(2)
    v_mfma_f32_32x32x16_bf16 v[0:15], a[232:235], v[192:195], v[0:15]
    ds_read_b128 a[248:251], v225 offset:53248
    v_fmac_f32 v46, v229, v246
    v_fmac_f32 v47, v229, v247
    v_mul_f32 v240, v230, v40
    v_mfma_f32_32x32x16_bf16 v[0:15], a[236:239], v[196:199], v[0:15]
    ds_read_b128 a[252:255], v225 offset:54272
    v_mul_f32 v241, v230, v41
    v_mul_f32 v242, v230, v42
    v_mul_f32 v243, v230, v43
    s_waitcnt lgkmcnt(2)
    v_mfma_f32_32x32x16_bf16 v[0:15], a[240:243], v[200:203], v[0:15]
    ds_read_b128 a[232:235], v225 offset:55296
    v_exp_f32 v240, v240
    v_mul_f32 v40, v40, v44
    v_exp_f32 v241, v241
    v_mfma_f32_32x32x16_bf16 v[0:15], a[244:247], v[204:207], v[0:15]
    ds_read_b128 a[236:239], v225 offset:56320
    v_mul_f32 v41, v41, v45
    v_exp_f32 v242, v242
    v_mul_f32 v42, v42, v46
    s_waitcnt vmcnt(10)
    s_barrier
    s_waitcnt lgkmcnt(2)
    v_mfma_f32_32x32x16_bf16 v[0:15], a[248:251], v[208:211], v[0:15]
    ds_read_b128 a[240:243], v225 offset:57344
    v_exp_f32 v243, v243
    v_mul_f32 v43, v43, v47
    v_fma_f32 v240, v240, v231, v231
    v_mfma_f32_32x32x16_bf16 v[0:15], a[252:255], v[212:215], v[0:15]
    ds_read_b128 a[244:247], v225 offset:58368
    s_lshr_b32 s63, s71, 2
    s_add_u32 s98, s84, 6144
    s_add_u32 m0, s63, 131072
    s_nop 0
    buffer_load_dwordx4 v224, s[4:7], s98 offen sc1 lds
    s_waitcnt lgkmcnt(2)
    v_mfma_f32_32x32x16_bf16 v[0:15], a[232:235], v[216:219], v[0:15]
    ds_read_b128 a[248:251], v225 offset:59392
    v_fma_f32 v241, v241, v231, v231
    v_fma_f32 v242, v242, v231, v231
    v_fma_f32 v243, v243, v231, v231
    v_mfma_f32_32x32x16_bf16 v[0:15], a[236:239], v[220:223], v[0:15]
    ds_read_b128 a[252:255], v225 offset:60416
    s_add_u32 s98, s85, 6144
    s_add_u32 m0, s63, 135168
    s_nop 0
    buffer_load_dwordx4 v224, s[4:7], s98 offen sc1 lds
    s_waitcnt lgkmcnt(2)
    v_mfma_f32_32x32x16_bf16 v[16:31], a[240:243], v[64:67], 0
    ds_read_b128 a[232:235], v225 offset:61440
    v_rcp_f32 v240, v240
    v_rcp_f32 v241, v241
    v_mfma_f32_32x32x16_bf16 v[16:31], a[244:247], v[68:71], v[16:31]
    ds_read_b128 a[236:239], v225 offset:62464
    s_add_u32 s98, s86, 6144
    s_add_u32 m0, s63, 139264
    s_nop 0
    buffer_load_dwordx4 v224, s[4:7], s98 offen sc1 lds
    s_waitcnt lgkmcnt(2)
    v_mfma_f32_32x32x16_bf16 v[16:31], a[248:251], v[72:75], v[16:31]
    ds_read_b128 a[240:243], v225 offset:63488
    v_rcp_f32 v242, v242
    v_rcp_f32 v243, v243
    v_mul_f32 v40, v40, v240
    v_mfma_f32_32x32x16_bf16 v[16:31], a[252:255], v[76:79], v[16:31]
    ds_read_b128 a[244:247], v225 offset:64512
    s_add_u32 s98, s87, 6144
    s_add_u32 m0, s63, 143360
    s_nop 0
    buffer_load_dwordx4 v224, s[4:7], s98 offen sc1 lds
    v_mul_f32 v41, v41, v241
    s_waitcnt lgkmcnt(2)
    v_mfma_f32_32x32x16_bf16 v[16:31], a[232:235], v[80:83], v[16:31]
    ds_read_b128 a[248:251], v226 offset:0
    v_mul_f32 v42, v42, v242
    v_mul_f32 v43, v43, v243
    v_cvt_pk_bf16_f32 v38, v40, v41
    v_mfma_f32_32x32x16_bf16 v[16:31], a[236:239], v[84:87], v[16:31]
    ds_read_b128 a[252:255], v226 offset:1024
    s_add_u32 s98, s88, 6144
    s_add_u32 m0, s63, 147456
    s_nop 0
    buffer_load_dwordx4 v224, s[4:7], s98 offen sc1 lds
    v_cvt_pk_bf16_f32 v39, v42, v43
    s_waitcnt lgkmcnt(2)
    v_mfma_f32_32x32x16_bf16 v[16:31], a[240:243], v[88:91], v[16:31]
    ds_read_b128 a[232:235], v226 offset:2048
    s_and_b32 s74, s65, 3
    s_lshl_b32 s74, s74, 9
    s_add_u32 s74, s74, s77
    s_add_u32 s74, s74, 12288
    s_cmp_ge_u32 s65, 12
    s_cselect_b32 s75, 2147483648, 0
    v_or_b32 v254, s75, v228
    buffer_store_dwordx4 v[36:39], v254, s[4:7], s74 offen offset:0 sc1
    v_mfma_f32_32x32x16_bf16 v[16:31], a[244:247], v[92:95], v[16:31]
    ds_read_b128 a[236:239], v226 offset:3072
    s_add_u32 s98, s84, 7168
    s_add_u32 m0, s63, 151552
    s_nop 0
    buffer_load_dwordx4 v224, s[4:7], s98 offen sc1 lds
    s_waitcnt lgkmcnt(2)
    v_mfma_f32_32x32x16_bf16 v[16:31], a[248:251], v[96:99], v[16:31]
    ds_read_b128 a[240:243], v226 offset:4096
    ds_read_b128 v[232:235], v248 offset:384
    ds_read_b128 v[236:239], v248 offset:400
    ds_read_b128 v[240:243], v248 offset:416
    ds_read_b128 v[244:247], v248 offset:432
    s_waitcnt lgkmcnt(2)
    v_fmac_f32 v48, v229, v232
    v_mfma_f32_32x32x16_bf16 v[16:31], a[252:255], v[100:103], v[16:31]
    ds_read_b128 a[244:247], v226 offset:5120
    s_add_u32 s98, s85, 7168
    s_add_u32 m0, s63, 155648
    s_nop 0
    buffer_load_dwordx4 v224, s[4:7], s98 offen sc1 lds
    v_fmac_f32 v49, v229, v233
    v_mfma_f32_32x32x16_bf16 v[16:31], a[232:235], v[104:107], v[16:31]
    ds_read_b128 a[248:251], v226 offset:6144
    v_fmac_f32 v50, v229, v234
    v_fmac_f32 v51, v229, v235
    v_fmac_f32 v52, v229, v236
    v_mfma_f32_32x32x16_bf16 v[16:31], a[236:239], v[108:111], v[16:31]
    ds_read_b128 a[252:255], v226 offset:7168
    s_add_u32 s98, s86, 7168
    s_add_u32 m0, s63, 0
    s_nop 0
    buffer_load_dwordx4 v224, s[4:7], s98 offen sc1 lds
    v_fmac_f32 v53, v229, v237
    s_waitcnt lgkmcnt(2)
    v_mfma_f32_32x32x16_bf16 v[16:31], a[240:243], v[112:115], v[16:31]
    ds_read_b128 a[232:235], v226 offset:8192
    v_fmac_f32 v54, v229, v238
    v_fmac_f32 v55, v229, v239
    v_mul_f32 v232, v230, v48
    v_mfma_f32_32x32x16_bf16 v[16:31], a[244:247], v[116:119], v[16:31]
    ds_read_b128 a[236:239], v226 offset:9216
    v_mul_f32 v233, v230, v49
    v_mul_f32 v234, v230, v50
    v_mul_f32 v235, v230, v51
    s_waitcnt lgkmcnt(2)
    v_mfma_f32_32x32x16_bf16 v[16:31], a[248:251], v[120:123], v[16:31]
    ds_read_b128 a[240:243], v226 offset:10240
    v_exp_f32 v232, v232
    v_mul_f32 v48, v48, v52
    v_exp_f32 v233, v233
    v_mfma_f32_32x32x16_bf16 v[16:31], a[252:255], v[124:127], v[16:31]
    ds_read_b128 a[244:247], v226 offset:11264
    v_mul_f32 v49, v49, v53
    v_exp_f32 v234, v234
    v_mul_f32 v50, v50, v54
    s_waitcnt lgkmcnt(2)
    v_mfma_f32_32x32x16_bf16 v[16:31], a[232:235], v[128:131], v[16:31]
    ds_read_b128 a[248:251], v226 offset:20480
    v_exp_f32 v235, v235
    v_mul_f32 v51, v51, v55
    v_fma_f32 v232, v232, v231, v231
    v_mfma_f32_32x32x16_bf16 v[16:31], a[236:239], v[132:135], v[16:31]
    ds_read_b128 a[252:255], v226 offset:21504
    v_fma_f32 v233, v233, v231, v231
    v_fma_f32 v234, v234, v231, v231
    v_fma_f32 v235, v235, v231, v231
    s_waitcnt lgkmcnt(2)
    v_mfma_f32_32x32x16_bf16 v[16:31], a[240:243], v[136:139], v[16:31]
    ds_read_b128 a[232:235], v226 offset:22528
    v_rcp_f32 v232, v232
    v_rcp_f32 v233, v233
    v_mfma_f32_32x32x16_bf16 v[16:31], a[244:247], v[140:143], v[16:31]
    ds_read_b128 a[236:239], v226 offset:23552
    v_rcp_f32 v234, v234
    v_rcp_f32 v235, v235
    s_waitcnt lgkmcnt(2)
    v_mfma_f32_32x32x16_bf16 v[16:31], a[248:251], v[144:147], v[16:31]
    ds_read_b128 a[240:243], v226 offset:24576
    v_mul_f32 v48, v48, v232
    v_mul_f32 v49, v49, v233
    v_mul_f32 v50, v50, v234
    v_mfma_f32_32x32x16_bf16 v[16:31], a[252:255], v[148:151], v[16:31]
    ds_read_b128 a[244:247], v226 offset:25600
    v_mul_f32 v51, v51, v235
    v_cvt_pk_bf16_f32 v52, v48, v49
    v_cvt_pk_bf16_f32 v53, v50, v51
    s_waitcnt lgkmcnt(2)
    v_mfma_f32_32x32x16_bf16 v[16:31], a[232:235], v[152:155], v[16:31]
    ds_read_b128 a[248:251], v226 offset:26624
    v_fmac_f32 v56, v229, v240
    v_fmac_f32 v57, v229, v241
    v_fmac_f32 v58, v229, v242
    v_mfma_f32_32x32x16_bf16 v[16:31], a[236:239], v[156:159], v[16:31]
    ds_read_b128 a[252:255], v226 offset:27648
    v_fmac_f32 v59, v229, v243
    v_fmac_f32 v60, v229, v244
    v_fmac_f32 v61, v229, v245
    s_waitcnt lgkmcnt(2)
    v_mfma_f32_32x32x16_bf16 v[16:31], a[240:243], v[160:163], v[16:31]
    ds_read_b128 a[232:235], v226 offset:28672
    v_fmac_f32 v62, v229, v246
    v_fmac_f32 v63, v229, v247
    v_mul_f32 v240, v230, v56
    v_mfma_f32_32x32x16_bf16 v[16:31], a[244:247], v[164:167], v[16:31]
    ds_read_b128 a[236:239], v226 offset:29696
    v_mul_f32 v241, v230, v57
    v_mul_f32 v242, v230, v58
    v_mul_f32 v243, v230, v59
    s_waitcnt lgkmcnt(2)
    v_mfma_f32_32x32x16_bf16 v[16:31], a[248:251], v[168:171], v[16:31]
    ds_read_b128 a[240:243], v226 offset:30720
    v_exp_f32 v240, v240
    v_mul_f32 v56, v56, v60
    v_exp_f32 v241, v241
    v_mfma_f32_32x32x16_bf16 v[16:31], a[252:255], v[172:175], v[16:31]
    ds_read_b128 a[244:247], v226 offset:31744
    v_mul_f32 v57, v57, v61
    v_exp_f32 v242, v242
    v_mul_f32 v58, v58, v62
    s_waitcnt lgkmcnt(2)
    v_mfma_f32_32x32x16_bf16 v[16:31], a[232:235], v[176:179], v[16:31]
    ds_read_b128 a[248:251], v226 offset:32768
    v_exp_f32 v243, v243
    v_mul_f32 v59, v59, v63
    v_fma_f32 v240, v240, v231, v231
    v_mfma_f32_32x32x16_bf16 v[16:31], a[236:239], v[180:183], v[16:31]
    ds_read_b128 a[252:255], v226 offset:33792
    v_fma_f32 v241, v241, v231, v231
    v_fma_f32 v242, v242, v231, v231
    v_fma_f32 v243, v243, v231, v231
    s_waitcnt lgkmcnt(2)
    v_mfma_f32_32x32x16_bf16 v[16:31], a[240:243], v[184:187], v[16:31]
    ds_read_b128 a[232:235], v226 offset:34816
    v_rcp_f32 v240, v240
    v_rcp_f32 v241, v241
    v_mfma_f32_32x32x16_bf16 v[16:31], a[244:247], v[188:191], v[16:31]
    ds_read_b128 a[236:239], v226 offset:35840
    v_rcp_f32 v242, v242
    v_rcp_f32 v243, v243
    s_waitcnt lgkmcnt(2)
    v_mfma_f32_32x32x16_bf16 v[16:31], a[248:251], v[192:195], v[16:31]
    ds_read_b128 a[240:243], v226 offset:36864
    v_mul_f32 v56, v56, v240
    v_mul_f32 v57, v57, v241
    v_mul_f32 v58, v58, v242
    v_mfma_f32_32x32x16_bf16 v[16:31], a[252:255], v[196:199], v[16:31]
    ds_read_b128 a[244:247], v226 offset:37888
    v_mul_f32 v59, v59, v243
    v_cvt_pk_bf16_f32 v54, v56, v57
    v_cvt_pk_bf16_f32 v55, v58, v59
    s_waitcnt lgkmcnt(2)
    v_mfma_f32_32x32x16_bf16 v[16:31], a[232:235], v[200:203], v[16:31]
    ds_read_b128 a[248:251], v226 offset:38912
    s_and_b32 s74, s65, 3
    s_lshl_b32 s74, s74, 9
    s_add_u32 s74, s74, s77
    s_add_u32 s74, s74, 6144
    buffer_store_dwordx4 v[52:55], v228, s[4:7], s74 offen offset:0 sc1
    v_mfma_f32_32x32x16_bf16 v[16:31], a[236:239], v[204:207], v[16:31]
    ds_read_b128 a[252:255], v226 offset:39936
    ds_read_b128 v[232:235], v248 offset:0
    ds_read_b128 v[236:239], v248 offset:16
    ds_read_b128 v[240:243], v248 offset:32
    ds_read_b128 v[244:247], v248 offset:48
    s_waitcnt lgkmcnt(2)
    v_mfma_f32_32x32x16_bf16 v[16:31], a[240:243], v[208:211], v[16:31]
    ds_read_b128 a[232:235], v226 offset:40960
    v_fmac_f32 v0, v229, v232
    v_fmac_f32 v1, v229, v233
    v_fmac_f32 v2, v229, v234
    v_mfma_f32_32x32x16_bf16 v[16:31], a[244:247], v[212:215], v[16:31]
    ds_read_b128 a[236:239], v226 offset:41984
    v_fmac_f32 v3, v229, v235
    v_fmac_f32 v4, v229, v236
    v_fmac_f32 v5, v229, v237
    v_mfma_f32_32x32x16_bf16 v[16:31], a[248:251], v[216:219], v[16:31]
    ds_read_b128 a[240:243], v226 offset:43008
    v_fmac_f32 v6, v229, v238
    v_fmac_f32 v7, v229, v239
    v_mul_f32 v232, v230, v0
    v_mfma_f32_32x32x16_bf16 v[16:31], a[252:255], v[220:223], v[16:31]
    ds_read_b128 a[244:247], v226 offset:44032
    v_mul_f32 v233, v230, v1
    v_mul_f32 v234, v230, v2
    v_mul_f32 v235, v230, v3
    s_waitcnt lgkmcnt(2)
    v_mfma_f32_32x32x16_bf16 v[32:47], a[232:235], v[64:67], 0
    ds_read_b128 a[248:251], v226 offset:45056
    v_exp_f32 v232, v232
    v_mul_f32 v0, v0, v4
    v_exp_f32 v233, v233
    v_mfma_f32_32x32x16_bf16 v[32:47], a[236:239], v[68:71], v[32:47]
    ds_read_b128 a[252:255], v226 offset:46080
    v_mul_f32 v1, v1, v5
    v_exp_f32 v234, v234
    v_mul_f32 v2, v2, v6
    s_waitcnt lgkmcnt(2)
    v_mfma_f32_32x32x16_bf16 v[32:47], a[240:243], v[72:75], v[32:47]
    ds_read_b128 a[232:235], v226 offset:47104
    v_exp_f32 v235, v235
    v_mul_f32 v3, v3, v7
    v_fma_f32 v232, v232, v231, v231
    v_mfma_f32_32x32x16_bf16 v[32:47], a[244:247], v[76:79], v[32:47]
    ds_read_b128 a[236:239], v226 offset:48128
    v_fma_f32 v233, v233, v231, v231
    v_fma_f32 v234, v234, v231, v231
    v_fma_f32 v235, v235, v231, v231
    s_waitcnt vmcnt(11)
    s_waitcnt vmcnt(0)
    s_barrier
    s_lshl_b32 s74, s64, 9
    s_lshl_b32 s75, s65, 2
    s_add_u32 s74, s74, s75
    s_add_u32 s74, s74, 20480
    s_cmp_lg_u32 s59, 0
    s_cbranch_scc1 L_fs_63
    v_mbcnt_lo_u32_b32 v250, -1, 0
    v_mul_u32_u24 v250, 128, v250
    v_mov_b32 v251, s3
    s_mov_b64 exec, 15
    buffer_store_dword v251, v250, s[4:7], s74 offen sc1
    s_mov_b64 exec, -1
L_fs_63:
    s_waitcnt lgkmcnt(2)
    v_mfma_f32_32x32x16_bf16 v[32:47], a[248:251], v[80:83], v[32:47]
    ds_read_b128 a[240:243], v226 offset:49152
    v_rcp_f32 v232, v232
    v_rcp_f32 v233, v233
    v_mfma_f32_32x32x16_bf16 v[32:47], a[252:255], v[84:87], v[32:47]
    ds_read_b128 a[244:247], v226 offset:50176
    v_rcp_f32 v234, v234
    v_rcp_f32 v235, v235
    s_waitcnt lgkmcnt(2)
    v_mfma_f32_32x32x16_bf16 v[32:47], a[232:235], v[88:91], v[32:47]
    ds_read_b128 a[248:251], v226 offset:51200
    v_mul_f32 v0, v0, v232
    v_mul_f32 v1, v1, v233
    v_mul_f32 v2, v2, v234
    v_mfma_f32_32x32x16_bf16 v[32:47], a[236:239], v[92:95], v[32:47]
    ds_read_b128 a[252:255], v226 offset:52224
    v_mul_f32 v3, v3, v235
    v_cvt_pk_bf16_f32 v4, v0, v1
    v_cvt_pk_bf16_f32 v5, v2, v3
    s_waitcnt lgkmcnt(2)
    v_mfma_f32_32x32x16_bf16 v[32:47], a[240:243], v[96:99], v[32:47]
    ds_read_b128 a[232:235], v225 offset:36864
    v_fmac_f32 v8, v229, v240
    v_fmac_f32 v9, v229, v241
    v_fmac_f32 v10, v229, v242
    v_mfma_f32_32x32x16_bf16 v[32:47], a[244:247], v[100:103], v[32:47]
    ds_read_b128 a[236:239], v225 offset:37888
    v_fmac_f32 v11, v229, v243
    v_fmac_f32 v12, v229, v244
    v_fmac_f32 v13, v229, v245
    s_waitcnt lgkmcnt(2)
    v_mfma_f32_32x32x16_bf16 v[32:47], a[248:251], v[104:107], v[32:47]
    ds_read_b128 a[240:243], v225 offset:38912
    v_fmac_f32 v14, v229, v246
    v_fmac_f32 v15, v229, v247
    v_mul_f32 v240, v230, v8
    v_mfma_f32_32x32x16_bf16 v[32:47], a[252:255], v[108:111], v[32:47]
    ds_read_b128 a[244:247], v225 offset:39936
    v_mul_f32 v241, v230, v9
    v_mul_f32 v242, v230, v10
    v_mul_f32 v243, v230, v11
    s_waitcnt lgkmcnt(2)
    v_mfma_f32_32x32x16_bf16 v[32:47], a[232:235], v[112:115], v[32:47]
    ds_read_b128 a[248:251], v225 offset:40960
    v_exp_f32 v240, v240
    v_mul_f32 v8, v8, v12
    v_exp_f32 v241, v241
    v_mfma_f32_32x32x16_bf16 v[32:47], a[236:239], v[116:119], v[32:47]
    ds_read_b128 a[252:255], v225 offset:41984
    v_mul_f32 v9, v9, v13
    v_exp_f32 v242, v242
    v_mul_f32 v10, v10, v14
    s_waitcnt lgkmcnt(2)
    v_mfma_f32_32x32x16_bf16 v[32:47], a[240:243], v[120:123], v[32:47]
    ds_read_b128 a[232:235], v225 offset:43008
    v_exp_f32 v243, v243
    v_mul_f32 v11, v11, v15
    v_fma_f32 v240, v240, v231, v231
    v_mfma_f32_32x32x16_bf16 v[32:47], a[244:247], v[124:127], v[32:47]
    ds_read_b128 a[236:239], v225 offset:44032
    v_fma_f32 v241, v241, v231, v231
    v_fma_f32 v242, v242, v231, v231
    v_fma_f32 v243, v243, v231, v231
    s_waitcnt lgkmcnt(2)
    v_mfma_f32_32x32x16_bf16 v[32:47], a[248:251], v[128:131], v[32:47]
    ds_read_b128 a[240:243], v226 offset:12288
    v_rcp_f32 v240, v240
    v_rcp_f32 v241, v241
    v_mfma_f32_32x32x16_bf16 v[32:47], a[252:255], v[132:135], v[32:47]
    ds_read_b128 a[244:247], v226 offset:13312
    v_rcp_f32 v242, v242
    v_rcp_f32 v243, v243
    s_waitcnt lgkmcnt(2)
    v_mfma_f32_32x32x16_bf16 v[32:47], a[232:235], v[136:139], v[32:47]
    ds_read_b128 a[248:251], v226 offset:14336
    v_mul_f32 v8, v8, v240
    v_mul_f32 v9, v9, v241
    v_mul_f32 v10, v10, v242
    v_mfma_f32_32x32x16_bf16 v[32:47], a[236:239], v[140:143], v[32:47]
    ds_read_b128 a[252:255], v226 offset:15360
    v_mul_f32 v11, v11, v243
    v_cvt_pk_bf16_f32 v6, v8, v9
    v_cvt_pk_bf16_f32 v7, v10, v11
    s_waitcnt lgkmcnt(2)
    v_mfma_f32_32x32x16_bf16 v[32:47], a[240:243], v[144:147], v[32:47]
    ds_read_b128 a[232:235], v226 offset:16384
    s_and_b32 s74, s65, 3
    s_lshl_b32 s74, s74, 10
    s_add_u32 s74, s74, s77
    buffer_store_dwordx4 v[4:7], v228, s[4:7], s74 offen offset:0 sc1
    v_mfma_f32_32x32x16_bf16 v[32:47], a[244:247], v[148:151], v[32:47]
    ds_read_b128 a[236:239], v226 offset:17408
    ds_read_b128 v[232:235], v248 offset:128
    ds_read_b128 v[236:239], v248 offset:144
    ds_read_b128 v[240:243], v248 offset:160
    ds_read_b128 v[244:247], v248 offset:176
    s_waitcnt lgkmcnt(2)
    v_mfma_f32_32x32x16_bf16 v[32:47], a[248:251], v[152:155], v[32:47]
    ds_read_b128 a[240:243], v226 offset:18432
    v_fmac_f32 v16, v229, v232
    v_fmac_f32 v17, v229, v233
    v_fmac_f32 v18, v229, v234
    v_mfma_f32_32x32x16_bf16 v[32:47], a[252:255], v[156:159], v[32:47]
    ds_read_b128 a[244:247], v226 offset:19456
    v_fmac_f32 v19, v229, v235
    v_fmac_f32 v20, v229, v236
    v_fmac_f32 v21, v229, v237
    v_mfma_f32_32x32x16_bf16 v[32:47], a[232:235], v[160:163], v[32:47]
    ds_read_b128 a[248:251], v226 offset:53248
    v_fmac_f32 v22, v229, v238
    v_fmac_f32 v23, v229, v239
    v_mul_f32 v232, v230, v16
    v_mfma_f32_32x32x16_bf16 v[32:47], a[236:239], v[164:167], v[32:47]
    ds_read_b128 a[252:255], v226 offset:54272
    v_mul_f32 v233, v230, v17
    v_mul_f32 v234, v230, v18
    v_mul_f32 v235, v230, v19
    s_waitcnt lgkmcnt(2)
    v_mfma_f32_32x32x16_bf16 v[32:47], a[240:243], v[168:171], v[32:47]
    ds_read_b128 a[232:235], v226 offset:55296
    v_exp_f32 v232, v232
    v_mul_f32 v16, v16, v20
    v_exp_f32 v233, v233
    v_mfma_f32_32x32x16_bf16 v[32:47], a[244:247], v[172:175], v[32:47]
    ds_read_b128 a[236:239], v226 offset:56320
    v_mul_f32 v17, v17, v21
    v_exp_f32 v234, v234
    v_mul_f32 v18, v18, v22
    s_waitcnt lgkmcnt(2)
    v_mfma_f32_32x32x16_bf16 v[32:47], a[248:251], v[176:179], v[32:47]
    ds_read_b128 a[240:243], v226 offset:57344
    v_exp_f32 v235, v235
    v_mul_f32 v19, v19, v23
    v_fma_f32 v232, v232, v231, v231
    v_mfma_f32_32x32x16_bf16 v[32:47], a[252:255], v[180:183], v[32:47]
    ds_read_b128 a[244:247], v226 offset:58368
    v_fma_f32 v233, v233, v231, v231
    v_fma_f32 v234, v234, v231, v231
    v_fma_f32 v235, v235, v231, v231
    s_waitcnt lgkmcnt(2)
    v_mfma_f32_32x32x16_bf16 v[32:47], a[232:235], v[184:187], v[32:47]
    ds_read_b128 a[248:251], v226 offset:59392
    v_rcp_f32 v232, v232
    v_rcp_f32 v233, v233
    v_mfma_f32_32x32x16_bf16 v[32:47], a[236:239], v[188:191], v[32:47]
    ds_read_b128 a[252:255], v226 offset:60416
    v_rcp_f32 v234, v234
    v_rcp_f32 v235, v235
    s_waitcnt lgkmcnt(2)
    v_mfma_f32_32x32x16_bf16 v[32:47], a[240:243], v[192:195], v[32:47]
    ds_read_b128 a[232:235], v226 offset:61440
    v_mul_f32 v16, v16, v232
    v_mul_f32 v17, v17, v233
    v_mul_f32 v18, v18, v234
    v_mfma_f32_32x32x16_bf16 v[32:47], a[244:247], v[196:199], v[32:47]
    ds_read_b128 a[236:239], v226 offset:62464
    v_mul_f32 v19, v19, v235
    v_cvt_pk_bf16_f32 v20, v16, v17
    v_cvt_pk_bf16_f32 v21, v18, v19
    s_waitcnt lgkmcnt(2)
    v_mfma_f32_32x32x16_bf16 v[32:47], a[248:251], v[200:203], v[32:47]
    ds_read_b128 a[240:243], v226 offset:63488
    v_fmac_f32 v24, v229, v240
    v_fmac_f32 v25, v229, v241
    v_fmac_f32 v26, v229, v242
    v_mfma_f32_32x32x16_bf16 v[32:47], a[252:255], v[204:207], v[32:47]
    ds_read_b128 a[244:247], v226 offset:64512
    v_fmac_f32 v27, v229, v243
    v_fmac_f32 v28, v229, v244
    v_fmac_f32 v29, v229, v245
    s_waitcnt lgkmcnt(2)
    v_mfma_f32_32x32x16_bf16 v[32:47], a[232:235], v[208:211], v[32:47]
    v_fmac_f32 v30, v229, v246
    v_fmac_f32 v31, v229, v247
    v_mul_f32 v240, v230, v24
    v_mfma_f32_32x32x16_bf16 v[32:47], a[236:239], v[212:215], v[32:47]
    v_mul_f32 v241, v230, v25
    v_mul_f32 v242, v230, v26
    v_mul_f32 v243, v230, v27
    s_waitcnt lgkmcnt(0)
    v_mfma_f32_32x32x16_bf16 v[32:47], a[240:243], v[216:219], v[32:47]
    v_exp_f32 v240, v240
    v_mul_f32 v24, v24, v28
    v_exp_f32 v241, v241
    v_mfma_f32_32x32x16_bf16 v[32:47], a[244:247], v[220:223], v[32:47]
    v_mul_f32 v25, v25, v29
    v_exp_f32 v242, v242
    v_mul_f32 v26, v26, v30
    v_lshrrev_b32 v249, 4, v224
    v_min_u32 v249, 3, v249
    s_lshl_b32 s75, s59, 2
    v_add_u32 v249, s75, v249
    v_lshlrev_b32 v249, 2, v249
    s_lshr_b32 s80, s68, 1
    s_lshl_b32 s80, s80, 2
    s_add_u32 s80, s80, s59
    s_lshl_b32 s80, s80, 7
    s_add_u32 s80, s80, 20480
    buffer_load_dword v250, v249, s[4:7], s80 offen sc1
    v_exp_f32 v243, v243
    v_mul_f32 v27, v27, v31
    v_fma_f32 v240, v240, v231, v231
    v_fma_f32 v241, v241, v231, v231
    v_fma_f32 v242, v242, v231, v231
    v_fma_f32 v243, v243, v231, v231
    v_rcp_f32 v240, v240
    v_rcp_f32 v241, v241
    v_rcp_f32 v242, v242
    v_rcp_f32 v243, v243
    v_mul_f32 v24, v24, v240
    v_mul_f32 v25, v25, v241
    v_mul_f32 v26, v26, v242
    v_mul_f32 v27, v27, v243
    v_cvt_pk_bf16_f32 v22, v24, v25
    v_cvt_pk_bf16_f32 v23, v26, v27
    s_and_b32 s74, s65, 3
    s_lshl_b32 s74, s74, 10
    s_add_u32 s74, s74, s77
    buffer_store_dwordx4 v[20:23], v228, s[4:7], s74 offen offset:512 sc1
    ds_read_b128 v[232:235], v248 offset:256
    ds_read_b128 v[236:239], v248 offset:272
    ds_read_b128 v[240:243], v248 offset:288
    ds_read_b128 v[244:247], v248 offset:304
    s_waitcnt lgkmcnt(2)
    v_fmac_f32 v32, v229, v232
    v_fmac_f32 v33, v229, v233
    v_fmac_f32 v34, v229, v234
    v_fmac_f32 v35, v229, v235
    v_fmac_f32 v36, v229, v236
    v_fmac_f32 v37, v229, v237
    v_fmac_f32 v38, v229, v238
    v_fmac_f32 v39, v229, v239
    v_mul_f32 v232, v230, v32
    v_mul_f32 v233, v230, v33
    v_mul_f32 v234, v230, v34
    v_mul_f32 v235, v230, v35
    v_exp_f32 v232, v232
    v_mul_f32 v32, v32, v36
    v_exp_f32 v233, v233
    v_mul_f32 v33, v33, v37
    v_exp_f32 v234, v234
    v_mul_f32 v34, v34, v38
    v_exp_f32 v235, v235
    v_mul_f32 v35, v35, v39
    v_fma_f32 v232, v232, v231, v231
    v_fma_f32 v233, v233, v231, v231
    v_fma_f32 v234, v234, v231, v231
    v_fma_f32 v235, v235, v231, v231
    v_rcp_f32 v232, v232
    v_rcp_f32 v233, v233
    v_rcp_f32 v234, v234
    v_rcp_f32 v235, v235
    v_mul_f32 v32, v32, v232
    v_mul_f32 v33, v33, v233
    v_mul_f32 v34, v34, v234
    v_mul_f32 v35, v35, v235
    v_cvt_pk_bf16_f32 v36, v32, v33
    v_cvt_pk_bf16_f32 v37, v34, v35
    s_waitcnt lgkmcnt(0)
    v_fmac_f32 v40, v229, v240
    v_fmac_f32 v41, v229, v241
    v_fmac_f32 v42, v229, v242
    v_fmac_f32 v43, v229, v243
    v_fmac_f32 v44, v229, v244
    v_fmac_f32 v45, v229, v245
    v_fmac_f32 v46, v229, v246
    v_fmac_f32 v47, v229, v247
    v_mul_f32 v240, v230, v40
    v_mul_f32 v241, v230, v41
    v_mul_f32 v242, v230, v42
    v_mul_f32 v243, v230, v43
    v_exp_f32 v240, v240
    v_mul_f32 v40, v40, v44
    v_exp_f32 v241, v241
    v_mul_f32 v41, v41, v45
    v_exp_f32 v242, v242
    v_mul_f32 v42, v42, v46
    v_exp_f32 v243, v243
    v_mul_f32 v43, v43, v47
    v_fma_f32 v240, v240, v231, v231
    v_fma_f32 v241, v241, v231, v231
    v_fma_f32 v242, v242, v231, v231
    v_fma_f32 v243, v243, v231, v231
    v_rcp_f32 v240, v240
    v_rcp_f32 v241, v241
    v_rcp_f32 v242, v242
    v_rcp_f32 v243, v243
    v_mul_f32 v40, v40, v240
    v_mul_f32 v41, v41, v241
    v_mul_f32 v42, v42, v242
    v_mul_f32 v43, v43, v243
    v_cvt_pk_bf16_f32 v38, v40, v41
    v_cvt_pk_bf16_f32 v39, v42, v43
    s_and_b32 s74, s65, 3
    s_lshl_b32 s74, s74, 9
    s_add_u32 s74, s74, s77
    s_add_u32 s74, s74, 4096
    buffer_store_dwordx4 v[36:39], v228, s[4:7], s74 offen offset:0 sc1
    s_lshl_b32 s79, s64, 9
    s_lshl_b32 s75, s65, 2
    s_add_u32 s79, s79, s75
    s_add_u32 s79, s79, 20544
    s_load_dwordx2 s[8:9], s[0:1], 80
    s_mov_b32 s10, 2621440
    s_mov_b32 s11, 0x00020000
    v_mov_b32 v242, 2147483648
    s_cmp_eq_u32 s59, 3
    s_cselect_b32 s74, -1, 0
    v_and_b32 v242, s74, v242
    v_or_b32 v242, v242, v224
    v_lshrrev_b32 v244, 8, v224
    v_lshlrev_b32 v244, 8, v244
    v_bfe_u32 v243, v224, 4, 4
    v_lshl_add_u32 v243, v243, 3, v244
    s_lshl_b32 s75, s68, 1
    s_lshr_b32 s76, s59, 1
    s_add_u32 s75, s75, s76
    s_mul_i32 s75, s75, 40960
    s_mul_i32 s76, s69, 5120
    s_add_u32 s75, s75, s76
    s_and_b32 s76, s59, 1
    s_lshl_b32 s76, s76, 7
    s_add_u32 s94, s75, s76
    s_waitcnt vmcnt(2)
    v_cmp_ne_u32 vcc, s3, v250
    s_cbranch_vccnz L_spin_64
L_back_65:
    buffer_load_dwordx4 v[64:67], v224, s[4:7], s90 offen offset:0 sc1
    buffer_load_dwordx4 v[68:71], v224, s[4:7], s91 offen offset:0 sc1
    buffer_load_dwordx4 v[72:75], v224, s[4:7], s92 offen offset:0 sc1
    buffer_load_dwordx4 v[76:79], v224, s[4:7], s93 offen offset:0 sc1
    buffer_load_dwordx4 v[80:83], v224, s[4:7], s90 offen offset:1024 sc1
    buffer_load_dwordx4 v[84:87], v224, s[4:7], s91 offen offset:1024 sc1
    buffer_load_dwordx4 v[88:91], v224, s[4:7], s92 offen offset:1024 sc1
    buffer_load_dwordx4 v[92:95], v224, s[4:7], s93 offen offset:1024 sc1
    s_waitcnt vmcnt(8)
    s_barrier
    s_cmp_lg_u32 s59, 0
    s_cbranch_scc1 L_fs_66
    v_mbcnt_lo_u32_b32 v251, -1, 0
    v_mul_u32_u24 v251, 128, v251
    v_mov_b32 v252, s3
    s_mov_b64 exec, 15
    buffer_store_dword v252, v251, s[4:7], s79 offen sc1
    s_mov_b64 exec, -1
L_fs_66:
    s_lshr_b32 s74, s71, 2
    v_add_u32 v244, s74, v224
    v_add_u32 v245, 126976, v244
    ds_read_b128 v[0:3], v245 offset:4096
    ds_read_b128 v[4:7], v245 offset:8192
    ds_read_b128 v[8:11], v245 offset:12288
    ds_read_b128 v[12:15], v245 offset:16384
    ds_read_b128 v[16:19], v245 offset:20480
    ds_read_b128 v[20:23], v245 offset:24576
    ds_read_b128 v[24:27], v245 offset:28672
    ds_read_b128 v[28:31], v244 offset:0
    buffer_load_dwordx4 v[96:99], v224, s[4:7], s90 offen offset:2048 sc1
    buffer_load_dwordx4 v[100:103], v224, s[4:7], s91 offen offset:2048 sc1
    buffer_load_dwordx4 v[104:107], v224, s[4:7], s92 offen offset:2048 sc1
    buffer_load_dwordx4 v[108:111], v224, s[4:7], s93 offen offset:2048 sc1
    buffer_load_dwordx4 v[112:115], v224, s[4:7], s90 offen offset:3072 sc1
    buffer_load_dwordx4 v[116:119], v224, s[4:7], s91 offen offset:3072 sc1
    buffer_load_dwordx4 v[120:123], v224, s[4:7], s92 offen offset:3072 sc1
    buffer_load_dwordx4 v[124:127], v224, s[4:7], s93 offen offset:3072 sc1
    s_waitcnt vmcnt(15)
    v_mfma_f32_16x16x32_bf16 v[144:147], a[112:115], v[64:67], 0
    s_add_u32 s90, s90, 4096
    buffer_load_dwordx4 v[128:131], v242, s[4:7], s90 offen offset:0 sc1
    v_mfma_f32_16x16x32_bf16 v[148:151], a[116:119], v[64:67], 0
    v_mfma_f32_16x16x32_bf16 v[152:155], a[120:123], v[64:67], 0
    v_mfma_f32_16x16x32_bf16 v[156:159], a[124:127], v[64:67], 0
    v_mfma_f32_16x16x32_bf16 v[160:163], a[128:131], v[64:67], 0
    s_waitcnt vmcnt(15)
    v_mfma_f32_16x16x32_bf16 v[164:167], a[112:115], v[68:71], 0
    s_add_u32 s91, s91, 4096
    buffer_load_dwordx4 v[132:135], v242, s[4:7], s91 offen offset:0 sc1
    v_mfma_f32_16x16x32_bf16 v[168:171], a[116:119], v[68:71], 0
    v_mfma_f32_16x16x32_bf16 v[172:175], a[120:123], v[68:71], 0
    v_mfma_f32_16x16x32_bf16 v[176:179], a[124:127], v[68:71], 0
    v_mfma_f32_16x16x32_bf16 v[180:183], a[128:131], v[68:71], 0
    s_waitcnt vmcnt(15)
    v_mfma_f32_16x16x32_bf16 v[184:187], a[112:115], v[72:75], 0
    s_add_u32 s92, s92, 4096
    buffer_load_dwordx4 v[136:139], v242, s[4:7], s92 offen offset:0 sc1
    v_mfma_f32_16x16x32_bf16 v[188:191], a[116:119], v[72:75], 0
    v_mfma_f32_16x16x32_bf16 v[192:195], a[120:123], v[72:75], 0
    v_mfma_f32_16x16x32_bf16 v[196:199], a[124:127], v[72:75], 0
    v_mfma_f32_16x16x32_bf16 v[200:203], a[128:131], v[72:75], 0
    s_waitcnt vmcnt(15)
    v_mfma_f32_16x16x32_bf16 v[204:207], a[112:115], v[76:79], 0
    s_add_u32 s93, s93, 4096
    buffer_load_dwordx4 v[140:143], v242, s[4:7], s93 offen offset:0 sc1
    v_mfma_f32_16x16x32_bf16 v[208:211], a[116:119], v[76:79], 0
    v_mfma_f32_16x16x32_bf16 v[212:215], a[120:123], v[76:79], 0
    v_mfma_f32_16x16x32_bf16 v[216:219], a[124:127], v[76:79], 0
    v_mfma_f32_16x16x32_bf16 v[220:223], a[128:131], v[76:79], 0
    s_waitcnt vmcnt(15)
    v_mfma_f32_16x16x32_bf16 v[144:147], a[132:135], v[80:83], v[144:147]
    buffer_load_dwordx4 v[64:67], v242, s[4:7], s90 offen offset:1024 sc1
    v_mfma_f32_16x16x32_bf16 v[148:151], a[136:139], v[80:83], v[148:151]
    v_mfma_f32_16x16x32_bf16 v[152:155], a[140:143], v[80:83], v[152:155]
    s_add_u32 s74, s87, 4096
    buffer_load_dwordx4 v[32:35], v224, s[4:7], s74 offen offset:3072 sc1
    v_mfma_f32_16x16x32_bf16 v[156:159], a[144:147], v[80:83], v[156:159]
    v_mfma_f32_16x16x32_bf16 v[160:163], a[148:151], v[80:83], v[160:163]
    s_add_u32 s74, s88, 4096
    buffer_load_dwordx4 v[36:39], v224, s[4:7], s74 offen offset:3072 sc1
    s_waitcnt vmcnt(17)
    v_mfma_f32_16x16x32_bf16 v[164:167], a[132:135], v[84:87], v[164:167]
    buffer_load_dwordx4 v[68:71], v242, s[4:7], s91 offen offset:1024 sc1
    v_mfma_f32_16x16x32_bf16 v[168:171], a[136:139], v[84:87], v[168:171]
    v_mfma_f32_16x16x32_bf16 v[172:175], a[140:143], v[84:87], v[172:175]
    s_add_u32 s74, s87, 4096
    buffer_load_dwordx4 v[40:43], v224, s[4:7], s74 offen offset:1024 sc1
    v_mfma_f32_16x16x32_bf16 v[176:179], a[144:147], v[84:87], v[176:179]
    v_mfma_f32_16x16x32_bf16 v[180:183], a[148:151], v[84:87], v[180:183]
    s_add_u32 s74, s88, 4096
    buffer_load_dwordx4 v[44:47], v224, s[4:7], s74 offen offset:1024 sc1
    s_waitcnt vmcnt(19)
    v_mfma_f32_16x16x32_bf16 v[184:187], a[132:135], v[88:91], v[184:187]
    buffer_load_dwordx4 v[72:75], v242, s[4:7], s92 offen offset:1024 sc1
    v_mfma_f32_16x16x32_bf16 v[188:191], a[136:139], v[88:91], v[188:191]
    v_mfma_f32_16x16x32_bf16 v[192:195], a[140:143], v[88:91], v[192:195]
    v_mfma_f32_16x16x32_bf16 v[196:199], a[144:147], v[88:91], v[196:199]
    v_mfma_f32_16x16x32_bf16 v[200:203], a[148:151], v[88:91], v[200:203]
    s_waitcnt vmcnt(19)
    v_mfma_f32_16x16x32_bf16 v[204:207], a[132:135], v[92:95], v[204:207]
    buffer_load_dwordx4 v[76:79], v242, s[4:7], s93 offen offset:1024 sc1
    v_mfma_f32_16x16x32_bf16 v[208:211], a[136:139], v[92:95], v[208:211]
    v_mfma_f32_16x16x32_bf16 v[212:215], a[140:143], v[92:95], v[212:215]
    v_mfma_f32_16x16x32_bf16 v[216:219], a[144:147], v[92:95], v[216:219]
    v_mfma_f32_16x16x32_bf16 v[220:223], a[148:151], v[92:95], v[220:223]
    s_waitcnt vmcnt(19)
    v_mfma_f32_16x16x32_bf16 v[144:147], a[152:155], v[96:99], v[144:147]
    s_sub_u32 s90, s90, 8192
    buffer_load_dwordx4 v[80:83], v224, s[4:7], s90 offen offset:2048 sc1
    v_mfma_f32_16x16x32_bf16 v[148:151], a[156:159], v[96:99], v[148:151]
    v_mfma_f32_16x16x32_bf16 v[152:155], a[160:163], v[96:99], v[152:155]
    v_mfma_f32_16x16x32_bf16 v[156:159], a[164:167], v[96:99], v[156:159]
    v_mfma_f32_16x16x32_bf16 v[160:163], a[168:171], v[96:99], v[160:163]
    s_waitcnt vmcnt(19)
    v_mfma_f32_16x16x32_bf16 v[164:167], a[152:155], v[100:103], v[164:167]
    s_sub_u32 s91, s91, 8192
    buffer_load_dwordx4 v[84:87], v224, s[4:7], s91 offen offset:2048 sc1
    v_mfma_f32_16x16x32_bf16 v[168:171], a[156:159], v[100:103], v[168:171]
    v_mfma_f32_16x16x32_bf16 v[172:175], a[160:163], v[100:103], v[172:175]
    v_mfma_f32_16x16x32_bf16 v[176:179], a[164:167], v[100:103], v[176:179]
    v_mfma_f32_16x16x32_bf16 v[180:183], a[168:171], v[100:103], v[180:183]
    s_waitcnt vmcnt(19)
    v_mfma_f32_16x16x32_bf16 v[184:187], a[152:155], v[104:107], v[184:187]
    s_sub_u32 s92, s92, 8192
    buffer_load_dwordx4 v[88:91], v224, s[4:7], s92 offen offset:2048 sc1
    v_mfma_f32_16x16x32_bf16 v[188:191], a[156:159], v[104:107], v[188:191]
    v_mfma_f32_16x16x32_bf16 v[192:195], a[160:163], v[104:107], v[192:195]
    v_mfma_f32_16x16x32_bf16 v[196:199], a[164:167], v[104:107], v[196:199]
    v_mfma_f32_16x16x32_bf16 v[200:203], a[168:171], v[104:107], v[200:203]
    s_waitcnt vmcnt(19)
    v_mfma_f32_16x16x32_bf16 v[204:207], a[152:155], v[108:111], v[204:207]
    s_sub_u32 s93, s93, 8192
    buffer_load_dwordx4 v[92:95], v224, s[4:7], s93 offen offset:2048 sc1
    v_mfma_f32_16x16x32_bf16 v[208:211], a[156:159], v[108:111], v[208:211]
    v_mfma_f32_16x16x32_bf16 v[212:215], a[160:163], v[108:111], v[212:215]
    v_mfma_f32_16x16x32_bf16 v[216:219], a[164:167], v[108:111], v[216:219]
    v_mfma_f32_16x16x32_bf16 v[220:223], a[168:171], v[108:111], v[220:223]
    s_waitcnt vmcnt(19)
    v_mfma_f32_16x16x32_bf16 v[144:147], a[172:175], v[112:115], v[144:147]
    buffer_load_dwordx4 v[96:99], v224, s[4:7], s90 offen offset:3072 sc1
    v_mfma_f32_16x16x32_bf16 v[148:151], a[176:179], v[112:115], v[148:151]
    v_mfma_f32_16x16x32_bf16 v[152:155], a[180:183], v[112:115], v[152:155]
    v_mfma_f32_16x16x32_bf16 v[156:159], a[184:187], v[112:115], v[156:159]
    v_mfma_f32_16x16x32_bf16 v[160:163], a[188:191], v[112:115], v[160:163]
    s_waitcnt vmcnt(19)
    v_mfma_f32_16x16x32_bf16 v[164:167], a[172:175], v[116:119], v[164:167]
    buffer_load_dwordx4 v[100:103], v224, s[4:7], s91 offen offset:3072 sc1
    v_mfma_f32_16x16x32_bf16 v[168:171], a[176:179], v[116:119], v[168:171]
    v_mfma_f32_16x16x32_bf16 v[172:175], a[180:183], v[116:119], v[172:175]
    v_mfma_f32_16x16x32_bf16 v[176:179], a[184:187], v[116:119], v[176:179]
    v_mfma_f32_16x16x32_bf16 v[180:183], a[188:191], v[116:119], v[180:183]
    s_waitcnt vmcnt(19)
    v_mfma_f32_16x16x32_bf16 v[184:187], a[172:175], v[120:123], v[184:187]
    buffer_load_dwordx4 v[104:107], v224, s[4:7], s92 offen offset:3072 sc1
    v_mfma_f32_16x16x32_bf16 v[188:191], a[176:179], v[120:123], v[188:191]
    v_mfma_f32_16x16x32_bf16 v[192:195], a[180:183], v[120:123], v[192:195]
    v_mfma_f32_16x16x32_bf16 v[196:199], a[184:187], v[120:123], v[196:199]
    v_mfma_f32_16x16x32_bf16 v[200:203], a[188:191], v[120:123], v[200:203]
    s_waitcnt vmcnt(19)
    v_mfma_f32_16x16x32_bf16 v[204:207], a[172:175], v[124:127], v[204:207]
    buffer_load_dwordx4 v[108:111], v224, s[4:7], s93 offen offset:3072 sc1
    v_mfma_f32_16x16x32_bf16 v[208:211], a[176:179], v[124:127], v[208:211]
    v_mfma_f32_16x16x32_bf16 v[212:215], a[180:183], v[124:127], v[212:215]
    v_mfma_f32_16x16x32_bf16 v[216:219], a[184:187], v[124:127], v[216:219]
    v_mfma_f32_16x16x32_bf16 v[220:223], a[188:191], v[124:127], v[220:223]
    s_waitcnt vmcnt(19)
    buffer_load_dword v250, v249, s[4:7], s80 offen offset:64 sc1
    v_mfma_f32_16x16x32_bf16 v[144:147], a[192:195], v[128:131], v[144:147]
    v_mfma_f32_16x16x32_bf16 v[148:151], a[196:199], v[128:131], v[148:151]
    v_mfma_f32_16x16x32_bf16 v[152:155], a[200:203], v[128:131], v[152:155]
    v_mfma_f32_16x16x32_bf16 v[156:159], a[204:207], v[128:131], v[156:159]
    v_mfma_f32_16x16x32_bf16 v[160:163], a[208:211], v[128:131], v[160:163]
    s_waitcnt vmcnt(19)
    v_mfma_f32_16x16x32_bf16 v[164:167], a[192:195], v[132:135], v[164:167]
    v_mfma_f32_16x16x32_bf16 v[168:171], a[196:199], v[132:135], v[168:171]
    v_mfma_f32_16x16x32_bf16 v[172:175], a[200:203], v[132:135], v[172:175]
    v_mfma_f32_16x16x32_bf16 v[176:179], a[204:207], v[132:135], v[176:179]
    v_mfma_f32_16x16x32_bf16 v[180:183], a[208:211], v[132:135], v[180:183]
    s_waitcnt vmcnt(18)
    v_mfma_f32_16x16x32_bf16 v[184:187], a[192:195], v[136:139], v[184:187]
    v_mfma_f32_16x16x32_bf16 v[188:191], a[196:199], v[136:139], v[188:191]
    v_mfma_f32_16x16x32_bf16 v[192:195], a[200:203], v[136:139], v[192:195]
    v_mfma_f32_16x16x32_bf16 v[196:199], a[204:207], v[136:139], v[196:199]
    v_mfma_f32_16x16x32_bf16 v[200:203], a[208:211], v[136:139], v[200:203]
    s_waitcnt vmcnt(17)
    v_mfma_f32_16x16x32_bf16 v[204:207], a[192:195], v[140:143], v[204:207]
    v_mfma_f32_16x16x32_bf16 v[208:211], a[196:199], v[140:143], v[208:211]
    v_mfma_f32_16x16x32_bf16 v[212:215], a[200:203], v[140:143], v[212:215]
    v_mfma_f32_16x16x32_bf16 v[216:219], a[204:207], v[140:143], v[216:219]
    v_mfma_f32_16x16x32_bf16 v[220:223], a[208:211], v[140:143], v[220:223]
    s_waitcnt vmcnt(16)
    v_mfma_f32_16x16x32_bf16 v[144:147], a[212:215], v[64:67], v[144:147]
    v_mfma_f32_16x16x32_bf16 v[148:151], a[216:219], v[64:67], v[148:151]
    v_mfma_f32_16x16x32_bf16 v[152:155], a[220:223], v[64:67], v[152:155]
    v_mfma_f32_16x16x32_bf16 v[156:159], a[224:227], v[64:67], v[156:159]
    v_mfma_f32_16x16x32_bf16 v[160:163], a[228:231], v[64:67], v[160:163]
    s_waitcnt vmcnt(13)
    v_mfma_f32_16x16x32_bf16 v[164:167], a[212:215], v[68:71], v[164:167]
    v_mfma_f32_16x16x32_bf16 v[168:171], a[216:219], v[68:71], v[168:171]
    v_mfma_f32_16x16x32_bf16 v[172:175], a[220:223], v[68:71], v[172:175]
    v_mfma_f32_16x16x32_bf16 v[176:179], a[224:227], v[68:71], v[176:179]
    v_mfma_f32_16x16x32_bf16 v[180:183], a[228:231], v[68:71], v[180:183]
    s_waitcnt vmcnt(10)
    v_mfma_f32_16x16x32_bf16 v[184:187], a[212:215], v[72:75], v[184:187]
    v_mfma_f32_16x16x32_bf16 v[188:191], a[216:219], v[72:75], v[188:191]
    v_mfma_f32_16x16x32_bf16 v[192:195], a[220:223], v[72:75], v[192:195]
    v_mfma_f32_16x16x32_bf16 v[196:199], a[224:227], v[72:75], v[196:199]
    v_mfma_f32_16x16x32_bf16 v[200:203], a[228:231], v[72:75], v[200:203]
    s_waitcnt vmcnt(9)
    v_mfma_f32_16x16x32_bf16 v[204:207], a[212:215], v[76:79], v[204:207]
    v_mfma_f32_16x16x32_bf16 v[208:211], a[216:219], v[76:79], v[208:211]
    v_mfma_f32_16x16x32_bf16 v[212:215], a[220:223], v[76:79], v[212:215]
    v_mfma_f32_16x16x32_bf16 v[216:219], a[224:227], v[76:79], v[216:219]
    v_mfma_f32_16x16x32_bf16 v[220:223], a[228:231], v[76:79], v[220:223]
    s_waitcnt vmcnt(8)
    s_waitcnt vmcnt(0)
    v_cmp_ne_u32 vcc, s3, v250
    s_cbranch_vccnz L_spin_67
L_back_68:
    s_sub_u32 s90, s90, 4096
    buffer_load_dwordx4 v[112:115], v224, s[4:7], s90 offen offset:0 sc1
    s_sub_u32 s91, s91, 4096
    buffer_load_dwordx4 v[116:119], v224, s[4:7], s91 offen offset:0 sc1
    s_sub_u32 s92, s92, 4096
    buffer_load_dwordx4 v[120:123], v224, s[4:7], s92 offen offset:0 sc1
    s_sub_u32 s93, s93, 4096
    buffer_load_dwordx4 v[124:127], v224, s[4:7], s93 offen offset:0 sc1
    buffer_load_dwordx4 v[128:131], v224, s[4:7], s90 offen offset:1024 sc1
    buffer_load_dwordx4 v[132:135], v224, s[4:7], s91 offen offset:1024 sc1
    buffer_load_dwordx4 v[136:139], v224, s[4:7], s92 offen offset:1024 sc1
    buffer_load_dwordx4 v[140:143], v224, s[4:7], s93 offen offset:1024 sc1
    s_waitcnt lgkmcnt(3)
    v_mfma_f32_16x16x32_bf16 v[144:147], v[0:3], v[80:83], v[144:147]
    buffer_load_dwordx4 v[64:67], v224, s[4:7], s90 offen offset:2048 sc1
    v_mfma_f32_16x16x32_bf16 v[148:151], v[4:7], v[80:83], v[148:151]
    v_mfma_f32_16x16x32_bf16 v[152:155], v[8:11], v[80:83], v[152:155]
    v_mfma_f32_16x16x32_bf16 v[156:159], v[12:15], v[80:83], v[156:159]
    v_mfma_f32_16x16x32_bf16 v[160:163], v[16:19], v[80:83], v[160:163]
    v_mfma_f32_16x16x32_bf16 v[164:167], v[0:3], v[84:87], v[164:167]
    buffer_load_dwordx4 v[68:71], v224, s[4:7], s91 offen offset:2048 sc1
    v_mfma_f32_16x16x32_bf16 v[168:171], v[4:7], v[84:87], v[168:171]
    v_mfma_f32_16x16x32_bf16 v[172:175], v[8:11], v[84:87], v[172:175]
    v_mfma_f32_16x16x32_bf16 v[176:179], v[12:15], v[84:87], v[176:179]
    v_mfma_f32_16x16x32_bf16 v[180:183], v[16:19], v[84:87], v[180:183]
    v_mfma_f32_16x16x32_bf16 v[184:187], v[0:3], v[88:91], v[184:187]
    buffer_load_dwordx4 v[72:75], v224, s[4:7], s92 offen offset:2048 sc1
    v_mfma_f32_16x16x32_bf16 v[188:191], v[4:7], v[88:91], v[188:191]
    v_mfma_f32_16x16x32_bf16 v[192:195], v[8:11], v[88:91], v[192:195]
    v_mfma_f32_16x16x32_bf16 v[196:199], v[12:15], v[88:91], v[196:199]
    v_mfma_f32_16x16x32_bf16 v[200:203], v[16:19], v[88:91], v[200:203]
    v_mfma_f32_16x16x32_bf16 v[204:207], v[0:3], v[92:95], v[204:207]
    buffer_load_dwordx4 v[76:79], v224, s[4:7], s93 offen offset:2048 sc1
    v_mfma_f32_16x16x32_bf16 v[208:211], v[4:7], v[92:95], v[208:211]
    v_mfma_f32_16x16x32_bf16 v[212:215], v[8:11], v[92:95], v[212:215]
    v_mfma_f32_16x16x32_bf16 v[216:219], v[12:15], v[92:95], v[216:219]
    v_mfma_f32_16x16x32_bf16 v[220:223], v[16:19], v[92:95], v[220:223]
    s_waitcnt lgkmcnt(0)
    v_mfma_f32_16x16x32_bf16 v[144:147], v[20:23], v[96:99], v[144:147]
    buffer_load_dwordx4 v[80:83], v224, s[4:7], s90 offen offset:3072 sc1
    v_mfma_f32_16x16x32_bf16 v[148:151], v[24:27], v[96:99], v[148:151]
    v_mfma_f32_16x16x32_bf16 v[152:155], v[28:31], v[96:99], v[152:155]
    v_mfma_f32_16x16x32_bf16 v[156:159], v[32:35], v[96:99], v[156:159]
    v_mfma_f32_16x16x32_bf16 v[160:163], v[36:39], v[96:99], v[160:163]
    v_mfma_f32_16x16x32_bf16 v[164:167], v[20:23], v[100:103], v[164:167]
    buffer_load_dwordx4 v[84:87], v224, s[4:7], s91 offen offset:3072 sc1
    v_mfma_f32_16x16x32_bf16 v[168:171], v[24:27], v[100:103], v[168:171]
    v_mfma_f32_16x16x32_bf16 v[172:175], v[28:31], v[100:103], v[172:175]
    v_mfma_f32_16x16x32_bf16 v[176:179], v[32:35], v[100:103], v[176:179]
    v_mfma_f32_16x16x32_bf16 v[180:183], v[36:39], v[100:103], v[180:183]
    v_mfma_f32_16x16x32_bf16 v[184:187], v[20:23], v[104:107], v[184:187]
    buffer_load_dwordx4 v[88:91], v224, s[4:7], s92 offen offset:3072 sc1
    v_mfma_f32_16x16x32_bf16 v[188:191], v[24:27], v[104:107], v[188:191]
    v_mfma_f32_16x16x32_bf16 v[192:195], v[28:31], v[104:107], v[192:195]
    v_mfma_f32_16x16x32_bf16 v[196:199], v[32:35], v[104:107], v[196:199]
    v_mfma_f32_16x16x32_bf16 v[200:203], v[36:39], v[104:107], v[200:203]
    v_mfma_f32_16x16x32_bf16 v[204:207], v[20:23], v[108:111], v[204:207]
    buffer_load_dwordx4 v[92:95], v224, s[4:7], s93 offen offset:3072 sc1
    v_mfma_f32_16x16x32_bf16 v[208:211], v[24:27], v[108:111], v[208:211]
    v_mfma_f32_16x16x32_bf16 v[212:215], v[28:31], v[108:111], v[212:215]
    v_mfma_f32_16x16x32_bf16 v[216:219], v[32:35], v[108:111], v[216:219]
    v_mfma_f32_16x16x32_bf16 v[220:223], v[36:39], v[108:111], v[220:223]
    s_waitcnt vmcnt(15)
    s_barrier
    v_mfma_f32_16x16x32_bf16 v[144:147], a[0:3], v[112:115], v[144:147]
    s_add_u32 s91, s91, 4096
    buffer_load_dwordx4 v[100:103], v224, s[4:7], s91 offen offset:0 sc1
    v_mfma_f32_16x16x32_bf16 v[148:151], a[4:7], v[112:115], v[148:151]
    v_mfma_f32_16x16x32_bf16 v[152:155], a[8:11], v[112:115], v[152:155]
    v_mfma_f32_16x16x32_bf16 v[156:159], a[12:15], v[112:115], v[156:159]
    v_mfma_f32_16x16x32_bf16 v[160:163], a[16:19], v[112:115], v[160:163]
    s_waitcnt vmcnt(15)
    v_mfma_f32_16x16x32_bf16 v[164:167], a[0:3], v[116:119], v[164:167]
    v_mfma_f32_16x16x32_bf16 v[168:171], a[4:7], v[116:119], v[168:171]
    v_mfma_f32_16x16x32_bf16 v[172:175], a[8:11], v[116:119], v[172:175]
    v_mfma_f32_16x16x32_bf16 v[176:179], a[12:15], v[116:119], v[176:179]
    v_mfma_f32_16x16x32_bf16 v[180:183], a[16:19], v[116:119], v[180:183]
    s_waitcnt vmcnt(14)
    v_mfma_f32_16x16x32_bf16 v[184:187], a[0:3], v[120:123], v[184:187]
    buffer_load_dwordx4 v[116:119], v224, s[4:7], s91 offen offset:1024 sc1
    v_mfma_f32_16x16x32_bf16 v[188:191], a[4:7], v[120:123], v[188:191]
    v_mfma_f32_16x16x32_bf16 v[192:195], a[8:11], v[120:123], v[192:195]
    s_add_u32 s92, s92, 4096
    buffer_load_dwordx4 v[104:107], v224, s[4:7], s92 offen offset:0 sc1
    v_mfma_f32_16x16x32_bf16 v[196:199], a[12:15], v[120:123], v[196:199]
    v_mfma_f32_16x16x32_bf16 v[200:203], a[16:19], v[120:123], v[200:203]
    s_waitcnt vmcnt(15)
    v_mfma_f32_16x16x32_bf16 v[204:207], a[0:3], v[124:127], v[204:207]
    buffer_load_dwordx4 v[120:123], v224, s[4:7], s92 offen offset:1024 sc1
    v_mfma_f32_16x16x32_bf16 v[208:211], a[4:7], v[124:127], v[208:211]
    v_mfma_f32_16x16x32_bf16 v[212:215], a[8:11], v[124:127], v[212:215]
    v_mfma_f32_16x16x32_bf16 v[216:219], a[12:15], v[124:127], v[216:219]
    v_mfma_f32_16x16x32_bf16 v[220:223], a[16:19], v[124:127], v[220:223]
    s_waitcnt vmcnt(15)
    v_mfma_f32_16x16x32_bf16 v[144:147], a[20:23], v[128:131], v[144:147]
    s_add_u32 s93, s93, 4096
    buffer_load_dwordx4 v[108:111], v224, s[4:7], s93 offen offset:0 sc1
    v_mfma_f32_16x16x32_bf16 v[148:151], a[24:27], v[128:131], v[148:151]
    v_mfma_f32_16x16x32_bf16 v[152:155], a[28:31], v[128:131], v[152:155]
    v_mfma_f32_16x16x32_bf16 v[156:159], a[32:35], v[128:131], v[156:159]
    v_mfma_f32_16x16x32_bf16 v[160:163], a[36:39], v[128:131], v[160:163]
    s_waitcnt vmcnt(15)
    v_mfma_f32_16x16x32_bf16 v[164:167], a[20:23], v[132:135], v[164:167]
    buffer_load_dwordx4 v[124:127], v224, s[4:7], s93 offen offset:1024 sc1
    v_mfma_f32_16x16x32_bf16 v[168:171], a[24:27], v[132:135], v[168:171]
    v_mfma_f32_16x16x32_bf16 v[172:175], a[28:31], v[132:135], v[172:175]
    v_mfma_f32_16x16x32_bf16 v[176:179], a[32:35], v[132:135], v[176:179]
    v_mfma_f32_16x16x32_bf16 v[180:183], a[36:39], v[132:135], v[180:183]
    s_waitcnt vmcnt(15)
    v_mfma_f32_16x16x32_bf16 v[184:187], a[20:23], v[136:139], v[184:187]
    s_add_u32 s90, s90, 4096
    buffer_load_dwordx4 v[96:99], v224, s[4:7], s90 offen offset:0 sc1
    v_mfma_f32_16x16x32_bf16 v[188:191], a[24:27], v[136:139], v[188:191]
    v_mfma_f32_16x16x32_bf16 v[192:195], a[28:31], v[136:139], v[192:195]
    v_mfma_f32_16x16x32_bf16 v[196:199], a[32:35], v[136:139], v[196:199]
    v_mfma_f32_16x16x32_bf16 v[200:203], a[36:39], v[136:139], v[200:203]
    s_waitcnt vmcnt(15)
    v_mfma_f32_16x16x32_bf16 v[204:207], a[20:23], v[140:143], v[204:207]
    buffer_load_dwordx4 v[112:115], v224, s[4:7], s90 offen offset:1024 sc1
    v_mfma_f32_16x16x32_bf16 v[208:211], a[24:27], v[140:143], v[208:211]
    v_mfma_f32_16x16x32_bf16 v[212:215], a[28:31], v[140:143], v[212:215]
    v_mfma_f32_16x16x32_bf16 v[216:219], a[32:35], v[140:143], v[216:219]
    v_mfma_f32_16x16x32_bf16 v[220:223], a[36:39], v[140:143], v[220:223]
    s_waitcnt vmcnt(15)
    v_mfma_f32_16x16x32_bf16 v[144:147], a[40:43], v[64:67], v[144:147]
    s_add_u32 s95, s94, 14155776
    buffer_load_dwordx2 v[232:233], v243, s[4:7], s95 offen offset:0 sc1
    v_mfma_f32_16x16x32_bf16 v[148:151], a[44:47], v[64:67], v[148:151]
    v_mfma_f32_16x16x32_bf16 v[152:155], a[48:51], v[64:67], v[152:155]
    v_mfma_f32_16x16x32_bf16 v[156:159], a[52:55], v[64:67], v[156:159]
    buffer_load_dwordx2 v[234:235], v243, s[4:7], s95 offen offset:1024 sc1
    v_mfma_f32_16x16x32_bf16 v[160:163], a[56:59], v[64:67], v[160:163]
    s_waitcnt vmcnt(16)
    v_mfma_f32_16x16x32_bf16 v[164:167], a[40:43], v[68:71], v[164:167]
    buffer_load_dwordx2 v[236:237], v243, s[4:7], s95 offen offset:2048 sc1
    v_mfma_f32_16x16x32_bf16 v[168:171], a[44:47], v[68:71], v[168:171]
    v_mfma_f32_16x16x32_bf16 v[172:175], a[48:51], v[68:71], v[172:175]
    v_mfma_f32_16x16x32_bf16 v[176:179], a[52:55], v[68:71], v[176:179]
    buffer_load_dwordx2 v[238:239], v243, s[4:7], s95 offen offset:3072 sc1
    v_mfma_f32_16x16x32_bf16 v[180:183], a[56:59], v[68:71], v[180:183]
    s_waitcnt vmcnt(17)
    v_mfma_f32_16x16x32_bf16 v[184:187], a[40:43], v[72:75], v[184:187]
    s_add_u32 s95, s95, 4096
    buffer_load_dwordx2 v[240:241], v243, s[4:7], s95 offen offset:0 sc1
    v_mfma_f32_16x16x32_bf16 v[188:191], a[44:47], v[72:75], v[188:191]
    v_mfma_f32_16x16x32_bf16 v[192:195], a[48:51], v[72:75], v[192:195]
    v_mfma_f32_16x16x32_bf16 v[196:199], a[52:55], v[72:75], v[196:199]
    v_mfma_f32_16x16x32_bf16 v[200:203], a[56:59], v[72:75], v[200:203]
    s_waitcnt vmcnt(17)
    v_mfma_f32_16x16x32_bf16 v[204:207], a[40:43], v[76:79], v[204:207]
    v_mfma_f32_16x16x32_bf16 v[208:211], a[44:47], v[76:79], v[208:211]
    v_mfma_f32_16x16x32_bf16 v[212:215], a[48:51], v[76:79], v[212:215]
    v_mfma_f32_16x16x32_bf16 v[216:219], a[52:55], v[76:79], v[216:219]
    v_mfma_f32_16x16x32_bf16 v[220:223], a[56:59], v[76:79], v[220:223]
    s_waitcnt vmcnt(16)
    v_mfma_f32_16x16x32_bf16 v[144:147], a[60:63], v[80:83], v[144:147]
    s_add_u32 s96, s59, 1
    s_and_b32 s96, s96, 3
    v_mfma_f32_16x16x32_bf16 v[148:151], a[64:67], v[80:83], v[148:151]
    s_mul_i32 s96, s96, 3
    s_add_u32 s96, s96, 0
    v_mfma_f32_16x16x32_bf16 v[152:155], a[68:71], v[80:83], v[152:155]
    s_lshl_b32 s97, s96, 10
    s_add_u32 s98, s97, 118784
    v_mfma_f32_16x16x32_bf16 v[156:159], a[72:75], v[80:83], v[156:159]
    v_add_u32 v128, s98, v224
    s_add_u32 s98, s97, 36864
    v_mfma_f32_16x16x32_bf16 v[160:163], a[76:79], v[80:83], v[160:163]
    s_add_u32 s99, s97, 147456
    s_cmp_lt_u32 s96, 8
    s_waitcnt vmcnt(15)
    v_mfma_f32_16x16x32_bf16 v[164:167], a[60:63], v[84:87], v[164:167]
    s_cselect_b32 s98, s98, s99
    v_add_u32 v129, s98, v224
    v_mfma_f32_16x16x32_bf16 v[168:171], a[64:67], v[84:87], v[168:171]
    s_add_u32 s98, s97, 77824
    s_add_u32 s99, s97, 4294959104
    v_mfma_f32_16x16x32_bf16 v[172:175], a[68:71], v[84:87], v[172:175]
    s_cmp_lt_u32 s96, 8
    s_cselect_b32 s98, s98, s99
    v_mfma_f32_16x16x32_bf16 v[176:179], a[72:75], v[84:87], v[176:179]
    v_add_u32 v130, s98, v224
    s_add_u32 s96, s59, 2
    v_mfma_f32_16x16x32_bf16 v[180:183], a[76:79], v[84:87], v[180:183]
    s_and_b32 s96, s96, 3
    s_mul_i32 s96, s96, 3
    s_waitcnt vmcnt(14)
    v_mfma_f32_16x16x32_bf16 v[184:187], a[60:63], v[88:91], v[184:187]
    s_add_u32 s96, s96, 1
    s_lshl_b32 s97, s96, 10
    v_mfma_f32_16x16x32_bf16 v[188:191], a[64:67], v[88:91], v[188:191]
    s_add_u32 s98, s97, 118784
    v_add_u32 v131, s98, v224
    v_mfma_f32_16x16x32_bf16 v[192:195], a[68:71], v[88:91], v[192:195]
    s_add_u32 s98, s97, 36864
    s_add_u32 s99, s97, 147456
    v_mfma_f32_16x16x32_bf16 v[196:199], a[72:75], v[88:91], v[196:199]
    s_cmp_lt_u32 s96, 8
    s_cselect_b32 s98, s98, s99
    v_mfma_f32_16x16x32_bf16 v[200:203], a[76:79], v[88:91], v[200:203]
    v_add_u32 v132, s98, v224
    s_add_u32 s98, s97, 77824
    s_waitcnt vmcnt(13)
    v_mfma_f32_16x16x32_bf16 v[204:207], a[60:63], v[92:95], v[204:207]
    s_add_u32 s99, s97, 4294959104
    s_cmp_lt_u32 s96, 8
    v_mfma_f32_16x16x32_bf16 v[208:211], a[64:67], v[92:95], v[208:211]
    s_cselect_b32 s98, s98, s99
    v_add_u32 v133, s98, v224
    v_mfma_f32_16x16x32_bf16 v[212:215], a[68:71], v[92:95], v[212:215]
    s_add_u32 s96, s59, 3
    s_and_b32 s96, s96, 3
    v_mfma_f32_16x16x32_bf16 v[216:219], a[72:75], v[92:95], v[216:219]
    s_mul_i32 s96, s96, 3
    s_add_u32 s96, s96, 2
    v_mfma_f32_16x16x32_bf16 v[220:223], a[76:79], v[92:95], v[220:223]
    s_lshl_b32 s97, s96, 10
    s_add_u32 s98, s97, 118784
    s_waitcnt vmcnt(12)
    v_mfma_f32_16x16x32_bf16 v[164:167], a[80:83], v[100:103], v[164:167]
    v_add_u32 v134, s98, v224
    s_add_u32 s98, s97, 36864
    v_mfma_f32_16x16x32_bf16 v[168:171], a[84:87], v[100:103], v[168:171]
    s_add_u32 s99, s97, 147456
    s_cmp_lt_u32 s96, 8
    v_mfma_f32_16x16x32_bf16 v[172:175], a[88:91], v[100:103], v[172:175]
    s_cselect_b32 s98, s98, s99
    v_add_u32 v135, s98, v224
    v_mfma_f32_16x16x32_bf16 v[176:179], a[92:95], v[100:103], v[176:179]
    s_add_u32 s98, s97, 77824
    s_add_u32 s99, s97, 4294959104
    v_mfma_f32_16x16x32_bf16 v[180:183], a[96:99], v[100:103], v[180:183]
    s_cmp_lt_u32 s96, 8
    s_cselect_b32 s98, s98, s99
    s_waitcnt vmcnt(11)
    v_mfma_f32_16x16x32_bf16 v[164:167], a[100:103], v[116:119], v[164:167]
    v_add_u32 v136, s98, v224
    s_mul_i32 s96, s59, 3
    v_mfma_f32_16x16x32_bf16 v[168:171], a[104:107], v[116:119], v[168:171]
    s_add_u32 s96, s96, 0
    s_lshl_b32 s97, s96, 10
    v_mfma_f32_16x16x32_bf16 v[172:175], a[108:111], v[116:119], v[172:175]
    s_add_u32 s98, s97, 118784
    v_add_u32 v137, s98, v224
    v_mfma_f32_16x16x32_bf16 v[176:179], v[40:43], v[116:119], v[176:179]
    s_add_u32 s98, s97, 36864
    s_add_u32 s99, s97, 147456
    v_mfma_f32_16x16x32_bf16 v[180:183], v[44:47], v[116:119], v[180:183]
    s_cmp_lt_u32 s96, 8
    s_cselect_b32 s98, s98, s99
    s_waitcnt vmcnt(10)
    v_mfma_f32_16x16x32_bf16 v[184:187], a[80:83], v[104:107], v[184:187]
    ds_write_b128 v128, v[164:167] offset:0
    v_add_u32 v138, s98, v224
    s_add_u32 s98, s97, 77824
    v_mfma_f32_16x16x32_bf16 v[188:191], a[84:87], v[104:107], v[188:191]
    s_add_u32 s99, s97, 4294959104
    s_cmp_lt_u32 s96, 8
    v_mfma_f32_16x16x32_bf16 v[192:195], a[88:91], v[104:107], v[192:195]
    ds_write_b128 v128, v[168:171] offset:12288
    s_cselect_b32 s98, s98, s99
    v_add_u32 v141, s98, v224
    v_mfma_f32_16x16x32_bf16 v[196:199], a[92:95], v[104:107], v[196:199]
    s_mul_i32 s96, s59, 3
    s_add_u32 s96, s96, 1
    v_mfma_f32_16x16x32_bf16 v[200:203], a[96:99], v[104:107], v[200:203]
    ds_write_b128 v128, v[172:175] offset:24576
    s_lshl_b32 s97, s96, 10
    s_add_u32 s98, s97, 36864
    s_waitcnt vmcnt(9)
    v_mfma_f32_16x16x32_bf16 v[184:187], a[100:103], v[120:123], v[184:187]
    s_add_u32 s99, s97, 147456
    s_cmp_lt_u32 s96, 8
    v_mfma_f32_16x16x32_bf16 v[188:191], a[104:107], v[120:123], v[188:191]
    ds_write_b128 v129, v[176:179]
    s_cselect_b32 s98, s98, s99
    v_add_u32 v139, s98, v224
    v_mfma_f32_16x16x32_bf16 v[192:195], a[108:111], v[120:123], v[192:195]
    s_add_u32 s98, s97, 77824
    s_add_u32 s99, s97, 4294959104
    v_mfma_f32_16x16x32_bf16 v[196:199], v[40:43], v[120:123], v[196:199]
    ds_write_b128 v130, v[180:183]
    s_cmp_lt_u32 s96, 8
    s_cselect_b32 s98, s98, s99
    v_mfma_f32_16x16x32_bf16 v[200:203], v[44:47], v[120:123], v[200:203]
    v_add_u32 v142, s98, v224
    s_mul_i32 s96, s59, 3
    s_waitcnt vmcnt(8)
    v_mfma_f32_16x16x32_bf16 v[204:207], a[80:83], v[108:111], v[204:207]
    ds_write_b128 v131, v[184:187] offset:0
    s_add_u32 s96, s96, 2
    s_lshl_b32 s97, s96, 10
    v_mfma_f32_16x16x32_bf16 v[208:211], a[84:87], v[108:111], v[208:211]
    s_add_u32 s98, s97, 36864
    s_add_u32 s99, s97, 147456
    v_mfma_f32_16x16x32_bf16 v[212:215], a[88:91], v[108:111], v[212:215]
    ds_write_b128 v131, v[188:191] offset:12288
    s_cmp_lt_u32 s96, 8
    s_cselect_b32 s98, s98, s99
    v_mfma_f32_16x16x32_bf16 v[216:219], a[92:95], v[108:111], v[216:219]
    v_add_u32 v140, s98, v224
    s_add_u32 s98, s97, 77824
    v_mfma_f32_16x16x32_bf16 v[220:223], a[96:99], v[108:111], v[220:223]
    ds_write_b128 v131, v[192:195] offset:24576
    s_add_u32 s99, s97, 4294959104
    s_cmp_lt_u32 s96, 8
    s_waitcnt vmcnt(7)
    v_mfma_f32_16x16x32_bf16 v[204:207], a[100:103], v[124:127], v[204:207]
    s_cselect_b32 s98, s98, s99
    v_add_u32 v143, s98, v224
    v_mfma_f32_16x16x32_bf16 v[208:211], a[104:107], v[124:127], v[208:211]
    ds_write_b128 v132, v[196:199]
    v_mfma_f32_16x16x32_bf16 v[212:215], a[108:111], v[124:127], v[212:215]
    v_mfma_f32_16x16x32_bf16 v[216:219], v[40:43], v[124:127], v[216:219]
    ds_write_b128 v133, v[200:203]
    v_mfma_f32_16x16x32_bf16 v[220:223], v[44:47], v[124:127], v[220:223]
    s_waitcnt vmcnt(6)
    v_mfma_f32_16x16x32_bf16 v[144:147], a[80:83], v[96:99], v[144:147]
    ds_write_b128 v134, v[204:207] offset:0
    v_mfma_f32_16x16x32_bf16 v[148:151], a[84:87], v[96:99], v[148:151]
    v_mfma_f32_16x16x32_bf16 v[152:155], a[88:91], v[96:99], v[152:155]
    ds_write_b128 v134, v[208:211] offset:12288
    v_mfma_f32_16x16x32_bf16 v[156:159], a[92:95], v[96:99], v[156:159]
    v_mfma_f32_16x16x32_bf16 v[160:163], a[96:99], v[96:99], v[160:163]
    ds_write_b128 v134, v[212:215] offset:24576
    s_waitcnt vmcnt(5)
    v_mfma_f32_16x16x32_bf16 v[144:147], a[100:103], v[112:115], v[144:147]
    v_mfma_f32_16x16x32_bf16 v[148:151], a[104:107], v[112:115], v[148:151]
    ds_write_b128 v135, v[216:219]
    v_mfma_f32_16x16x32_bf16 v[152:155], a[108:111], v[112:115], v[152:155]
    v_mfma_f32_16x16x32_bf16 v[156:159], v[40:43], v[112:115], v[156:159]
    ds_write_b128 v136, v[220:223]
    v_mfma_f32_16x16x32_bf16 v[160:163], v[44:47], v[112:115], v[160:163]
    s_waitcnt lgkmcnt(0)
    s_barrier
    ds_read_b128 v[64:67], v137 offset:0
    ds_read_b128 v[68:71], v137 offset:1024
    ds_read_b128 v[72:75], v137 offset:2048
    ds_read_b128 v[76:79], v137 offset:12288
    ds_read_b128 v[80:83], v137 offset:13312
    ds_read_b128 v[84:87], v137 offset:14336
    ds_read_b128 v[88:91], v137 offset:24576
    ds_read_b128 v[92:95], v137 offset:25600
    ds_read_b128 v[96:99], v137 offset:26624
    ds_read_b128 v[100:103], v138
    ds_read_b128 v[104:107], v139
    ds_read_b128 v[108:111], v140
    ds_read_b128 v[112:115], v141
    ds_read_b128 v[116:119], v142
    ds_read_b128 v[120:123], v143
    s_waitcnt vmcnt(0)
    s_mov_b32 s78, 0xffff0000
    s_waitcnt lgkmcnt(12)
    v_pk_add_f32 v[64:65], v[64:65], v[68:69]
    v_pk_add_f32 v[66:67], v[66:67], v[70:71]
    v_pk_add_f32 v[144:145], v[144:145], v[72:73]
    v_pk_add_f32 v[146:147], v[146:147], v[74:75]
    v_pk_add_f32 v[144:145], v[144:145], v[64:65]
    v_pk_add_f32 v[146:147], v[146:147], v[66:67]
    s_nop 1
    v_permlane32_swap_b32 v144, v146
    v_permlane32_swap_b32 v145, v147
    s_nop 1
    v_permlane16_swap_b32 v144, v145
    v_permlane16_swap_b32 v146, v147
    v_lshlrev_b32 v64, 16, v232
    v_and_b32 v65, s78, v232
    v_lshlrev_b32 v66, 16, v233
    v_and_b32 v67, s78, v233
    v_pk_add_f32 v[144:145], v[144:145], v[64:65]
    v_pk_add_f32 v[146:147], v[146:147], v[66:67]
    v_cvt_pk_bf16_f32 v204, v144, v145
    v_cvt_pk_bf16_f32 v205, v146, v147
    s_waitcnt lgkmcnt(9)
    v_pk_add_f32 v[76:77], v[76:77], v[80:81]
    v_pk_add_f32 v[78:79], v[78:79], v[82:83]
    v_pk_add_f32 v[148:149], v[148:149], v[84:85]
    v_pk_add_f32 v[150:151], v[150:151], v[86:87]
    v_pk_add_f32 v[148:149], v[148:149], v[76:77]
    v_pk_add_f32 v[150:151], v[150:151], v[78:79]
    s_nop 1
    v_permlane32_swap_b32 v148, v150
    v_permlane32_swap_b32 v149, v151
    s_nop 1
    v_permlane16_swap_b32 v148, v149
    v_permlane16_swap_b32 v150, v151
    v_lshlrev_b32 v76, 16, v234
    v_and_b32 v77, s78, v234
    v_lshlrev_b32 v78, 16, v235
    v_and_b32 v79, s78, v235
    v_pk_add_f32 v[148:149], v[148:149], v[76:77]
    v_pk_add_f32 v[150:151], v[150:151], v[78:79]
    v_cvt_pk_bf16_f32 v206, v148, v149
    v_cvt_pk_bf16_f32 v207, v150, v151
    s_waitcnt lgkmcnt(6)
    v_pk_add_f32 v[88:89], v[88:89], v[92:93]
    v_pk_add_f32 v[90:91], v[90:91], v[94:95]
    v_pk_add_f32 v[152:153], v[152:153], v[96:97]
    v_pk_add_f32 v[154:155], v[154:155], v[98:99]
    v_pk_add_f32 v[152:153], v[152:153], v[88:89]
    v_pk_add_f32 v[154:155], v[154:155], v[90:91]
    s_nop 1
    v_permlane32_swap_b32 v152, v154
    v_permlane32_swap_b32 v153, v155
    s_nop 1
    v_permlane16_swap_b32 v152, v153
    v_permlane16_swap_b32 v154, v155
    v_lshlrev_b32 v88, 16, v236
    v_and_b32 v89, s78, v236
    v_lshlrev_b32 v90, 16, v237
    v_and_b32 v91, s78, v237
    v_pk_add_f32 v[152:153], v[152:153], v[88:89]
    v_pk_add_f32 v[154:155], v[154:155], v[90:91]
    v_cvt_pk_bf16_f32 v208, v152, v153
    v_cvt_pk_bf16_f32 v209, v154, v155
    s_waitcnt lgkmcnt(3)
    v_pk_add_f32 v[100:101], v[100:101], v[104:105]
    v_pk_add_f32 v[102:103], v[102:103], v[106:107]
    v_pk_add_f32 v[156:157], v[156:157], v[108:109]
    v_pk_add_f32 v[158:159], v[158:159], v[110:111]
    v_pk_add_f32 v[156:157], v[156:157], v[100:101]
    v_pk_add_f32 v[158:159], v[158:159], v[102:103]
    s_nop 1
    v_permlane32_swap_b32 v156, v158
    v_permlane32_swap_b32 v157, v159
    s_nop 1
    v_permlane16_swap_b32 v156, v157
    v_permlane16_swap_b32 v158, v159
    v_lshlrev_b32 v100, 16, v238
    v_and_b32 v101, s78, v238
    v_lshlrev_b32 v102, 16, v239
    v_and_b32 v103, s78, v239
    v_pk_add_f32 v[156:157], v[156:157], v[100:101]
    v_pk_add_f32 v[158:159], v[158:159], v[102:103]
    v_cvt_pk_bf16_f32 v210, v156, v157
    v_cvt_pk_bf16_f32 v211, v158, v159
    s_waitcnt lgkmcnt(0)
    v_pk_add_f32 v[112:113], v[112:113], v[116:117]
    v_pk_add_f32 v[114:115], v[114:115], v[118:119]
    v_pk_add_f32 v[160:161], v[160:161], v[120:121]
    v_pk_add_f32 v[162:163], v[162:163], v[122:123]
    v_pk_add_f32 v[160:161], v[160:161], v[112:113]
    v_pk_add_f32 v[162:163], v[162:163], v[114:115]
    s_nop 1
    v_permlane32_swap_b32 v160, v162
    v_permlane32_swap_b32 v161, v163
    s_nop 1
    v_permlane16_swap_b32 v160, v161
    v_permlane16_swap_b32 v162, v163
    v_lshlrev_b32 v112, 16, v240
    v_and_b32 v113, s78, v240
    v_lshlrev_b32 v114, 16, v241
    v_and_b32 v115, s78, v241
    v_pk_add_f32 v[160:161], v[160:161], v[112:113]
    v_pk_add_f32 v[162:163], v[162:163], v[114:115]
    v_cvt_pk_bf16_f32 v212, v160, v161
    v_cvt_pk_bf16_f32 v213, v162, v163
    v_bfe_u32 v244, v224, 4, 4
    v_mul_u32_u24 v244, 1280, v244
    v_bfe_u32 v245, v224, 8, 1
    v_lshl_add_u32 v244, v245, 5, v244
    v_bfe_u32 v245, v224, 9, 1
    v_lshl_add_u32 v244, v245, 4, v244
    s_lshl_b32 s74, s68, 2
    s_add_u32 s74, s74, s59
    s_mul_i32 s74, s74, 20480
    s_mul_i32 s75, s69, 160
    s_add_u32 s74, s74, s75
    v_permlane16_swap_b32 v204, v206
    v_permlane16_swap_b32 v205, v207
    v_permlane16_swap_b32 v208, v210
    v_permlane16_swap_b32 v209, v211
    v_permlane16_swap_b32 v212, v214
    v_permlane16_swap_b32 v213, v215
    buffer_store_dwordx4 v[204:207], v244, s[8:11], s74 offen offset:0
    buffer_store_dwordx4 v[208:211], v244, s[8:11], s74 offen offset:64
    s_mov_b32 exec_lo, 0x0000ffff
    s_mov_b32 exec_hi, 0x0000ffff
    buffer_store_dwordx4 v[212:215], v244, s[8:11], s74 offen offset:128
    s_mov_b64 exec, -1
    s_waitcnt vmcnt(0)
    s_endpgm
L_spin_5:
    s_mov_b32 s57, 20000
L_lp_69:
    buffer_load_dword v5, v4, s[4:7], s42 offen sc1
    s_waitcnt vmcnt(0)
    v_cmp_ne_u32 vcc, s3, v5
    s_cbranch_vccz L_back_6
    s_sub_u32 s57, s57, 1
    s_cbranch_scc0 L_lp_69
    s_branch L_back_6
L_spin_11:
    s_mov_b32 s57, 20000
L_lp_70:
    buffer_load_dwordx4 v[20:23], v6, s[4:7], s45 offen sc1
    s_waitcnt vmcnt(0)
    v_xor_b32 v20, s3, v20
    v_xor_b32 v21, s3, v21
    v_xor_b32 v22, s3, v22
    v_xor_b32 v23, s3, v23
    v_or3_b32 v20, v20, v21, v22
    v_or_b32 v20, v20, v23
    v_cmp_ne_u32 vcc, 0, v20
    s_cbranch_vccz L_back_12
    s_sub_u32 s57, s57, 1
    s_cbranch_scc0 L_lp_70
    s_branch L_back_12
L_spin_14:
    s_mov_b32 s57, 20000
L_lp_71:
    buffer_load_dwordx4 v[8:11], v7, s[4:7], s52 offen sc1
    s_waitcnt vmcnt(0)
    v_xor_b32 v8, s3, v8
    v_xor_b32 v9, s3, v9
    v_xor_b32 v10, s3, v10
    v_xor_b32 v11, s3, v11
    v_or3_b32 v8, v8, v9, v10
    v_or_b32 v8, v8, v11
    v_cmp_ne_u32 vcc, 0, v8
    s_cbranch_vccz L_back_15
    s_sub_u32 s57, s57, 1
    s_cbranch_scc0 L_lp_71
    s_branch L_back_15
L_spin_24:
    s_mov_b32 s57, 20000
L_lp_72:
    buffer_load_dwordx4 v[84:87], v88, s[4:7], s45 offen sc1
    s_waitcnt vmcnt(0)
    v_xor_b32 v84, s3, v84
    v_xor_b32 v85, s3, v85
    v_xor_b32 v86, s3, v86
    v_xor_b32 v87, s3, v87
    v_or3_b32 v84, v84, v85, v86
    v_or_b32 v84, v84, v87
    v_cmp_ne_u32 vcc, 0, v84
    s_cbranch_vccz L_back_25
    s_sub_u32 s57, s57, 1
    s_cbranch_scc0 L_lp_72
    s_branch L_back_25
L_spin_26:
    s_mov_b32 s57, 20000
L_lp_73:
    buffer_load_dwordx2 v[84:85], v88, s[4:7], s90 offen sc1
    s_waitcnt vmcnt(0)
    v_cmp_ne_u32 vcc, s3, v84
    s_cbranch_vccz L_back_27
    s_sub_u32 s57, s57, 1
    s_cbranch_scc0 L_lp_73
    s_branch L_back_27
L_spin_29:
    s_mov_b32 s57, 20000
L_lp_74:
    buffer_load_dwordx4 v[84:87], v88, s[4:7], s74 offen sc1
    s_waitcnt vmcnt(0)
    v_xor_b32 v84, s3, v84
    v_xor_b32 v85, s3, v85
    v_xor_b32 v86, s3, v86
    v_xor_b32 v87, s3, v87
    v_or3_b32 v84, v84, v85, v86
    v_or_b32 v84, v84, v87
    v_cmp_ne_u32 vcc, 0, v84
    s_cbranch_vccz L_back_30
    s_sub_u32 s57, s57, 1
    s_cbranch_scc0 L_lp_74
    s_branch L_back_30
L_spin_36:
    s_mov_b32 s57, 20000
L_lp_75:
    buffer_load_dwordx4 v[240:243], v249, s[4:7], s80 offen sc1
    s_waitcnt vmcnt(0)
    v_xor_b32 v240, s3, v240
    v_xor_b32 v241, s3, v241
    v_xor_b32 v242, s3, v242
    v_xor_b32 v243, s3, v243
    v_or3_b32 v240, v240, v241, v242
    v_or_b32 v240, v240, v243
    v_cmp_ne_u32 vcc, 0, v240
    s_cbranch_vccz L_back_37
    s_sub_u32 s57, s57, 1
    s_cbranch_scc0 L_lp_75
    s_branch L_back_37
L_spin_38:
    s_mov_b32 s57, 20000
L_lp_76:
    buffer_load_dwordx4 v[232:235], v254, s[4:7], s74 offen sc1
    buffer_load_dwordx4 v[236:239], v254, s[4:7], s74 offen offset:2048 sc1
    s_waitcnt vmcnt(0)
    v_xor_b32 v250, s3, v233
    v_xor_b32 v251, s3, v235
    v_xor_b32 v252, s3, v237
    v_xor_b32 v253, s3, v239
    v_or3_b32 v250, v250, v251, v252
    v_or_b32 v250, v250, v253
    v_cmp_ne_u32 vcc, 0, v250
    s_cbranch_vccz L_px_77
    s_sub_u32 s57, s57, 1
    s_cbranch_scc0 L_lp_76
L_px_77:
    s_branch L_back_39
L_spin_44:
    s_mov_b32 s57, 20000
L_lp_78:
    buffer_load_dwordx4 v[250:253], v249, s[4:7], s80 offen sc1
    s_waitcnt vmcnt(0)
    v_xor_b32 v250, s3, v250
    v_xor_b32 v251, s3, v251
    v_xor_b32 v252, s3, v252
    v_xor_b32 v253, s3, v253
    v_or3_b32 v250, v250, v251, v252
    v_or_b32 v250, v250, v253
    v_cmp_ne_u32 vcc, 0, v250
    s_cbranch_vccz L_back_45
    s_sub_u32 s57, s57, 1
    s_cbranch_scc0 L_lp_78
    s_branch L_back_45
L_spin_47:
    s_mov_b32 s57, 20000
L_lp_79:
    buffer_load_dword v250, v249, s[4:7], s80 offen sc1
    s_waitcnt vmcnt(0)
    v_cmp_ne_u32 vcc, s3, v250
    s_cbranch_vccz L_back_48
    s_sub_u32 s57, s57, 1
    s_cbranch_scc0 L_lp_79
    s_branch L_back_48
L_spin_50:
    s_mov_b32 s57, 20000
L_lp_80:
    buffer_load_dword v250, v249, s[4:7], s80 offen offset:64 sc1
    s_waitcnt vmcnt(0)
    v_cmp_ne_u32 vcc, s3, v250
    s_cbranch_vccz L_back_51
    s_sub_u32 s57, s57, 1
    s_cbranch_scc0 L_lp_80
    s_branch L_back_51
L_mg_52:
    buffer_store_dwordx4 v[244:247], v58, s[4:7], s74 offen sc1
    s_branch L_mb_53
L_spin_54:
    s_mov_b32 s57, 20000
L_lp_81:
    buffer_load_dwordx4 v[64:67], v58, s[4:7], s79 offen sc1
    buffer_load_dwordx4 v[68:71], v58, s[4:7], s79 offen offset:1024 sc1
    s_waitcnt vmcnt(0)
    v_xor_b32 v250, s3, v65
    v_xor_b32 v251, s3, v67
    v_xor_b32 v252, s3, v69
    v_xor_b32 v253, s3, v71
    v_or3_b32 v250, v250, v251, v252
    v_or_b32 v250, v250, v253
    v_cmp_ne_u32 vcc, 0, v250
    s_cbranch_vccz L_px_82
    s_sub_u32 s57, s57, 1
    s_cbranch_scc0 L_lp_81
L_px_82:
    s_branch L_back_55
L_spin_59:
    s_mov_b32 s57, 20000
L_lp_83:
    buffer_load_dword v250, v249, s[4:7], s80 offen sc1
    s_waitcnt vmcnt(0)
    v_cmp_ne_u32 vcc, s3, v250
    s_cbranch_vccz L_back_60
    s_sub_u32 s57, s57, 1
    s_cbranch_scc0 L_lp_83
    s_branch L_back_60
L_spin_61:
    s_mov_b32 s57, 20000
L_lp_84:
    buffer_load_dwordx4 v[232:235], v254, s[4:7], s74 offen sc1
    buffer_load_dwordx4 v[236:239], v254, s[4:7], s74 offen offset:2048 sc1
    s_waitcnt vmcnt(0)
    v_xor_b32 v250, s3, v233
    v_xor_b32 v251, s3, v235
    v_xor_b32 v252, s3, v237
    v_xor_b32 v253, s3, v239
    v_or3_b32 v250, v250, v251, v252
    v_or_b32 v250, v250, v253
    v_cmp_ne_u32 vcc, 0, v250
    s_cbranch_vccz L_px_85
    s_sub_u32 s57, s57, 1
    s_cbranch_scc0 L_lp_84
L_px_85:
    s_branch L_back_62
L_spin_64:
    s_mov_b32 s57, 20000
L_lp_86:
    buffer_load_dword v250, v249, s[4:7], s80 offen sc1
    s_waitcnt vmcnt(0)
    v_cmp_ne_u32 vcc, s3, v250
    s_cbranch_vccz L_back_65
    s_sub_u32 s57, s57, 1
    s_cbranch_scc0 L_lp_86
    s_branch L_back_65
L_spin_67:
    s_mov_b32 s57, 20000
L_lp_87:
    buffer_load_dword v250, v249, s[4:7], s80 offen offset:64 sc1
    s_waitcnt vmcnt(0)
    v_cmp_ne_u32 vcc, s3, v250
    s_cbranch_vccz L_back_68
    s_sub_u32 s57, s57, 1
    s_cbranch_scc0 L_lp_87
    s_branch L_back_68
L_exit:
L_code_end:
    s_endpgm
.section .rodata,"a"
.p2align 6
.amdhsa_kernel interleave_layers__ssm_conv_h3__swiglu_ffn__prompt_kernel
  .amdhsa_next_free_vgpr 512
  .amdhsa_next_free_sgpr 102
  .amdhsa_accum_offset 256
  .amdhsa_group_segment_fixed_size 0
  .amdhsa_kernarg_size 104
  .amdhsa_user_sgpr_count 2
  .amdhsa_user_sgpr_kernarg_segment_ptr 1
  .amdhsa_system_sgpr_workgroup_id_x 1
.end_amdhsa_kernel
```
